```python
import torch

def _softmax(x, axis=-1):
    return torch.softmax(x, dim=axis)
def _gelu(x):
    return torch.nn.functional.gelu(x, approximate="tanh")
def _silu(x):
    return torch.nn.functional.silu(x)
def _sigmoid(x):
    return torch.sigmoid(x)
def _layernorm(x, axis=-1, eps=1e-5):
    m = x.mean(dim=axis, keepdim=True)
    v = x.var(dim=axis, keepdim=True, unbiased=False)
    return (x - m) / torch.sqrt(v + eps)
def _scatter_add(tgt, idx, src, axis=0):
    return tgt.clone().index_add_(axis, idx, src)
def _segment_sum(src, seg, n):
    out = torch.zeros((n,) + src.shape[1:], dtype=src.dtype)
    return out.index_add_(0, seg, src)
def _pad(x, pw):
    flat = tuple(v for pair in reversed(pw) for v in pair)
    return torch.nn.functional.pad(x, flat)

kernel_name = 'standalone__gqa_block_cached__near_ridge'

def setup_inputs():

    _w = (lambda a: (lambda t: t.to(torch.bfloat16) if t.is_floating_point() else t)(torch.as_tensor(a)))
    B, Sq, D = 32, 48, 448
    Hq, Hkv, Sk, Dh = 16, 8, 512, 256
    assert Hq % Hkv == 0, (Hq, Hkv)
    return {
        "x": _w((lambda *s: torch.randn(*s, dtype=torch.bfloat16) * 0.8)(B, Sq, D)),
        "k_cache": _w((lambda *s: torch.randn(*s, dtype=torch.bfloat16) * 0.8)(B, Hkv, Sk, Dh)),
        "v_cache": _w((lambda *s: torch.randn(*s, dtype=torch.bfloat16) * 0.05)(B, Hkv, Sk, Dh)),
        "wq": _w((lambda *s: torch.randn(*s, dtype=torch.bfloat16) * 0.8)(D, Hq * Dh) * (D ** -0.5)),
        "wo": _w((lambda *s: torch.randn(*s, dtype=torch.bfloat16) * 0.05)(Hq * Dh, D) * ((Hq * Dh) ** -0.5)),
    }

def reference(x, k_cache, v_cache, wq, wo):
    B, Sq, D = x.shape
    Hq, Dh = 16, 256
    Hkv = k_cache.shape[1]
    rep = Hq // Hkv
    q = (lambda x, *d: x.permute(*d))((x @ wq).reshape(B, Sq, Hq, Dh), 0, 2, 1, 3)
    k = (lambda x, n, axis: torch.repeat_interleave(x, n, dim=axis))(k_cache, rep, axis=1)
    v = (lambda x, n, axis: torch.repeat_interleave(x, n, dim=axis))(v_cache, rep, axis=1)
    scores = torch.einsum("bhqd,bhkd->bhqk", q, k) * (Dh ** -0.5)
    p = _softmax(scores, axis=-1)
    o = torch.einsum("bhqk,bhkd->bhqd", p, v)
    return (lambda x, *d: x.permute(*d))(o, 0, 2, 1, 3).reshape(B, Sq, Hq * Dh) @ wo
```

```asm
; @launch grid=(256,1,1) block=(512,1,1) lds=163840
.amdgcn_target "amdgcn-amd-amdhsa--gfx950"
.text
.globl standalone__gqa_block_cached__near_ridge_kernel
.p2align 8
.type standalone__gqa_block_cached__near_ridge_kernel,@function
standalone__gqa_block_cached__near_ridge_kernel:
s_load_dwordx16 s[4:19], s[0:1], 0
s_cmp_ge_u32 s2, 256
s_cbranch_scc0 L_go
L_end:
s_endpgm
L_go:
v_lshrrev_b32 v3, 6, v0
s_lshr_b32 s55, s2, 3
s_and_b32 s3, s2, 7
v_readfirstlane_b32 s52, v3
v_and_b32 v1, 63, v0
v_lshrrev_b32 v2, 3, v1
v_and_b32 v2, 6, v2
v_xor_b32 v2, v2, v1
v_and_b32 v2, 7, v2
v_lshlrev_b32 v2, 4, v2
v_lshrrev_b32 v12, 3, v1
s_mul_i32 s61, s55, 43008
s_lshl_b32 s64, s3, 10
s_mov_b32 s22, 43008
s_mov_b32 s23, 0x20000
s_sub_u32 s34, 3670016, s64
s_mov_b32 s35, 0x20000
s_cmp_ge_u32 s52, 6
s_cbranch_scc1 L_hp
v_lshrrev_b32 v3, 3, v0
v_mul_u32_u24 v3, 896, v3
v_add_u32 v3, v3, v2
s_lshl_b32 s53, s52, 10
s_waitcnt lgkmcnt(0)
s_add_u32 s20, s4, s61
s_addc_u32 s21, s5, 0
s_and_b32 s21, s21, 0xffff
s_add_u32 m0, s53, 32768
s_movk_i32 s54, 0
buffer_load_dwordx4 v3, s[20:23], s54 offen  lds
s_add_u32 m0, s53, 38912
s_movk_i32 s54, 128
buffer_load_dwordx4 v3, s[20:23], s54 offen  lds
s_add_u32 m0, s53, 45056
s_movk_i32 s54, 256
buffer_load_dwordx4 v3, s[20:23], s54 offen  lds
s_add_u32 m0, s53, 51200
s_movk_i32 s54, 384
buffer_load_dwordx4 v3, s[20:23], s54 offen  lds
s_add_u32 m0, s53, 57344
s_movk_i32 s54, 512
buffer_load_dwordx4 v3, s[20:23], s54 offen  lds
s_add_u32 m0, s53, 63488
s_movk_i32 s54, 640
buffer_load_dwordx4 v3, s[20:23], s54 offen  lds
s_add_u32 m0, s53, 69632
s_movk_i32 s54, 768
buffer_load_dwordx4 v3, s[20:23], s54 offen  lds
s_add_u32 s32, s10, s64
s_addc_u32 s33, s11, 0
s_and_b32 s33, s33, 0xffff
s_branch L_hq
L_hp:
s_and_b32 s60, s52, 1
s_lshl_b32 s60, s60, 5
s_add_u32 s60, s60, s55
s_lshl_b32 s60, s60, 7
v_lshl_add_u32 v4, v1, 13, s60
v_min_u32 v4, L_last-L_pc-4, v4
s_getpc_b64 s[44:45]
L_pc:
v_mov_b32 v5, s45
v_add_co_u32 v4, vcc, s44, v4
s_nop 1
v_addc_co_u32 v5, vcc, 0, v5, vcc
s_mov_b64 exec, 63
global_load_dword v15, v[4:5], off
s_mov_b64 exec, -1
s_lshl_b32 s60, s55, 1
s_add_u32 s60, s60, s52
s_sub_u32 s60, s60, 6
s_mul_i32 s60, s60, 57344
v_and_b32 v3, 7, v1
v_lshlrev_b32 v3, 7, v3
v_lshl_add_u32 v3, v12, 13, v3
s_waitcnt lgkmcnt(0)
s_add_u32 s32, s10, s64
s_addc_u32 s33, s11, 0
s_and_b32 s33, s33, 0xffff
s_mov_b32 exec_lo, 0xffffffff
s_mov_b32 exec_hi, 0xffffff
buffer_load_dword v14, v3, s[32:35], s60 offen
s_mov_b64 exec, -1
L_hq:
s_lshl_b32 s60, s2, 18
s_mul_i32 s65, s3, 458752
s_mul_i32 s54, s55, 346112
s_add_u32 s24, s6, s60
s_addc_u32 s25, s7, 0
s_and_b32 s25, s25, 0xffff
s_mov_b32 s26, 262144
s_mov_b32 s27, 0x20000
s_add_u32 s28, s8, s60
s_addc_u32 s29, s9, 0
s_and_b32 s29, s29, 0xffff
s_mov_b32 s30, 262144
s_mov_b32 s31, 0x20000
s_add_u32 s36, s12, s65
s_addc_u32 s37, s13, 0
s_and_b32 s37, s37, 0xffff
s_mov_b32 s38, 458752
s_mov_b32 s39, 0x20000
s_add_u32 s40, s18, s54
s_addc_u32 s41, s19, 0
s_and_b32 s41, s41, 0xffff
s_mov_b32 s42, 344064
s_mov_b32 s43, 0x20000
s_add_u32 s48, s40, 344064
s_addc_u32 s49, s41, 0
s_mov_b32 s50, 2048
s_mov_b32 s51, 0x20000
s_mov_b32 s57, 0x100000
v_mov_b32 v10, 0
s_cmp_lg_u32 s52, 7
s_cbranch_scc1 L_tch0
s_mov_b64 exec, 1
buffer_load_dword v15, v10, s[24:27], 0 offen offset:0 nt
buffer_load_dword v15, v10, s[28:31], 0 offen offset:0 nt
buffer_load_dword v15, v10, s[36:39], 0 offen offset:0 nt
buffer_load_dword v15, v10, s[48:51], 0 offen offset:1024 nt
s_mov_b64 exec, -1
L_tch0:
s_barrier
s_cmp_lt_u32 s52, 4
s_cbranch_scc1 L_attn
s_sub_u32 s60, s52, 4
s_lshl_b32 s53, s60, 10
v_lshl_add_u32 v3, v12, 9, v2
s_lshl_b32 s61, s60, 12
v_add_u32 v3, s61, v3
v_and_b32 v13, 4, v12
v_add_u32 v13, v13, v12
s_lshr_b32 s61, s60, 1
s_lshl_b32 s61, s61, 4
s_and_b32 s64, s60, 1
s_lshl_b32 s64, s64, 2
s_add_u32 s61, s61, s64
v_add_u32 v13, s61, v13
v_lshl_add_u32 v4, v13, 13, v2
s_add_u32 m0, s53, 98304
s_mov_b32 s54, 0
buffer_load_dwordx4 v4, s[32:35], s54 offen  lds
s_add_u32 m0, s53, 102400
s_mov_b32 s54, 262144
buffer_load_dwordx4 v4, s[32:35], s54 offen  lds
s_add_u32 m0, s53, 106496
s_mov_b32 s54, 524288
buffer_load_dwordx4 v4, s[32:35], s54 offen  lds
s_add_u32 m0, s53, 110592
s_mov_b32 s54, 786432
buffer_load_dwordx4 v4, s[32:35], s54 offen  lds
s_lshl_b32 s61, s60, 3
v_add_u32 v13, s61, v12
v_mul_u32_u24 v5, 896, v13
v_add_u32 v5, v5, v2
v_lshrrev_b32 v12, 5, v1
v_mul_u32_u24 v6, 2048, v12
v_bfe_u32 v12, v1, 2, 3
v_lshl_add_u32 v6, v12, 7, v6
v_bfe_u32 v12, v1, 3, 2
v_lshl_add_u32 v6, v12, 5, v6
v_and_b32 v12, 3, v1
v_lshl_add_u32 v6, v12, 3, v6
s_lshl_b32 s61, s60, 5
v_xor_b32 v6, s61, v6
v_add_u32 v6, 98304, v6
v_and_b32 v12, 15, v1
v_lshlrev_b32 v7, 4, v12
v_lshrrev_b32 v12, 5, v1
v_lshl_add_u32 v7, v12, 8, v7
v_bfe_u32 v12, v1, 4, 1
v_lshl_add_u32 v7, v12, 3, v7
s_lshr_b32 s61, s60, 1
s_mul_i32 s61, s61, 3072
s_and_b32 s64, s60, 1
s_lshl_b32 s64, s64, 9
s_add_u32 s61, s61, s64
s_add_u32 s61, s61, 155648
v_add_u32 v7, s61, v7
v_and_b32 v13, 15, v1
v_lshlrev_b32 v12, 7, v13
v_and_b32 v13, 6, v1
v_lshrrev_b32 v10, 4, v1
v_xor_b32 v13, v13, v10
v_lshl_add_u32 v12, v13, 4, v12
v_add_u32 v12, 32768, v12
v_xor_b32 v13, 64, v12
s_add_u32 m0, s53, 114688
s_mov_b32 s54, 1048576
buffer_load_dwordx4 v4, s[32:35], s54 offen  lds
s_add_u32 m0, s53, 118784
s_mov_b32 s54, 1310720
buffer_load_dwordx4 v4, s[32:35], s54 offen  lds
s_add_u32 m0, s53, 122880
s_mov_b32 s54, 1572864
buffer_load_dwordx4 v4, s[32:35], s54 offen  lds
s_add_u32 m0, s53, 126976
s_mov_b32 s54, 1835008
buffer_load_dwordx4 v4, s[32:35], s54 offen  lds
s_add_u32 m0, s53, 131072
s_mov_b32 s54, 2097152
buffer_load_dwordx4 v4, s[32:35], s54 offen  lds
s_add_u32 m0, s53, 135168
s_mov_b32 s54, 2359296
buffer_load_dwordx4 v4, s[32:35], s54 offen  lds
s_add_u32 m0, s53, 139264
s_mov_b32 s54, 2621440
buffer_load_dwordx4 v4, s[32:35], s54 offen  lds
s_add_u32 m0, s53, 143360
s_mov_b32 s54, 2883584
buffer_load_dwordx4 v4, s[32:35], s54 offen  lds
s_add_u32 m0, s53, 147456
s_mov_b32 s54, 3145728
buffer_load_dwordx4 v4, s[32:35], s54 offen  lds
s_add_u32 m0, s53, 151552
s_mov_b32 s54, 3407872
buffer_load_dwordx4 v4, s[32:35], s54 offen  lds
s_waitcnt vmcnt(14)
s_barrier
ds_read_b128 v[16:19], v12 offset:0
ds_read_b128 v[20:23], v12 offset:2048
ds_read_b128 v[24:27], v12 offset:4096
ds_read_b128 v[28:31], v13 offset:0
ds_read_b128 v[32:35], v13 offset:2048
ds_read_b128 v[36:39], v13 offset:4096
s_add_u32 m0, s53, 0
s_mov_b32 s54, 0
buffer_load_dwordx4 v3, s[24:27], s54 offen nt lds
ds_read_b128 v[40:43], v12 offset:6144
ds_read_b128 v[44:47], v12 offset:8192
ds_read_b128 v[48:51], v12 offset:10240
ds_read_b128 v[52:55], v13 offset:6144
ds_read_b128 v[56:59], v13 offset:8192
ds_read_b128 v[60:63], v13 offset:10240
s_add_u32 m0, s53, 4096
s_mov_b32 s54, 16384
buffer_load_dwordx4 v3, s[24:27], s54 offen nt lds
ds_read_b128 v[64:67], v12 offset:12288
ds_read_b128 v[68:71], v12 offset:14336
ds_read_b128 v[72:75], v12 offset:16384
ds_read_b128 v[76:79], v13 offset:12288
ds_read_b128 v[80:83], v13 offset:14336
ds_read_b128 v[84:87], v13 offset:16384
s_add_u32 m0, s53, 8192
s_mov_b32 s54, 32768
buffer_load_dwordx4 v3, s[24:27], s54 offen nt lds
ds_read_b128 v[88:91], v12 offset:18432
ds_read_b128 v[92:95], v12 offset:20480
ds_read_b128 v[96:99], v12 offset:22528
s_add_u32 m0, s53, 12288
s_mov_b32 s54, 49152
buffer_load_dwordx4 v3, s[24:27], s54 offen nt lds
ds_read_b128 v[100:103], v13 offset:18432
ds_read_b128 v[104:107], v13 offset:20480
ds_read_b128 v[108:111], v13 offset:22528
ds_read_b128 v[112:115], v12 offset:24576
ds_read_b128 v[116:119], v12 offset:26624
ds_read_b128 v[120:123], v12 offset:28672
s_add_u32 m0, s53, 16384
s_mov_b32 s54, 65536
buffer_load_dwordx4 v3, s[24:27], s54 offen nt lds
ds_read_b128 v[124:127], v13 offset:24576
ds_read_b128 v[128:131], v13 offset:26624
ds_read_b128 v[132:135], v13 offset:28672
ds_read_b128 v[136:139], v12 offset:30720
ds_read_b128 v[140:143], v12 offset:32768
ds_read_b128 v[144:147], v12 offset:34816
s_add_u32 m0, s53, 20480
s_mov_b32 s54, 81920
buffer_load_dwordx4 v3, s[24:27], s54 offen nt lds
ds_read_b128 v[148:151], v13 offset:30720
ds_read_b128 v[152:155], v13 offset:32768
ds_read_b128 v[156:159], v13 offset:34816
ds_read_b128 v[160:163], v12 offset:36864
ds_read_b128 v[164:167], v12 offset:38912
ds_read_b128 v[168:171], v12 offset:40960
s_add_u32 m0, s53, 24576
s_mov_b32 s54, 98304
buffer_load_dwordx4 v3, s[24:27], s54 offen nt lds
ds_read_b128 v[172:175], v13 offset:36864
ds_read_b128 v[176:179], v13 offset:38912
ds_read_b128 v[180:183], v13 offset:40960
s_add_u32 m0, s53, 28672
s_mov_b32 s54, 114688
buffer_load_dwordx4 v3, s[24:27], s54 offen nt lds
s_setprio 1
s_waitcnt vmcnt(8)
s_barrier
ds_read_b64_tr_b16 v[184:185], v6 offset:0
ds_read_b64_tr_b16 v[186:187], v6 offset:1024
ds_read_b64_tr_b16 v[188:189], v6 offset:4096
ds_read_b64_tr_b16 v[190:191], v6 offset:5120
ds_read_b64_tr_b16 v[192:193], v6 offset:8192
ds_read_b64_tr_b16 v[194:195], v6 offset:9216
ds_read_b64_tr_b16 v[196:197], v6 offset:12288
ds_read_b64_tr_b16 v[198:199], v6 offset:13312
ds_read_b64_tr_b16 v[200:201], v6 offset:16384
ds_read_b64_tr_b16 v[202:203], v6 offset:17408
ds_read_b64_tr_b16 v[204:205], v6 offset:20480
ds_read_b64_tr_b16 v[206:207], v6 offset:21504
ds_read_b64_tr_b16 v[208:209], v6 offset:24576
ds_read_b64_tr_b16 v[210:211], v6 offset:25600
ds_read_b64_tr_b16 v[212:213], v6 offset:28672
ds_read_b64_tr_b16 v[214:215], v6 offset:29696
ds_read_b64_tr_b16 v[216:217], v6 offset:32768
ds_read_b64_tr_b16 v[218:219], v6 offset:33792
ds_read_b64_tr_b16 v[220:221], v6 offset:36864
ds_read_b64_tr_b16 v[222:223], v6 offset:37888
ds_read_b64_tr_b16 v[224:225], v6 offset:40960
ds_read_b64_tr_b16 v[226:227], v6 offset:41984
ds_read_b64_tr_b16 v[228:229], v6 offset:45056
ds_read_b64_tr_b16 v[230:231], v6 offset:46080
ds_read_b64_tr_b16 v[232:233], v6 offset:49152
ds_read_b64_tr_b16 v[234:235], v6 offset:50176
ds_read_b64_tr_b16 v[236:237], v6 offset:53248
ds_read_b64_tr_b16 v[238:239], v6 offset:54272
s_waitcnt lgkmcnt(0)
s_barrier
s_add_u32 m0, s53, 98304
s_mov_b32 s54, 512
buffer_load_dwordx4 v4, s[32:35], s54 offen  lds
s_add_u32 m0, s53, 102400
s_mov_b32 s54, 262656
buffer_load_dwordx4 v4, s[32:35], s54 offen  lds
v_mfma_f32_16x16x32_bf16 v[240:243], v[184:187], v[16:19], 0
v_mfma_f32_16x16x32_bf16 v[240:243], v[188:191], v[28:31], v[240:243]
v_mfma_f32_16x16x32_bf16 v[240:243], v[192:195], v[40:43], v[240:243]
s_add_u32 m0, s53, 106496
s_mov_b32 s54, 524800
buffer_load_dwordx4 v4, s[32:35], s54 offen  lds
v_mfma_f32_16x16x32_bf16 v[240:243], v[196:199], v[52:55], v[240:243]
v_mfma_f32_16x16x32_bf16 v[240:243], v[200:203], v[64:67], v[240:243]
v_mfma_f32_16x16x32_bf16 v[240:243], v[204:207], v[76:79], v[240:243]
s_add_u32 m0, s53, 110592
s_mov_b32 s54, 786944
buffer_load_dwordx4 v4, s[32:35], s54 offen  lds
s_add_u32 m0, s53, 114688
s_mov_b32 s54, 1049088
buffer_load_dwordx4 v4, s[32:35], s54 offen  lds
v_mfma_f32_16x16x32_bf16 v[240:243], v[208:211], v[88:91], v[240:243]
v_mfma_f32_16x16x32_bf16 v[240:243], v[212:215], v[100:103], v[240:243]
v_mfma_f32_16x16x32_bf16 v[240:243], v[216:219], v[112:115], v[240:243]
s_add_u32 m0, s53, 118784
s_mov_b32 s54, 1311232
buffer_load_dwordx4 v4, s[32:35], s54 offen  lds
v_mfma_f32_16x16x32_bf16 v[240:243], v[220:223], v[124:127], v[240:243]
v_mfma_f32_16x16x32_bf16 v[240:243], v[224:227], v[136:139], v[240:243]
v_mfma_f32_16x16x32_bf16 v[240:243], v[228:231], v[148:151], v[240:243]
s_add_u32 m0, s53, 122880
s_mov_b32 s54, 1573376
buffer_load_dwordx4 v4, s[32:35], s54 offen  lds
s_add_u32 m0, s53, 126976
s_mov_b32 s54, 1835520
buffer_load_dwordx4 v4, s[32:35], s54 offen  lds
v_mfma_f32_16x16x32_bf16 v[240:243], v[232:235], v[160:163], v[240:243]
v_mfma_f32_16x16x32_bf16 v[240:243], v[236:239], v[172:175], v[240:243]
v_mfma_f32_16x16x32_bf16 v[244:247], v[184:187], v[20:23], 0
s_add_u32 m0, s53, 131072
s_mov_b32 s54, 2097664
buffer_load_dwordx4 v4, s[32:35], s54 offen  lds
v_mfma_f32_16x16x32_bf16 v[244:247], v[188:191], v[32:35], v[244:247]
v_mfma_f32_16x16x32_bf16 v[244:247], v[192:195], v[44:47], v[244:247]
v_mfma_f32_16x16x32_bf16 v[244:247], v[196:199], v[56:59], v[244:247]
s_add_u32 m0, s53, 135168
s_mov_b32 s54, 2359808
buffer_load_dwordx4 v4, s[32:35], s54 offen  lds
s_add_u32 m0, s53, 139264
s_mov_b32 s54, 2621952
buffer_load_dwordx4 v4, s[32:35], s54 offen  lds
v_mfma_f32_16x16x32_bf16 v[244:247], v[200:203], v[68:71], v[244:247]
v_mfma_f32_16x16x32_bf16 v[244:247], v[204:207], v[80:83], v[244:247]
v_mfma_f32_16x16x32_bf16 v[244:247], v[208:211], v[92:95], v[244:247]
s_add_u32 m0, s53, 143360
s_mov_b32 s54, 2884096
buffer_load_dwordx4 v4, s[32:35], s54 offen  lds
v_mfma_f32_16x16x32_bf16 v[244:247], v[212:215], v[104:107], v[244:247]
v_mfma_f32_16x16x32_bf16 v[244:247], v[216:219], v[116:119], v[244:247]
v_mfma_f32_16x16x32_bf16 v[244:247], v[220:223], v[128:131], v[244:247]
s_add_u32 m0, s53, 147456
s_mov_b32 s54, 3146240
buffer_load_dwordx4 v4, s[32:35], s54 offen  lds
s_add_u32 m0, s53, 151552
s_mov_b32 s54, 3408384
buffer_load_dwordx4 v4, s[32:35], s54 offen  lds
s_barrier
s_add_u32 m0, s53, 32768
s_mov_b32 s54, 131072
buffer_load_dwordx4 v3, s[24:27], s54 offen nt lds
s_add_u32 m0, s53, 36864
s_mov_b32 s54, 147456
buffer_load_dwordx4 v3, s[24:27], s54 offen nt lds
v_mfma_f32_16x16x32_bf16 v[244:247], v[224:227], v[140:143], v[244:247]
v_mfma_f32_16x16x32_bf16 v[244:247], v[228:231], v[152:155], v[244:247]
v_mfma_f32_16x16x32_bf16 v[244:247], v[232:235], v[164:167], v[244:247]
v_mfma_f32_16x16x32_bf16 v[244:247], v[236:239], v[176:179], v[244:247]
v_mfma_f32_16x16x32_bf16 v[248:251], v[184:187], v[24:27], 0
v_mfma_f32_16x16x32_bf16 v[248:251], v[188:191], v[36:39], v[248:251]
s_add_u32 m0, s53, 40960
s_mov_b32 s54, 163840
buffer_load_dwordx4 v3, s[24:27], s54 offen nt lds
v_mfma_f32_16x16x32_bf16 v[248:251], v[192:195], v[48:51], v[248:251]
v_mfma_f32_16x16x32_bf16 v[248:251], v[196:199], v[60:63], v[248:251]
v_mfma_f32_16x16x32_bf16 v[248:251], v[200:203], v[72:75], v[248:251]
s_add_u32 m0, s53, 45056
s_mov_b32 s54, 180224
buffer_load_dwordx4 v3, s[24:27], s54 offen nt lds
v_mfma_f32_16x16x32_bf16 v[248:251], v[204:207], v[84:87], v[248:251]
v_mfma_f32_16x16x32_bf16 v[248:251], v[208:211], v[96:99], v[248:251]
v_mfma_f32_16x16x32_bf16 v[248:251], v[212:215], v[108:111], v[248:251]
s_add_u32 m0, s53, 49152
s_mov_b32 s54, 196608
buffer_load_dwordx4 v3, s[24:27], s54 offen nt lds
v_mfma_f32_16x16x32_bf16 v[248:251], v[216:219], v[120:123], v[248:251]
v_mfma_f32_16x16x32_bf16 v[248:251], v[220:223], v[132:135], v[248:251]
v_mfma_f32_16x16x32_bf16 v[248:251], v[224:227], v[144:147], v[248:251]
s_add_u32 m0, s53, 53248
s_mov_b32 s54, 212992
buffer_load_dwordx4 v3, s[24:27], s54 offen nt lds
v_mfma_f32_16x16x32_bf16 v[248:251], v[228:231], v[156:159], v[248:251]
v_mfma_f32_16x16x32_bf16 v[248:251], v[232:235], v[168:171], v[248:251]
v_mfma_f32_16x16x32_bf16 v[248:251], v[236:239], v[180:183], v[248:251]
s_add_u32 m0, s53, 57344
s_mov_b32 s54, 229376
buffer_load_dwordx4 v3, s[24:27], s54 offen nt lds
s_add_u32 m0, s53, 61440
s_mov_b32 s54, 245760
buffer_load_dwordx4 v3, s[24:27], s54 offen nt lds
v_cvt_pk_bf16_f32 v240, v240, v241
v_cvt_pk_bf16_f32 v241, v242, v243
v_cvt_pk_bf16_f32 v244, v244, v245
v_cvt_pk_bf16_f32 v245, v246, v247
v_cvt_pk_bf16_f32 v248, v248, v249
v_cvt_pk_bf16_f32 v249, v250, v251
s_waitcnt vmcnt(8)
s_barrier
ds_write_b64 v7, v[240:241] offset:0
ds_write_b64 v7, v[244:245] offset:1024
ds_write_b64 v7, v[248:249] offset:2048
ds_read_b64_tr_b16 v[184:185], v6 offset:0
ds_read_b64_tr_b16 v[186:187], v6 offset:1024
ds_read_b64_tr_b16 v[188:189], v6 offset:4096
ds_read_b64_tr_b16 v[190:191], v6 offset:5120
ds_read_b64_tr_b16 v[192:193], v6 offset:8192
ds_read_b64_tr_b16 v[194:195], v6 offset:9216
ds_read_b64_tr_b16 v[196:197], v6 offset:12288
ds_read_b64_tr_b16 v[198:199], v6 offset:13312
ds_read_b64_tr_b16 v[200:201], v6 offset:16384
ds_read_b64_tr_b16 v[202:203], v6 offset:17408
ds_read_b64_tr_b16 v[204:205], v6 offset:20480
ds_read_b64_tr_b16 v[206:207], v6 offset:21504
ds_read_b64_tr_b16 v[208:209], v6 offset:24576
ds_read_b64_tr_b16 v[210:211], v6 offset:25600
ds_read_b64_tr_b16 v[212:213], v6 offset:28672
ds_read_b64_tr_b16 v[214:215], v6 offset:29696
ds_read_b64_tr_b16 v[216:217], v6 offset:32768
ds_read_b64_tr_b16 v[218:219], v6 offset:33792
ds_read_b64_tr_b16 v[220:221], v6 offset:36864
ds_read_b64_tr_b16 v[222:223], v6 offset:37888
ds_read_b64_tr_b16 v[224:225], v6 offset:40960
ds_read_b64_tr_b16 v[226:227], v6 offset:41984
ds_read_b64_tr_b16 v[228:229], v6 offset:45056
ds_read_b64_tr_b16 v[230:231], v6 offset:46080
ds_read_b64_tr_b16 v[232:233], v6 offset:49152
ds_read_b64_tr_b16 v[234:235], v6 offset:50176
ds_read_b64_tr_b16 v[236:237], v6 offset:53248
ds_read_b64_tr_b16 v[238:239], v6 offset:54272
s_waitcnt lgkmcnt(0)
s_barrier
s_add_u32 m0, s53, 98304
s_mov_b32 s54, 128
buffer_load_dwordx4 v4, s[32:35], s54 offen  lds
s_add_u32 m0, s53, 102400
s_mov_b32 s54, 262272
buffer_load_dwordx4 v4, s[32:35], s54 offen  lds
v_mfma_f32_16x16x32_bf16 v[240:243], v[184:187], v[16:19], 0
v_mfma_f32_16x16x32_bf16 v[240:243], v[188:191], v[28:31], v[240:243]
v_mfma_f32_16x16x32_bf16 v[240:243], v[192:195], v[40:43], v[240:243]
s_add_u32 m0, s53, 106496
s_mov_b32 s54, 524416
buffer_load_dwordx4 v4, s[32:35], s54 offen  lds
v_mfma_f32_16x16x32_bf16 v[240:243], v[196:199], v[52:55], v[240:243]
v_mfma_f32_16x16x32_bf16 v[240:243], v[200:203], v[64:67], v[240:243]
v_mfma_f32_16x16x32_bf16 v[240:243], v[204:207], v[76:79], v[240:243]
s_add_u32 m0, s53, 110592
s_mov_b32 s54, 786560
buffer_load_dwordx4 v4, s[32:35], s54 offen  lds
s_add_u32 m0, s53, 114688
s_mov_b32 s54, 1048704
buffer_load_dwordx4 v4, s[32:35], s54 offen  lds
v_mfma_f32_16x16x32_bf16 v[240:243], v[208:211], v[88:91], v[240:243]
v_mfma_f32_16x16x32_bf16 v[240:243], v[212:215], v[100:103], v[240:243]
v_mfma_f32_16x16x32_bf16 v[240:243], v[216:219], v[112:115], v[240:243]
s_add_u32 m0, s53, 118784
s_mov_b32 s54, 1310848
buffer_load_dwordx4 v4, s[32:35], s54 offen  lds
v_mfma_f32_16x16x32_bf16 v[240:243], v[220:223], v[124:127], v[240:243]
v_mfma_f32_16x16x32_bf16 v[240:243], v[224:227], v[136:139], v[240:243]
v_mfma_f32_16x16x32_bf16 v[240:243], v[228:231], v[148:151], v[240:243]
s_add_u32 m0, s53, 122880
s_mov_b32 s54, 1572992
buffer_load_dwordx4 v4, s[32:35], s54 offen  lds
s_add_u32 m0, s53, 126976
s_mov_b32 s54, 1835136
buffer_load_dwordx4 v4, s[32:35], s54 offen  lds
v_mfma_f32_16x16x32_bf16 v[240:243], v[232:235], v[160:163], v[240:243]
v_mfma_f32_16x16x32_bf16 v[240:243], v[236:239], v[172:175], v[240:243]
v_mfma_f32_16x16x32_bf16 v[244:247], v[184:187], v[20:23], 0
s_add_u32 m0, s53, 131072
s_mov_b32 s54, 2097280
buffer_load_dwordx4 v4, s[32:35], s54 offen  lds
v_mfma_f32_16x16x32_bf16 v[244:247], v[188:191], v[32:35], v[244:247]
v_mfma_f32_16x16x32_bf16 v[244:247], v[192:195], v[44:47], v[244:247]
v_mfma_f32_16x16x32_bf16 v[244:247], v[196:199], v[56:59], v[244:247]
s_add_u32 m0, s53, 135168
s_mov_b32 s54, 2359424
buffer_load_dwordx4 v4, s[32:35], s54 offen  lds
s_add_u32 m0, s53, 139264
s_mov_b32 s54, 2621568
buffer_load_dwordx4 v4, s[32:35], s54 offen  lds
v_mfma_f32_16x16x32_bf16 v[244:247], v[200:203], v[68:71], v[244:247]
v_mfma_f32_16x16x32_bf16 v[244:247], v[204:207], v[80:83], v[244:247]
v_mfma_f32_16x16x32_bf16 v[244:247], v[208:211], v[92:95], v[244:247]
s_add_u32 m0, s53, 143360
s_mov_b32 s54, 2883712
buffer_load_dwordx4 v4, s[32:35], s54 offen  lds
v_mfma_f32_16x16x32_bf16 v[244:247], v[212:215], v[104:107], v[244:247]
v_mfma_f32_16x16x32_bf16 v[244:247], v[216:219], v[116:119], v[244:247]
v_mfma_f32_16x16x32_bf16 v[244:247], v[220:223], v[128:131], v[244:247]
s_add_u32 m0, s53, 147456
s_mov_b32 s54, 3145856
buffer_load_dwordx4 v4, s[32:35], s54 offen  lds
s_add_u32 m0, s53, 151552
s_mov_b32 s54, 3408000
buffer_load_dwordx4 v4, s[32:35], s54 offen  lds
s_barrier
s_add_u32 m0, s53, 65536
s_mov_b32 s54, 128
buffer_load_dwordx4 v3, s[24:27], s54 offen nt lds
s_add_u32 m0, s53, 69632
s_mov_b32 s54, 16512
buffer_load_dwordx4 v3, s[24:27], s54 offen nt lds
v_mfma_f32_16x16x32_bf16 v[244:247], v[224:227], v[140:143], v[244:247]
v_mfma_f32_16x16x32_bf16 v[244:247], v[228:231], v[152:155], v[244:247]
v_mfma_f32_16x16x32_bf16 v[244:247], v[232:235], v[164:167], v[244:247]
v_mfma_f32_16x16x32_bf16 v[244:247], v[236:239], v[176:179], v[244:247]
v_mfma_f32_16x16x32_bf16 v[248:251], v[184:187], v[24:27], 0
v_mfma_f32_16x16x32_bf16 v[248:251], v[188:191], v[36:39], v[248:251]
s_add_u32 m0, s53, 73728
s_mov_b32 s54, 32896
buffer_load_dwordx4 v3, s[24:27], s54 offen nt lds
v_mfma_f32_16x16x32_bf16 v[248:251], v[192:195], v[48:51], v[248:251]
v_mfma_f32_16x16x32_bf16 v[248:251], v[196:199], v[60:63], v[248:251]
v_mfma_f32_16x16x32_bf16 v[248:251], v[200:203], v[72:75], v[248:251]
s_add_u32 m0, s53, 77824
s_mov_b32 s54, 49280
buffer_load_dwordx4 v3, s[24:27], s54 offen nt lds
v_mfma_f32_16x16x32_bf16 v[248:251], v[204:207], v[84:87], v[248:251]
v_mfma_f32_16x16x32_bf16 v[248:251], v[208:211], v[96:99], v[248:251]
v_mfma_f32_16x16x32_bf16 v[248:251], v[212:215], v[108:111], v[248:251]
s_add_u32 m0, s53, 81920
s_mov_b32 s54, 65664
buffer_load_dwordx4 v3, s[24:27], s54 offen nt lds
v_mfma_f32_16x16x32_bf16 v[248:251], v[216:219], v[120:123], v[248:251]
v_mfma_f32_16x16x32_bf16 v[248:251], v[220:223], v[132:135], v[248:251]
v_mfma_f32_16x16x32_bf16 v[248:251], v[224:227], v[144:147], v[248:251]
s_add_u32 m0, s53, 86016
s_mov_b32 s54, 82048
buffer_load_dwordx4 v3, s[24:27], s54 offen nt lds
v_mfma_f32_16x16x32_bf16 v[248:251], v[228:231], v[156:159], v[248:251]
v_mfma_f32_16x16x32_bf16 v[248:251], v[232:235], v[168:171], v[248:251]
v_mfma_f32_16x16x32_bf16 v[248:251], v[236:239], v[180:183], v[248:251]
s_add_u32 m0, s53, 90112
s_mov_b32 s54, 98432
buffer_load_dwordx4 v3, s[24:27], s54 offen nt lds
s_add_u32 m0, s53, 94208
s_mov_b32 s54, 114816
buffer_load_dwordx4 v3, s[24:27], s54 offen nt lds
v_cvt_pk_bf16_f32 v240, v240, v241
v_cvt_pk_bf16_f32 v241, v242, v243
v_cvt_pk_bf16_f32 v244, v244, v245
v_cvt_pk_bf16_f32 v245, v246, v247
v_cvt_pk_bf16_f32 v248, v248, v249
v_cvt_pk_bf16_f32 v249, v250, v251
s_waitcnt vmcnt(8)
s_barrier
ds_write_b64 v7, v[240:241] offset:0
ds_write_b64 v7, v[244:245] offset:1024
ds_write_b64 v7, v[248:249] offset:2048
ds_read_b64_tr_b16 v[184:185], v6 offset:0
ds_read_b64_tr_b16 v[186:187], v6 offset:1024
ds_read_b64_tr_b16 v[188:189], v6 offset:4096
ds_read_b64_tr_b16 v[190:191], v6 offset:5120
ds_read_b64_tr_b16 v[192:193], v6 offset:8192
ds_read_b64_tr_b16 v[194:195], v6 offset:9216
ds_read_b64_tr_b16 v[196:197], v6 offset:12288
ds_read_b64_tr_b16 v[198:199], v6 offset:13312
ds_read_b64_tr_b16 v[200:201], v6 offset:16384
ds_read_b64_tr_b16 v[202:203], v6 offset:17408
ds_read_b64_tr_b16 v[204:205], v6 offset:20480
ds_read_b64_tr_b16 v[206:207], v6 offset:21504
ds_read_b64_tr_b16 v[208:209], v6 offset:24576
ds_read_b64_tr_b16 v[210:211], v6 offset:25600
ds_read_b64_tr_b16 v[212:213], v6 offset:28672
ds_read_b64_tr_b16 v[214:215], v6 offset:29696
ds_read_b64_tr_b16 v[216:217], v6 offset:32768
ds_read_b64_tr_b16 v[218:219], v6 offset:33792
ds_read_b64_tr_b16 v[220:221], v6 offset:36864
ds_read_b64_tr_b16 v[222:223], v6 offset:37888
ds_read_b64_tr_b16 v[224:225], v6 offset:40960
ds_read_b64_tr_b16 v[226:227], v6 offset:41984
ds_read_b64_tr_b16 v[228:229], v6 offset:45056
ds_read_b64_tr_b16 v[230:231], v6 offset:46080
ds_read_b64_tr_b16 v[232:233], v6 offset:49152
ds_read_b64_tr_b16 v[234:235], v6 offset:50176
ds_read_b64_tr_b16 v[236:237], v6 offset:53248
ds_read_b64_tr_b16 v[238:239], v6 offset:54272
s_waitcnt lgkmcnt(0)
s_barrier
s_add_u32 m0, s53, 98304
s_mov_b32 s54, 640
buffer_load_dwordx4 v4, s[32:35], s54 offen  lds
s_add_u32 m0, s53, 102400
s_mov_b32 s54, 262784
buffer_load_dwordx4 v4, s[32:35], s54 offen  lds
v_mfma_f32_16x16x32_bf16 v[240:243], v[184:187], v[16:19], 0
v_mfma_f32_16x16x32_bf16 v[240:243], v[188:191], v[28:31], v[240:243]
v_mfma_f32_16x16x32_bf16 v[240:243], v[192:195], v[40:43], v[240:243]
s_add_u32 m0, s53, 106496
s_mov_b32 s54, 524928
buffer_load_dwordx4 v4, s[32:35], s54 offen  lds
v_mfma_f32_16x16x32_bf16 v[240:243], v[196:199], v[52:55], v[240:243]
v_mfma_f32_16x16x32_bf16 v[240:243], v[200:203], v[64:67], v[240:243]
v_mfma_f32_16x16x32_bf16 v[240:243], v[204:207], v[76:79], v[240:243]
s_add_u32 m0, s53, 110592
s_mov_b32 s54, 787072
buffer_load_dwordx4 v4, s[32:35], s54 offen  lds
s_add_u32 m0, s53, 114688
s_mov_b32 s54, 1049216
buffer_load_dwordx4 v4, s[32:35], s54 offen  lds
v_mfma_f32_16x16x32_bf16 v[240:243], v[208:211], v[88:91], v[240:243]
v_mfma_f32_16x16x32_bf16 v[240:243], v[212:215], v[100:103], v[240:243]
v_mfma_f32_16x16x32_bf16 v[240:243], v[216:219], v[112:115], v[240:243]
s_add_u32 m0, s53, 118784
s_mov_b32 s54, 1311360
buffer_load_dwordx4 v4, s[32:35], s54 offen  lds
v_mfma_f32_16x16x32_bf16 v[240:243], v[220:223], v[124:127], v[240:243]
v_mfma_f32_16x16x32_bf16 v[240:243], v[224:227], v[136:139], v[240:243]
v_mfma_f32_16x16x32_bf16 v[240:243], v[228:231], v[148:151], v[240:243]
s_add_u32 m0, s53, 122880
s_mov_b32 s54, 1573504
buffer_load_dwordx4 v4, s[32:35], s54 offen  lds
s_add_u32 m0, s53, 126976
s_mov_b32 s54, 1835648
buffer_load_dwordx4 v4, s[32:35], s54 offen  lds
v_mfma_f32_16x16x32_bf16 v[240:243], v[232:235], v[160:163], v[240:243]
v_mfma_f32_16x16x32_bf16 v[240:243], v[236:239], v[172:175], v[240:243]
v_mfma_f32_16x16x32_bf16 v[244:247], v[184:187], v[20:23], 0
s_add_u32 m0, s53, 131072
s_mov_b32 s54, 2097792
buffer_load_dwordx4 v4, s[32:35], s54 offen  lds
v_mfma_f32_16x16x32_bf16 v[244:247], v[188:191], v[32:35], v[244:247]
v_mfma_f32_16x16x32_bf16 v[244:247], v[192:195], v[44:47], v[244:247]
v_mfma_f32_16x16x32_bf16 v[244:247], v[196:199], v[56:59], v[244:247]
s_add_u32 m0, s53, 135168
s_mov_b32 s54, 2359936
buffer_load_dwordx4 v4, s[32:35], s54 offen  lds
s_add_u32 m0, s53, 139264
s_mov_b32 s54, 2622080
buffer_load_dwordx4 v4, s[32:35], s54 offen  lds
v_mfma_f32_16x16x32_bf16 v[244:247], v[200:203], v[68:71], v[244:247]
v_mfma_f32_16x16x32_bf16 v[244:247], v[204:207], v[80:83], v[244:247]
v_mfma_f32_16x16x32_bf16 v[244:247], v[208:211], v[92:95], v[244:247]
s_add_u32 m0, s53, 143360
s_mov_b32 s54, 2884224
buffer_load_dwordx4 v4, s[32:35], s54 offen  lds
v_mfma_f32_16x16x32_bf16 v[244:247], v[212:215], v[104:107], v[244:247]
v_mfma_f32_16x16x32_bf16 v[244:247], v[216:219], v[116:119], v[244:247]
v_mfma_f32_16x16x32_bf16 v[244:247], v[220:223], v[128:131], v[244:247]
s_add_u32 m0, s53, 147456
s_mov_b32 s54, 3146368
buffer_load_dwordx4 v4, s[32:35], s54 offen  lds
s_add_u32 m0, s53, 151552
s_mov_b32 s54, 3408512
buffer_load_dwordx4 v4, s[32:35], s54 offen  lds
s_barrier
s_add_u32 m0, s53, 0
s_mov_b32 s54, 131200
buffer_load_dwordx4 v3, s[24:27], s54 offen nt lds
s_add_u32 m0, s53, 4096
s_mov_b32 s54, 147584
buffer_load_dwordx4 v3, s[24:27], s54 offen nt lds
v_mfma_f32_16x16x32_bf16 v[244:247], v[224:227], v[140:143], v[244:247]
v_mfma_f32_16x16x32_bf16 v[244:247], v[228:231], v[152:155], v[244:247]
v_mfma_f32_16x16x32_bf16 v[244:247], v[232:235], v[164:167], v[244:247]
v_mfma_f32_16x16x32_bf16 v[244:247], v[236:239], v[176:179], v[244:247]
v_mfma_f32_16x16x32_bf16 v[248:251], v[184:187], v[24:27], 0
v_mfma_f32_16x16x32_bf16 v[248:251], v[188:191], v[36:39], v[248:251]
s_add_u32 m0, s53, 8192
s_mov_b32 s54, 163968
buffer_load_dwordx4 v3, s[24:27], s54 offen nt lds
v_mfma_f32_16x16x32_bf16 v[248:251], v[192:195], v[48:51], v[248:251]
v_mfma_f32_16x16x32_bf16 v[248:251], v[196:199], v[60:63], v[248:251]
v_mfma_f32_16x16x32_bf16 v[248:251], v[200:203], v[72:75], v[248:251]
s_add_u32 m0, s53, 12288
s_mov_b32 s54, 180352
buffer_load_dwordx4 v3, s[24:27], s54 offen nt lds
v_mfma_f32_16x16x32_bf16 v[248:251], v[204:207], v[84:87], v[248:251]
v_mfma_f32_16x16x32_bf16 v[248:251], v[208:211], v[96:99], v[248:251]
v_mfma_f32_16x16x32_bf16 v[248:251], v[212:215], v[108:111], v[248:251]
s_add_u32 m0, s53, 16384
s_mov_b32 s54, 196736
buffer_load_dwordx4 v3, s[24:27], s54 offen nt lds
v_mfma_f32_16x16x32_bf16 v[248:251], v[216:219], v[120:123], v[248:251]
v_mfma_f32_16x16x32_bf16 v[248:251], v[220:223], v[132:135], v[248:251]
v_mfma_f32_16x16x32_bf16 v[248:251], v[224:227], v[144:147], v[248:251]
s_add_u32 m0, s53, 20480
s_mov_b32 s54, 213120
buffer_load_dwordx4 v3, s[24:27], s54 offen nt lds
v_mfma_f32_16x16x32_bf16 v[248:251], v[228:231], v[156:159], v[248:251]
v_mfma_f32_16x16x32_bf16 v[248:251], v[232:235], v[168:171], v[248:251]
v_mfma_f32_16x16x32_bf16 v[248:251], v[236:239], v[180:183], v[248:251]
s_add_u32 m0, s53, 24576
s_mov_b32 s54, 229504
buffer_load_dwordx4 v3, s[24:27], s54 offen nt lds
s_add_u32 m0, s53, 28672
s_mov_b32 s54, 245888
buffer_load_dwordx4 v3, s[24:27], s54 offen nt lds
v_cvt_pk_bf16_f32 v240, v240, v241
v_cvt_pk_bf16_f32 v241, v242, v243
v_cvt_pk_bf16_f32 v244, v244, v245
v_cvt_pk_bf16_f32 v245, v246, v247
v_cvt_pk_bf16_f32 v248, v248, v249
v_cvt_pk_bf16_f32 v249, v250, v251
s_waitcnt vmcnt(8)
s_barrier
ds_write_b64 v7, v[240:241] offset:0
ds_write_b64 v7, v[244:245] offset:1024
ds_write_b64 v7, v[248:249] offset:2048
ds_read_b64_tr_b16 v[184:185], v6 offset:0
ds_read_b64_tr_b16 v[186:187], v6 offset:1024
ds_read_b64_tr_b16 v[188:189], v6 offset:4096
ds_read_b64_tr_b16 v[190:191], v6 offset:5120
ds_read_b64_tr_b16 v[192:193], v6 offset:8192
ds_read_b64_tr_b16 v[194:195], v6 offset:9216
ds_read_b64_tr_b16 v[196:197], v6 offset:12288
ds_read_b64_tr_b16 v[198:199], v6 offset:13312
ds_read_b64_tr_b16 v[200:201], v6 offset:16384
ds_read_b64_tr_b16 v[202:203], v6 offset:17408
ds_read_b64_tr_b16 v[204:205], v6 offset:20480
ds_read_b64_tr_b16 v[206:207], v6 offset:21504
ds_read_b64_tr_b16 v[208:209], v6 offset:24576
ds_read_b64_tr_b16 v[210:211], v6 offset:25600
ds_read_b64_tr_b16 v[212:213], v6 offset:28672
ds_read_b64_tr_b16 v[214:215], v6 offset:29696
ds_read_b64_tr_b16 v[216:217], v6 offset:32768
ds_read_b64_tr_b16 v[218:219], v6 offset:33792
ds_read_b64_tr_b16 v[220:221], v6 offset:36864
ds_read_b64_tr_b16 v[222:223], v6 offset:37888
ds_read_b64_tr_b16 v[224:225], v6 offset:40960
ds_read_b64_tr_b16 v[226:227], v6 offset:41984
ds_read_b64_tr_b16 v[228:229], v6 offset:45056
ds_read_b64_tr_b16 v[230:231], v6 offset:46080
ds_read_b64_tr_b16 v[232:233], v6 offset:49152
ds_read_b64_tr_b16 v[234:235], v6 offset:50176
ds_read_b64_tr_b16 v[236:237], v6 offset:53248
ds_read_b64_tr_b16 v[238:239], v6 offset:54272
s_waitcnt lgkmcnt(0)
s_barrier
s_setprio 0
s_add_u32 m0, s53, 98304
s_mov_b32 s54, 256
buffer_load_dwordx4 v4, s[32:35], s54 offen  lds
s_add_u32 m0, s53, 102400
s_mov_b32 s54, 262400
buffer_load_dwordx4 v4, s[32:35], s54 offen  lds
v_mfma_f32_16x16x32_bf16 v[240:243], v[184:187], v[16:19], 0
v_mfma_f32_16x16x32_bf16 v[240:243], v[188:191], v[28:31], v[240:243]
v_mfma_f32_16x16x32_bf16 v[240:243], v[192:195], v[40:43], v[240:243]
v_mfma_f32_16x16x32_bf16 v[240:243], v[196:199], v[52:55], v[240:243]
v_mfma_f32_16x16x32_bf16 v[240:243], v[200:203], v[64:67], v[240:243]
v_mfma_f32_16x16x32_bf16 v[240:243], v[204:207], v[76:79], v[240:243]
s_add_u32 m0, s53, 106496
s_mov_b32 s54, 524544
buffer_load_dwordx4 v4, s[32:35], s54 offen  lds
v_mfma_f32_16x16x32_bf16 v[240:243], v[208:211], v[88:91], v[240:243]
v_mfma_f32_16x16x32_bf16 v[240:243], v[212:215], v[100:103], v[240:243]
v_mfma_f32_16x16x32_bf16 v[240:243], v[216:219], v[112:115], v[240:243]
s_add_u32 m0, s53, 110592
s_mov_b32 s54, 786688
buffer_load_dwordx4 v4, s[32:35], s54 offen  lds
v_mfma_f32_16x16x32_bf16 v[240:243], v[220:223], v[124:127], v[240:243]
v_mfma_f32_16x16x32_bf16 v[240:243], v[224:227], v[136:139], v[240:243]
v_mfma_f32_16x16x32_bf16 v[240:243], v[228:231], v[148:151], v[240:243]
s_add_u32 m0, s53, 114688
s_mov_b32 s54, 1048832
buffer_load_dwordx4 v4, s[32:35], s54 offen  lds
v_mfma_f32_16x16x32_bf16 v[240:243], v[232:235], v[160:163], v[240:243]
v_mfma_f32_16x16x32_bf16 v[240:243], v[236:239], v[172:175], v[240:243]
v_mfma_f32_16x16x32_bf16 v[244:247], v[184:187], v[20:23], 0
s_add_u32 m0, s53, 118784
s_mov_b32 s54, 1310976
buffer_load_dwordx4 v4, s[32:35], s54 offen  lds
v_mfma_f32_16x16x32_bf16 v[244:247], v[188:191], v[32:35], v[244:247]
v_mfma_f32_16x16x32_bf16 v[244:247], v[192:195], v[44:47], v[244:247]
v_mfma_f32_16x16x32_bf16 v[244:247], v[196:199], v[56:59], v[244:247]
s_add_u32 m0, s53, 122880
s_mov_b32 s54, 1573120
buffer_load_dwordx4 v4, s[32:35], s54 offen  lds
v_mfma_f32_16x16x32_bf16 v[244:247], v[200:203], v[68:71], v[244:247]
v_mfma_f32_16x16x32_bf16 v[244:247], v[204:207], v[80:83], v[244:247]
v_mfma_f32_16x16x32_bf16 v[244:247], v[208:211], v[92:95], v[244:247]
s_add_u32 m0, s53, 126976
s_mov_b32 s54, 1835264
buffer_load_dwordx4 v4, s[32:35], s54 offen  lds
v_mfma_f32_16x16x32_bf16 v[244:247], v[212:215], v[104:107], v[244:247]
v_mfma_f32_16x16x32_bf16 v[244:247], v[216:219], v[116:119], v[244:247]
v_mfma_f32_16x16x32_bf16 v[244:247], v[220:223], v[128:131], v[244:247]
v_mfma_f32_16x16x32_bf16 v[244:247], v[224:227], v[140:143], v[244:247]
v_mfma_f32_16x16x32_bf16 v[244:247], v[228:231], v[152:155], v[244:247]
v_mfma_f32_16x16x32_bf16 v[244:247], v[232:235], v[164:167], v[244:247]
s_add_u32 m0, s53, 131072
s_mov_b32 s54, 2097408
buffer_load_dwordx4 v4, s[32:35], s54 offen  lds
v_mfma_f32_16x16x32_bf16 v[244:247], v[236:239], v[176:179], v[244:247]
v_mfma_f32_16x16x32_bf16 v[248:251], v[184:187], v[24:27], 0
v_mfma_f32_16x16x32_bf16 v[248:251], v[188:191], v[36:39], v[248:251]
s_add_u32 m0, s53, 135168
s_mov_b32 s54, 2359552
buffer_load_dwordx4 v4, s[32:35], s54 offen  lds
v_mfma_f32_16x16x32_bf16 v[248:251], v[192:195], v[48:51], v[248:251]
v_mfma_f32_16x16x32_bf16 v[248:251], v[196:199], v[60:63], v[248:251]
v_mfma_f32_16x16x32_bf16 v[248:251], v[200:203], v[72:75], v[248:251]
s_add_u32 m0, s53, 139264
s_mov_b32 s54, 2621696
buffer_load_dwordx4 v4, s[32:35], s54 offen  lds
v_mfma_f32_16x16x32_bf16 v[248:251], v[204:207], v[84:87], v[248:251]
v_mfma_f32_16x16x32_bf16 v[248:251], v[208:211], v[96:99], v[248:251]
v_mfma_f32_16x16x32_bf16 v[248:251], v[212:215], v[108:111], v[248:251]
s_add_u32 m0, s53, 143360
s_mov_b32 s54, 2883840
buffer_load_dwordx4 v4, s[32:35], s54 offen  lds
v_mfma_f32_16x16x32_bf16 v[248:251], v[216:219], v[120:123], v[248:251]
v_mfma_f32_16x16x32_bf16 v[248:251], v[220:223], v[132:135], v[248:251]
v_mfma_f32_16x16x32_bf16 v[248:251], v[224:227], v[144:147], v[248:251]
s_add_u32 m0, s53, 147456
s_mov_b32 s54, 3145984
buffer_load_dwordx4 v4, s[32:35], s54 offen  lds
v_mfma_f32_16x16x32_bf16 v[248:251], v[228:231], v[156:159], v[248:251]
v_mfma_f32_16x16x32_bf16 v[248:251], v[232:235], v[168:171], v[248:251]
v_mfma_f32_16x16x32_bf16 v[248:251], v[236:239], v[180:183], v[248:251]
s_add_u32 m0, s53, 151552
s_mov_b32 s54, 3408128
buffer_load_dwordx4 v4, s[32:35], s54 offen  lds
s_setprio 1
s_barrier
s_add_u32 m0, s53, 32768
s_mov_b32 s54, 256
buffer_load_dwordx4 v3, s[24:27], s54 offen nt lds
s_add_u32 m0, s53, 36864
s_mov_b32 s54, 16640
buffer_load_dwordx4 v3, s[24:27], s54 offen nt lds
s_add_u32 m0, s53, 40960
s_mov_b32 s54, 33024
buffer_load_dwordx4 v3, s[24:27], s54 offen nt lds
s_add_u32 m0, s53, 45056
s_mov_b32 s54, 49408
buffer_load_dwordx4 v3, s[24:27], s54 offen nt lds
s_add_u32 m0, s53, 49152
s_mov_b32 s54, 65792
buffer_load_dwordx4 v3, s[24:27], s54 offen nt lds
s_add_u32 m0, s53, 53248
s_mov_b32 s54, 82176
buffer_load_dwordx4 v3, s[24:27], s54 offen nt lds
s_add_u32 m0, s53, 57344
s_mov_b32 s54, 98560
buffer_load_dwordx4 v3, s[24:27], s54 offen nt lds
s_add_u32 m0, s53, 61440
s_mov_b32 s54, 114944
buffer_load_dwordx4 v3, s[24:27], s54 offen nt lds
v_cvt_pk_bf16_f32 v240, v240, v241
v_cvt_pk_bf16_f32 v241, v242, v243
v_cvt_pk_bf16_f32 v244, v244, v245
v_cvt_pk_bf16_f32 v245, v246, v247
v_cvt_pk_bf16_f32 v248, v248, v249
v_cvt_pk_bf16_f32 v249, v250, v251
s_waitcnt vmcnt(8)
s_barrier
ds_write_b64 v7, v[240:241] offset:0
ds_write_b64 v7, v[244:245] offset:1024
ds_write_b64 v7, v[248:249] offset:2048
ds_read_b64_tr_b16 v[184:185], v6 offset:0
ds_read_b64_tr_b16 v[186:187], v6 offset:1024
ds_read_b64_tr_b16 v[188:189], v6 offset:4096
ds_read_b64_tr_b16 v[190:191], v6 offset:5120
ds_read_b64_tr_b16 v[192:193], v6 offset:8192
ds_read_b64_tr_b16 v[194:195], v6 offset:9216
ds_read_b64_tr_b16 v[196:197], v6 offset:12288
ds_read_b64_tr_b16 v[198:199], v6 offset:13312
ds_read_b64_tr_b16 v[200:201], v6 offset:16384
ds_read_b64_tr_b16 v[202:203], v6 offset:17408
ds_read_b64_tr_b16 v[204:205], v6 offset:20480
ds_read_b64_tr_b16 v[206:207], v6 offset:21504
ds_read_b64_tr_b16 v[208:209], v6 offset:24576
ds_read_b64_tr_b16 v[210:211], v6 offset:25600
ds_read_b64_tr_b16 v[212:213], v6 offset:28672
ds_read_b64_tr_b16 v[214:215], v6 offset:29696
ds_read_b64_tr_b16 v[216:217], v6 offset:32768
ds_read_b64_tr_b16 v[218:219], v6 offset:33792
ds_read_b64_tr_b16 v[220:221], v6 offset:36864
ds_read_b64_tr_b16 v[222:223], v6 offset:37888
ds_read_b64_tr_b16 v[224:225], v6 offset:40960
ds_read_b64_tr_b16 v[226:227], v6 offset:41984
ds_read_b64_tr_b16 v[228:229], v6 offset:45056
ds_read_b64_tr_b16 v[230:231], v6 offset:46080
ds_read_b64_tr_b16 v[232:233], v6 offset:49152
ds_read_b64_tr_b16 v[234:235], v6 offset:50176
ds_read_b64_tr_b16 v[236:237], v6 offset:53248
ds_read_b64_tr_b16 v[238:239], v6 offset:54272
s_waitcnt lgkmcnt(0)
s_barrier
s_add_u32 m0, s53, 98304
s_mov_b32 s54, 768
buffer_load_dwordx4 v4, s[32:35], s54 offen  lds
s_add_u32 m0, s53, 102400
s_mov_b32 s54, 262912
buffer_load_dwordx4 v4, s[32:35], s54 offen  lds
v_mfma_f32_16x16x32_bf16 v[240:243], v[184:187], v[16:19], 0
v_mfma_f32_16x16x32_bf16 v[240:243], v[188:191], v[28:31], v[240:243]
v_mfma_f32_16x16x32_bf16 v[240:243], v[192:195], v[40:43], v[240:243]
s_add_u32 m0, s53, 106496
s_mov_b32 s54, 525056
buffer_load_dwordx4 v4, s[32:35], s54 offen  lds
v_mfma_f32_16x16x32_bf16 v[240:243], v[196:199], v[52:55], v[240:243]
v_mfma_f32_16x16x32_bf16 v[240:243], v[200:203], v[64:67], v[240:243]
v_mfma_f32_16x16x32_bf16 v[240:243], v[204:207], v[76:79], v[240:243]
s_add_u32 m0, s53, 110592
s_mov_b32 s54, 787200
buffer_load_dwordx4 v4, s[32:35], s54 offen  lds
s_add_u32 m0, s53, 114688
s_mov_b32 s54, 1049344
buffer_load_dwordx4 v4, s[32:35], s54 offen  lds
v_mfma_f32_16x16x32_bf16 v[240:243], v[208:211], v[88:91], v[240:243]
v_mfma_f32_16x16x32_bf16 v[240:243], v[212:215], v[100:103], v[240:243]
v_mfma_f32_16x16x32_bf16 v[240:243], v[216:219], v[112:115], v[240:243]
s_add_u32 m0, s53, 118784
s_mov_b32 s54, 1311488
buffer_load_dwordx4 v4, s[32:35], s54 offen  lds
v_mfma_f32_16x16x32_bf16 v[240:243], v[220:223], v[124:127], v[240:243]
v_mfma_f32_16x16x32_bf16 v[240:243], v[224:227], v[136:139], v[240:243]
v_mfma_f32_16x16x32_bf16 v[240:243], v[228:231], v[148:151], v[240:243]
s_add_u32 m0, s53, 122880
s_mov_b32 s54, 1573632
buffer_load_dwordx4 v4, s[32:35], s54 offen  lds
s_add_u32 m0, s53, 126976
s_mov_b32 s54, 1835776
buffer_load_dwordx4 v4, s[32:35], s54 offen  lds
v_mfma_f32_16x16x32_bf16 v[240:243], v[232:235], v[160:163], v[240:243]
v_mfma_f32_16x16x32_bf16 v[240:243], v[236:239], v[172:175], v[240:243]
v_mfma_f32_16x16x32_bf16 v[244:247], v[184:187], v[20:23], 0
s_add_u32 m0, s53, 131072
s_mov_b32 s54, 2097920
buffer_load_dwordx4 v4, s[32:35], s54 offen  lds
v_mfma_f32_16x16x32_bf16 v[244:247], v[188:191], v[32:35], v[244:247]
v_mfma_f32_16x16x32_bf16 v[244:247], v[192:195], v[44:47], v[244:247]
v_mfma_f32_16x16x32_bf16 v[244:247], v[196:199], v[56:59], v[244:247]
s_add_u32 m0, s53, 135168
s_mov_b32 s54, 2360064
buffer_load_dwordx4 v4, s[32:35], s54 offen  lds
s_add_u32 m0, s53, 139264
s_mov_b32 s54, 2622208
buffer_load_dwordx4 v4, s[32:35], s54 offen  lds
v_mfma_f32_16x16x32_bf16 v[244:247], v[200:203], v[68:71], v[244:247]
v_mfma_f32_16x16x32_bf16 v[244:247], v[204:207], v[80:83], v[244:247]
v_mfma_f32_16x16x32_bf16 v[244:247], v[208:211], v[92:95], v[244:247]
s_add_u32 m0, s53, 143360
s_mov_b32 s54, 2884352
buffer_load_dwordx4 v4, s[32:35], s54 offen  lds
v_mfma_f32_16x16x32_bf16 v[244:247], v[212:215], v[104:107], v[244:247]
v_mfma_f32_16x16x32_bf16 v[244:247], v[216:219], v[116:119], v[244:247]
v_mfma_f32_16x16x32_bf16 v[244:247], v[220:223], v[128:131], v[244:247]
s_add_u32 m0, s53, 147456
s_mov_b32 s54, 3146496
buffer_load_dwordx4 v4, s[32:35], s54 offen  lds
s_add_u32 m0, s53, 151552
s_mov_b32 s54, 3408640
buffer_load_dwordx4 v4, s[32:35], s54 offen  lds
s_barrier
s_add_u32 m0, s53, 65536
s_mov_b32 s54, 131328
buffer_load_dwordx4 v3, s[24:27], s54 offen nt lds
s_add_u32 m0, s53, 69632
s_mov_b32 s54, 147712
buffer_load_dwordx4 v3, s[24:27], s54 offen nt lds
v_mfma_f32_16x16x32_bf16 v[244:247], v[224:227], v[140:143], v[244:247]
v_mfma_f32_16x16x32_bf16 v[244:247], v[228:231], v[152:155], v[244:247]
v_mfma_f32_16x16x32_bf16 v[244:247], v[232:235], v[164:167], v[244:247]
v_mfma_f32_16x16x32_bf16 v[244:247], v[236:239], v[176:179], v[244:247]
v_mfma_f32_16x16x32_bf16 v[248:251], v[184:187], v[24:27], 0
v_mfma_f32_16x16x32_bf16 v[248:251], v[188:191], v[36:39], v[248:251]
s_add_u32 m0, s53, 73728
s_mov_b32 s54, 164096
buffer_load_dwordx4 v3, s[24:27], s54 offen nt lds
v_mfma_f32_16x16x32_bf16 v[248:251], v[192:195], v[48:51], v[248:251]
v_mfma_f32_16x16x32_bf16 v[248:251], v[196:199], v[60:63], v[248:251]
v_mfma_f32_16x16x32_bf16 v[248:251], v[200:203], v[72:75], v[248:251]
s_add_u32 m0, s53, 77824
s_mov_b32 s54, 180480
buffer_load_dwordx4 v3, s[24:27], s54 offen nt lds
v_mfma_f32_16x16x32_bf16 v[248:251], v[204:207], v[84:87], v[248:251]
v_mfma_f32_16x16x32_bf16 v[248:251], v[208:211], v[96:99], v[248:251]
v_mfma_f32_16x16x32_bf16 v[248:251], v[212:215], v[108:111], v[248:251]
s_add_u32 m0, s53, 81920
s_mov_b32 s54, 196864
buffer_load_dwordx4 v3, s[24:27], s54 offen nt lds
v_mfma_f32_16x16x32_bf16 v[248:251], v[216:219], v[120:123], v[248:251]
v_mfma_f32_16x16x32_bf16 v[248:251], v[220:223], v[132:135], v[248:251]
v_mfma_f32_16x16x32_bf16 v[248:251], v[224:227], v[144:147], v[248:251]
s_add_u32 m0, s53, 86016
s_mov_b32 s54, 213248
buffer_load_dwordx4 v3, s[24:27], s54 offen nt lds
v_mfma_f32_16x16x32_bf16 v[248:251], v[228:231], v[156:159], v[248:251]
v_mfma_f32_16x16x32_bf16 v[248:251], v[232:235], v[168:171], v[248:251]
v_mfma_f32_16x16x32_bf16 v[248:251], v[236:239], v[180:183], v[248:251]
s_add_u32 m0, s53, 90112
s_mov_b32 s54, 229632
buffer_load_dwordx4 v3, s[24:27], s54 offen nt lds
s_add_u32 m0, s53, 94208
s_mov_b32 s54, 246016
buffer_load_dwordx4 v3, s[24:27], s54 offen nt lds
v_cvt_pk_bf16_f32 v240, v240, v241
v_cvt_pk_bf16_f32 v241, v242, v243
v_cvt_pk_bf16_f32 v244, v244, v245
v_cvt_pk_bf16_f32 v245, v246, v247
v_cvt_pk_bf16_f32 v248, v248, v249
v_cvt_pk_bf16_f32 v249, v250, v251
s_waitcnt vmcnt(8)
s_barrier
ds_write_b64 v7, v[240:241] offset:0
ds_write_b64 v7, v[244:245] offset:1024
ds_write_b64 v7, v[248:249] offset:2048
ds_read_b64_tr_b16 v[184:185], v6 offset:0
ds_read_b64_tr_b16 v[186:187], v6 offset:1024
ds_read_b64_tr_b16 v[188:189], v6 offset:4096
ds_read_b64_tr_b16 v[190:191], v6 offset:5120
ds_read_b64_tr_b16 v[192:193], v6 offset:8192
ds_read_b64_tr_b16 v[194:195], v6 offset:9216
ds_read_b64_tr_b16 v[196:197], v6 offset:12288
ds_read_b64_tr_b16 v[198:199], v6 offset:13312
ds_read_b64_tr_b16 v[200:201], v6 offset:16384
ds_read_b64_tr_b16 v[202:203], v6 offset:17408
ds_read_b64_tr_b16 v[204:205], v6 offset:20480
ds_read_b64_tr_b16 v[206:207], v6 offset:21504
ds_read_b64_tr_b16 v[208:209], v6 offset:24576
ds_read_b64_tr_b16 v[210:211], v6 offset:25600
ds_read_b64_tr_b16 v[212:213], v6 offset:28672
ds_read_b64_tr_b16 v[214:215], v6 offset:29696
ds_read_b64_tr_b16 v[216:217], v6 offset:32768
ds_read_b64_tr_b16 v[218:219], v6 offset:33792
ds_read_b64_tr_b16 v[220:221], v6 offset:36864
ds_read_b64_tr_b16 v[222:223], v6 offset:37888
ds_read_b64_tr_b16 v[224:225], v6 offset:40960
ds_read_b64_tr_b16 v[226:227], v6 offset:41984
ds_read_b64_tr_b16 v[228:229], v6 offset:45056
ds_read_b64_tr_b16 v[230:231], v6 offset:46080
ds_read_b64_tr_b16 v[232:233], v6 offset:49152
ds_read_b64_tr_b16 v[234:235], v6 offset:50176
ds_read_b64_tr_b16 v[236:237], v6 offset:53248
ds_read_b64_tr_b16 v[238:239], v6 offset:54272
s_waitcnt lgkmcnt(0)
s_barrier
s_add_u32 m0, s53, 98304
s_mov_b32 s54, 384
buffer_load_dwordx4 v4, s[32:35], s54 offen  lds
s_add_u32 m0, s53, 102400
s_mov_b32 s54, 262528
buffer_load_dwordx4 v4, s[32:35], s54 offen  lds
v_mfma_f32_16x16x32_bf16 v[240:243], v[184:187], v[16:19], 0
v_mfma_f32_16x16x32_bf16 v[240:243], v[188:191], v[28:31], v[240:243]
v_mfma_f32_16x16x32_bf16 v[240:243], v[192:195], v[40:43], v[240:243]
s_add_u32 m0, s53, 106496
s_mov_b32 s54, 524672
buffer_load_dwordx4 v4, s[32:35], s54 offen  lds
v_mfma_f32_16x16x32_bf16 v[240:243], v[196:199], v[52:55], v[240:243]
v_mfma_f32_16x16x32_bf16 v[240:243], v[200:203], v[64:67], v[240:243]
v_mfma_f32_16x16x32_bf16 v[240:243], v[204:207], v[76:79], v[240:243]
s_add_u32 m0, s53, 110592
s_mov_b32 s54, 786816
buffer_load_dwordx4 v4, s[32:35], s54 offen  lds
s_add_u32 m0, s53, 114688
s_mov_b32 s54, 1048960
buffer_load_dwordx4 v4, s[32:35], s54 offen  lds
v_mfma_f32_16x16x32_bf16 v[240:243], v[208:211], v[88:91], v[240:243]
v_mfma_f32_16x16x32_bf16 v[240:243], v[212:215], v[100:103], v[240:243]
v_mfma_f32_16x16x32_bf16 v[240:243], v[216:219], v[112:115], v[240:243]
s_add_u32 m0, s53, 118784
s_mov_b32 s54, 1311104
buffer_load_dwordx4 v4, s[32:35], s54 offen  lds
v_mfma_f32_16x16x32_bf16 v[240:243], v[220:223], v[124:127], v[240:243]
v_mfma_f32_16x16x32_bf16 v[240:243], v[224:227], v[136:139], v[240:243]
v_mfma_f32_16x16x32_bf16 v[240:243], v[228:231], v[148:151], v[240:243]
s_add_u32 m0, s53, 122880
s_mov_b32 s54, 1573248
buffer_load_dwordx4 v4, s[32:35], s54 offen  lds
s_add_u32 m0, s53, 126976
s_mov_b32 s54, 1835392
buffer_load_dwordx4 v4, s[32:35], s54 offen  lds
v_mfma_f32_16x16x32_bf16 v[240:243], v[232:235], v[160:163], v[240:243]
v_mfma_f32_16x16x32_bf16 v[240:243], v[236:239], v[172:175], v[240:243]
v_mfma_f32_16x16x32_bf16 v[244:247], v[184:187], v[20:23], 0
s_add_u32 m0, s53, 131072
s_mov_b32 s54, 2097536
buffer_load_dwordx4 v4, s[32:35], s54 offen  lds
v_mfma_f32_16x16x32_bf16 v[244:247], v[188:191], v[32:35], v[244:247]
v_mfma_f32_16x16x32_bf16 v[244:247], v[192:195], v[44:47], v[244:247]
v_mfma_f32_16x16x32_bf16 v[244:247], v[196:199], v[56:59], v[244:247]
s_add_u32 m0, s53, 135168
s_mov_b32 s54, 2359680
buffer_load_dwordx4 v4, s[32:35], s54 offen  lds
s_add_u32 m0, s53, 139264
s_mov_b32 s54, 2621824
buffer_load_dwordx4 v4, s[32:35], s54 offen  lds
v_mfma_f32_16x16x32_bf16 v[244:247], v[200:203], v[68:71], v[244:247]
v_mfma_f32_16x16x32_bf16 v[244:247], v[204:207], v[80:83], v[244:247]
v_mfma_f32_16x16x32_bf16 v[244:247], v[208:211], v[92:95], v[244:247]
s_add_u32 m0, s53, 143360
s_mov_b32 s54, 2883968
buffer_load_dwordx4 v4, s[32:35], s54 offen  lds
v_mfma_f32_16x16x32_bf16 v[244:247], v[212:215], v[104:107], v[244:247]
v_mfma_f32_16x16x32_bf16 v[244:247], v[216:219], v[116:119], v[244:247]
v_mfma_f32_16x16x32_bf16 v[244:247], v[220:223], v[128:131], v[244:247]
s_add_u32 m0, s53, 147456
s_mov_b32 s54, 3146112
buffer_load_dwordx4 v4, s[32:35], s54 offen  lds
s_add_u32 m0, s53, 151552
s_mov_b32 s54, 3408256
buffer_load_dwordx4 v4, s[32:35], s54 offen  lds
s_barrier
s_add_u32 m0, s53, 0
s_mov_b32 s54, 384
buffer_load_dwordx4 v3, s[24:27], s54 offen nt lds
s_add_u32 m0, s53, 4096
s_mov_b32 s54, 16768
buffer_load_dwordx4 v3, s[24:27], s54 offen nt lds
v_mfma_f32_16x16x32_bf16 v[244:247], v[224:227], v[140:143], v[244:247]
v_mfma_f32_16x16x32_bf16 v[244:247], v[228:231], v[152:155], v[244:247]
v_mfma_f32_16x16x32_bf16 v[244:247], v[232:235], v[164:167], v[244:247]
v_mfma_f32_16x16x32_bf16 v[244:247], v[236:239], v[176:179], v[244:247]
v_mfma_f32_16x16x32_bf16 v[248:251], v[184:187], v[24:27], 0
v_mfma_f32_16x16x32_bf16 v[248:251], v[188:191], v[36:39], v[248:251]
s_add_u32 m0, s53, 8192
s_mov_b32 s54, 33152
buffer_load_dwordx4 v3, s[24:27], s54 offen nt lds
v_mfma_f32_16x16x32_bf16 v[248:251], v[192:195], v[48:51], v[248:251]
v_mfma_f32_16x16x32_bf16 v[248:251], v[196:199], v[60:63], v[248:251]
v_mfma_f32_16x16x32_bf16 v[248:251], v[200:203], v[72:75], v[248:251]
s_add_u32 m0, s53, 12288
s_mov_b32 s54, 49536
buffer_load_dwordx4 v3, s[24:27], s54 offen nt lds
v_mfma_f32_16x16x32_bf16 v[248:251], v[204:207], v[84:87], v[248:251]
v_mfma_f32_16x16x32_bf16 v[248:251], v[208:211], v[96:99], v[248:251]
v_mfma_f32_16x16x32_bf16 v[248:251], v[212:215], v[108:111], v[248:251]
s_add_u32 m0, s53, 16384
s_mov_b32 s54, 65920
buffer_load_dwordx4 v3, s[24:27], s54 offen nt lds
v_mfma_f32_16x16x32_bf16 v[248:251], v[216:219], v[120:123], v[248:251]
v_mfma_f32_16x16x32_bf16 v[248:251], v[220:223], v[132:135], v[248:251]
v_mfma_f32_16x16x32_bf16 v[248:251], v[224:227], v[144:147], v[248:251]
s_add_u32 m0, s53, 20480
s_mov_b32 s54, 82304
buffer_load_dwordx4 v3, s[24:27], s54 offen nt lds
v_mfma_f32_16x16x32_bf16 v[248:251], v[228:231], v[156:159], v[248:251]
v_mfma_f32_16x16x32_bf16 v[248:251], v[232:235], v[168:171], v[248:251]
v_mfma_f32_16x16x32_bf16 v[248:251], v[236:239], v[180:183], v[248:251]
s_add_u32 m0, s53, 24576
s_mov_b32 s54, 98688
buffer_load_dwordx4 v3, s[24:27], s54 offen nt lds
s_add_u32 m0, s53, 28672
s_mov_b32 s54, 115072
buffer_load_dwordx4 v3, s[24:27], s54 offen nt lds
v_cvt_pk_bf16_f32 v240, v240, v241
v_cvt_pk_bf16_f32 v241, v242, v243
v_cvt_pk_bf16_f32 v244, v244, v245
v_cvt_pk_bf16_f32 v245, v246, v247
v_cvt_pk_bf16_f32 v248, v248, v249
v_cvt_pk_bf16_f32 v249, v250, v251
s_waitcnt vmcnt(8)
s_barrier
ds_write_b64 v7, v[240:241] offset:0
ds_write_b64 v7, v[244:245] offset:1024
ds_write_b64 v7, v[248:249] offset:2048
ds_read_b64_tr_b16 v[184:185], v6 offset:0
ds_read_b64_tr_b16 v[186:187], v6 offset:1024
ds_read_b64_tr_b16 v[188:189], v6 offset:4096
ds_read_b64_tr_b16 v[190:191], v6 offset:5120
ds_read_b64_tr_b16 v[192:193], v6 offset:8192
ds_read_b64_tr_b16 v[194:195], v6 offset:9216
ds_read_b64_tr_b16 v[196:197], v6 offset:12288
ds_read_b64_tr_b16 v[198:199], v6 offset:13312
ds_read_b64_tr_b16 v[200:201], v6 offset:16384
ds_read_b64_tr_b16 v[202:203], v6 offset:17408
ds_read_b64_tr_b16 v[204:205], v6 offset:20480
ds_read_b64_tr_b16 v[206:207], v6 offset:21504
ds_read_b64_tr_b16 v[208:209], v6 offset:24576
ds_read_b64_tr_b16 v[210:211], v6 offset:25600
ds_read_b64_tr_b16 v[212:213], v6 offset:28672
ds_read_b64_tr_b16 v[214:215], v6 offset:29696
ds_read_b64_tr_b16 v[216:217], v6 offset:32768
ds_read_b64_tr_b16 v[218:219], v6 offset:33792
ds_read_b64_tr_b16 v[220:221], v6 offset:36864
ds_read_b64_tr_b16 v[222:223], v6 offset:37888
ds_read_b64_tr_b16 v[224:225], v6 offset:40960
ds_read_b64_tr_b16 v[226:227], v6 offset:41984
ds_read_b64_tr_b16 v[228:229], v6 offset:45056
ds_read_b64_tr_b16 v[230:231], v6 offset:46080
ds_read_b64_tr_b16 v[232:233], v6 offset:49152
ds_read_b64_tr_b16 v[234:235], v6 offset:50176
ds_read_b64_tr_b16 v[236:237], v6 offset:53248
ds_read_b64_tr_b16 v[238:239], v6 offset:54272
s_waitcnt lgkmcnt(0)
s_barrier
s_add_u32 m0, s53, 98304
s_mov_b32 s54, 896
buffer_load_dwordx4 v4, s[32:35], s54 offen  lds
s_add_u32 m0, s53, 102400
s_mov_b32 s54, 263040
buffer_load_dwordx4 v4, s[32:35], s54 offen  lds
v_mfma_f32_16x16x32_bf16 v[240:243], v[184:187], v[16:19], 0
v_mfma_f32_16x16x32_bf16 v[240:243], v[188:191], v[28:31], v[240:243]
v_mfma_f32_16x16x32_bf16 v[240:243], v[192:195], v[40:43], v[240:243]
s_add_u32 m0, s53, 106496
s_mov_b32 s54, 525184
buffer_load_dwordx4 v4, s[32:35], s54 offen  lds
v_mfma_f32_16x16x32_bf16 v[240:243], v[196:199], v[52:55], v[240:243]
v_mfma_f32_16x16x32_bf16 v[240:243], v[200:203], v[64:67], v[240:243]
v_mfma_f32_16x16x32_bf16 v[240:243], v[204:207], v[76:79], v[240:243]
s_add_u32 m0, s53, 110592
s_mov_b32 s54, 787328
buffer_load_dwordx4 v4, s[32:35], s54 offen  lds
s_add_u32 m0, s53, 114688
s_mov_b32 s54, 1049472
buffer_load_dwordx4 v4, s[32:35], s54 offen  lds
v_mfma_f32_16x16x32_bf16 v[240:243], v[208:211], v[88:91], v[240:243]
v_mfma_f32_16x16x32_bf16 v[240:243], v[212:215], v[100:103], v[240:243]
v_mfma_f32_16x16x32_bf16 v[240:243], v[216:219], v[112:115], v[240:243]
s_add_u32 m0, s53, 118784
s_mov_b32 s54, 1311616
buffer_load_dwordx4 v4, s[32:35], s54 offen  lds
v_mfma_f32_16x16x32_bf16 v[240:243], v[220:223], v[124:127], v[240:243]
v_mfma_f32_16x16x32_bf16 v[240:243], v[224:227], v[136:139], v[240:243]
v_mfma_f32_16x16x32_bf16 v[240:243], v[228:231], v[148:151], v[240:243]
s_add_u32 m0, s53, 122880
s_mov_b32 s54, 1573760
buffer_load_dwordx4 v4, s[32:35], s54 offen  lds
s_add_u32 m0, s53, 126976
s_mov_b32 s54, 1835904
buffer_load_dwordx4 v4, s[32:35], s54 offen  lds
v_mfma_f32_16x16x32_bf16 v[240:243], v[232:235], v[160:163], v[240:243]
v_mfma_f32_16x16x32_bf16 v[240:243], v[236:239], v[172:175], v[240:243]
v_mfma_f32_16x16x32_bf16 v[244:247], v[184:187], v[20:23], 0
s_add_u32 m0, s53, 131072
s_mov_b32 s54, 2098048
buffer_load_dwordx4 v4, s[32:35], s54 offen  lds
v_mfma_f32_16x16x32_bf16 v[244:247], v[188:191], v[32:35], v[244:247]
v_mfma_f32_16x16x32_bf16 v[244:247], v[192:195], v[44:47], v[244:247]
v_mfma_f32_16x16x32_bf16 v[244:247], v[196:199], v[56:59], v[244:247]
s_add_u32 m0, s53, 135168
s_mov_b32 s54, 2360192
buffer_load_dwordx4 v4, s[32:35], s54 offen  lds
s_add_u32 m0, s53, 139264
s_mov_b32 s54, 2622336
buffer_load_dwordx4 v4, s[32:35], s54 offen  lds
v_mfma_f32_16x16x32_bf16 v[244:247], v[200:203], v[68:71], v[244:247]
v_mfma_f32_16x16x32_bf16 v[244:247], v[204:207], v[80:83], v[244:247]
v_mfma_f32_16x16x32_bf16 v[244:247], v[208:211], v[92:95], v[244:247]
s_add_u32 m0, s53, 143360
s_mov_b32 s54, 2884480
buffer_load_dwordx4 v4, s[32:35], s54 offen  lds
v_mfma_f32_16x16x32_bf16 v[244:247], v[212:215], v[104:107], v[244:247]
v_mfma_f32_16x16x32_bf16 v[244:247], v[216:219], v[116:119], v[244:247]
v_mfma_f32_16x16x32_bf16 v[244:247], v[220:223], v[128:131], v[244:247]
s_add_u32 m0, s53, 147456
s_mov_b32 s54, 3146624
buffer_load_dwordx4 v4, s[32:35], s54 offen  lds
s_add_u32 m0, s53, 151552
s_mov_b32 s54, 3408768
buffer_load_dwordx4 v4, s[32:35], s54 offen  lds
s_barrier
s_add_u32 m0, s53, 32768
s_mov_b32 s54, 131456
buffer_load_dwordx4 v3, s[24:27], s54 offen nt lds
s_add_u32 m0, s53, 36864
s_mov_b32 s54, 147840
buffer_load_dwordx4 v3, s[24:27], s54 offen nt lds
v_mfma_f32_16x16x32_bf16 v[244:247], v[224:227], v[140:143], v[244:247]
v_mfma_f32_16x16x32_bf16 v[244:247], v[228:231], v[152:155], v[244:247]
v_mfma_f32_16x16x32_bf16 v[244:247], v[232:235], v[164:167], v[244:247]
v_mfma_f32_16x16x32_bf16 v[244:247], v[236:239], v[176:179], v[244:247]
v_mfma_f32_16x16x32_bf16 v[248:251], v[184:187], v[24:27], 0
v_mfma_f32_16x16x32_bf16 v[248:251], v[188:191], v[36:39], v[248:251]
s_add_u32 m0, s53, 40960
s_mov_b32 s54, 164224
buffer_load_dwordx4 v3, s[24:27], s54 offen nt lds
v_mfma_f32_16x16x32_bf16 v[248:251], v[192:195], v[48:51], v[248:251]
v_mfma_f32_16x16x32_bf16 v[248:251], v[196:199], v[60:63], v[248:251]
v_mfma_f32_16x16x32_bf16 v[248:251], v[200:203], v[72:75], v[248:251]
s_add_u32 m0, s53, 45056
s_mov_b32 s54, 180608
buffer_load_dwordx4 v3, s[24:27], s54 offen nt lds
v_mfma_f32_16x16x32_bf16 v[248:251], v[204:207], v[84:87], v[248:251]
v_mfma_f32_16x16x32_bf16 v[248:251], v[208:211], v[96:99], v[248:251]
v_mfma_f32_16x16x32_bf16 v[248:251], v[212:215], v[108:111], v[248:251]
s_add_u32 m0, s53, 49152
s_mov_b32 s54, 196992
buffer_load_dwordx4 v3, s[24:27], s54 offen nt lds
v_mfma_f32_16x16x32_bf16 v[248:251], v[216:219], v[120:123], v[248:251]
v_mfma_f32_16x16x32_bf16 v[248:251], v[220:223], v[132:135], v[248:251]
v_mfma_f32_16x16x32_bf16 v[248:251], v[224:227], v[144:147], v[248:251]
s_add_u32 m0, s53, 53248
s_mov_b32 s54, 213376
buffer_load_dwordx4 v3, s[24:27], s54 offen nt lds
v_mfma_f32_16x16x32_bf16 v[248:251], v[228:231], v[156:159], v[248:251]
v_mfma_f32_16x16x32_bf16 v[248:251], v[232:235], v[168:171], v[248:251]
v_mfma_f32_16x16x32_bf16 v[248:251], v[236:239], v[180:183], v[248:251]
s_add_u32 m0, s53, 57344
s_mov_b32 s54, 229760
buffer_load_dwordx4 v3, s[24:27], s54 offen nt lds
s_add_u32 m0, s53, 61440
s_mov_b32 s54, 246144
buffer_load_dwordx4 v3, s[24:27], s54 offen nt lds
v_cvt_pk_bf16_f32 v252, v240, v241
v_cvt_pk_bf16_f32 v253, v242, v243
v_cvt_pk_bf16_f32 v254, v244, v245
v_cvt_pk_bf16_f32 v255, v246, v247
v_cvt_pk_bf16_f32 v14, v248, v249
v_cvt_pk_bf16_f32 v15, v250, v251
s_waitcnt vmcnt(8)
s_barrier
ds_read_b64_tr_b16 v[184:185], v6 offset:0
ds_read_b64_tr_b16 v[186:187], v6 offset:1024
ds_read_b64_tr_b16 v[188:189], v6 offset:4096
ds_read_b64_tr_b16 v[190:191], v6 offset:5120
ds_read_b64_tr_b16 v[192:193], v6 offset:8192
ds_read_b64_tr_b16 v[194:195], v6 offset:9216
ds_read_b64_tr_b16 v[196:197], v6 offset:12288
ds_read_b64_tr_b16 v[198:199], v6 offset:13312
ds_read_b64_tr_b16 v[200:201], v6 offset:16384
ds_read_b64_tr_b16 v[202:203], v6 offset:17408
ds_read_b64_tr_b16 v[204:205], v6 offset:20480
ds_read_b64_tr_b16 v[206:207], v6 offset:21504
s_waitcnt lgkmcnt(10)
v_mfma_f32_16x16x32_bf16 v[240:243], v[184:187], v[16:19], 0
ds_read_b64_tr_b16 v[208:209], v6 offset:24576
ds_read_b64_tr_b16 v[210:211], v6 offset:25600
s_waitcnt lgkmcnt(10)
v_mfma_f32_16x16x32_bf16 v[240:243], v[188:191], v[28:31], v[240:243]
ds_read_b64_tr_b16 v[212:213], v6 offset:28672
ds_read_b64_tr_b16 v[214:215], v6 offset:29696
v_mfma_f32_16x16x32_bf16 v[244:247], v[188:191], v[32:35], 0
ds_read_b64_tr_b16 v[216:217], v6 offset:32768
ds_read_b64_tr_b16 v[218:219], v6 offset:33792
v_mfma_f32_16x16x32_bf16 v[244:247], v[184:187], v[20:23], v[244:247]
ds_read_b64_tr_b16 v[220:221], v6 offset:36864
ds_read_b64_tr_b16 v[222:223], v6 offset:37888
v_mfma_f32_16x16x32_bf16 v[248:251], v[184:187], v[24:27], 0
ds_read_b64_tr_b16 v[224:225], v6 offset:40960
ds_read_b64_tr_b16 v[226:227], v6 offset:41984
v_mfma_f32_16x16x32_bf16 v[248:251], v[188:191], v[36:39], v[248:251]
ds_read_b64_tr_b16 v[228:229], v6 offset:45056
ds_read_b64_tr_b16 v[230:231], v6 offset:46080
s_waitcnt lgkmcnt(15)
v_mfma_f32_16x16x32_bf16 v[240:243], v[192:195], v[40:43], v[240:243]
ds_read_b64_tr_b16 v[232:233], v6 offset:49152
ds_read_b64_tr_b16 v[234:235], v6 offset:50176
v_mfma_f32_16x16x32_bf16 v[240:243], v[196:199], v[52:55], v[240:243]
ds_read_b64_tr_b16 v[236:237], v6 offset:53248
ds_read_b64_tr_b16 v[238:239], v6 offset:54272
ds_write_b64 v7, v[252:253] offset:0
ds_write_b64 v7, v[254:255] offset:1024
ds_write_b64 v7, v[14:15] offset:2048
v_mfma_f32_16x16x32_bf16 v[244:247], v[196:199], v[56:59], v[244:247]
v_mfma_f32_16x16x32_bf16 v[244:247], v[192:195], v[44:47], v[244:247]
v_mfma_f32_16x16x32_bf16 v[248:251], v[192:195], v[48:51], v[248:251]
v_mfma_f32_16x16x32_bf16 v[248:251], v[196:199], v[60:63], v[248:251]
s_waitcnt lgkmcnt(15)
v_mfma_f32_16x16x32_bf16 v[240:243], v[200:203], v[64:67], v[240:243]
v_mfma_f32_16x16x32_bf16 v[240:243], v[204:207], v[76:79], v[240:243]
v_mfma_f32_16x16x32_bf16 v[244:247], v[204:207], v[80:83], v[244:247]
v_mfma_f32_16x16x32_bf16 v[244:247], v[200:203], v[68:71], v[244:247]
v_mfma_f32_16x16x32_bf16 v[248:251], v[200:203], v[72:75], v[248:251]
v_mfma_f32_16x16x32_bf16 v[248:251], v[204:207], v[84:87], v[248:251]
s_waitcnt lgkmcnt(0)
s_barrier
v_subrev_u32 v7, 6144, v7
v_mfma_f32_16x16x32_bf16 v[240:243], v[208:211], v[88:91], v[240:243]
v_mfma_f32_16x16x32_bf16 v[240:243], v[212:215], v[100:103], v[240:243]
v_mfma_f32_16x16x32_bf16 v[244:247], v[212:215], v[104:107], v[244:247]
v_mfma_f32_16x16x32_bf16 v[244:247], v[208:211], v[92:95], v[244:247]
v_mfma_f32_16x16x32_bf16 v[248:251], v[208:211], v[96:99], v[248:251]
v_mfma_f32_16x16x32_bf16 v[248:251], v[212:215], v[108:111], v[248:251]
s_add_u32 m0, s53, 65536
s_mov_b32 s54, 384
buffer_load_dwordx4 v3, s[28:31], s54 offen nt lds
v_mfma_f32_16x16x32_bf16 v[240:243], v[216:219], v[112:115], v[240:243]
v_mfma_f32_16x16x32_bf16 v[240:243], v[220:223], v[124:127], v[240:243]
v_mfma_f32_16x16x32_bf16 v[244:247], v[220:223], v[128:131], v[244:247]
v_mfma_f32_16x16x32_bf16 v[244:247], v[216:219], v[116:119], v[244:247]
v_mfma_f32_16x16x32_bf16 v[248:251], v[216:219], v[120:123], v[248:251]
v_mfma_f32_16x16x32_bf16 v[248:251], v[220:223], v[132:135], v[248:251]
s_add_u32 m0, s53, 69632
s_mov_b32 s54, 16768
buffer_load_dwordx4 v3, s[28:31], s54 offen nt lds
v_mfma_f32_16x16x32_bf16 v[240:243], v[224:227], v[136:139], v[240:243]
v_mfma_f32_16x16x32_bf16 v[240:243], v[228:231], v[148:151], v[240:243]
v_mfma_f32_16x16x32_bf16 v[244:247], v[228:231], v[152:155], v[244:247]
v_mfma_f32_16x16x32_bf16 v[244:247], v[224:227], v[140:143], v[244:247]
v_mfma_f32_16x16x32_bf16 v[248:251], v[224:227], v[144:147], v[248:251]
v_mfma_f32_16x16x32_bf16 v[248:251], v[228:231], v[156:159], v[248:251]
s_add_u32 m0, s53, 73728
s_mov_b32 s54, 33152
buffer_load_dwordx4 v3, s[28:31], s54 offen nt lds
v_mfma_f32_16x16x32_bf16 v[240:243], v[232:235], v[160:163], v[240:243]
v_mfma_f32_16x16x32_bf16 v[240:243], v[236:239], v[172:175], v[240:243]
v_mfma_f32_16x16x32_bf16 v[244:247], v[236:239], v[176:179], v[244:247]
v_mfma_f32_16x16x32_bf16 v[244:247], v[232:235], v[164:167], v[244:247]
v_mfma_f32_16x16x32_bf16 v[248:251], v[232:235], v[168:171], v[248:251]
v_mfma_f32_16x16x32_bf16 v[248:251], v[236:239], v[180:183], v[248:251]
s_add_u32 m0, s53, 77824
s_mov_b32 s54, 49536
buffer_load_dwordx4 v3, s[28:31], s54 offen nt lds
s_nop 0
v_cvt_pk_bf16_f32 v240, v240, v241
v_cvt_pk_bf16_f32 v241, v242, v243
ds_write_b64 v7, v[240:241] offset:0
v_cvt_pk_bf16_f32 v244, v244, v245
v_cvt_pk_bf16_f32 v245, v246, v247
ds_write_b64 v7, v[244:245] offset:1024
v_cvt_pk_bf16_f32 v248, v248, v249
v_cvt_pk_bf16_f32 v249, v250, v251
ds_write_b64 v7, v[248:249] offset:2048
s_waitcnt lgkmcnt(0)
s_barrier
s_add_u32 m0, s53, 81920
s_mov_b32 s54, 65920
buffer_load_dwordx4 v3, s[28:31], s54 offen nt lds
s_add_u32 m0, s53, 86016
s_mov_b32 s54, 82304
buffer_load_dwordx4 v3, s[28:31], s54 offen nt lds
s_add_u32 m0, s53, 90112
s_mov_b32 s54, 98688
buffer_load_dwordx4 v3, s[28:31], s54 offen nt lds
s_add_u32 m0, s53, 94208
s_mov_b32 s54, 115072
buffer_load_dwordx4 v3, s[28:31], s54 offen nt lds
v_lshrrev_b32 v12, 5, v1
v_mul_u32_u24 v6, 1024, v12
v_bfe_u32 v12, v1, 2, 3
v_lshl_add_u32 v6, v12, 7, v6
v_bfe_u32 v12, v1, 3, 2
v_lshl_add_u32 v6, v12, 5, v6
v_and_b32 v12, 3, v1
v_lshl_add_u32 v6, v12, 3, v6
s_lshr_b32 s61, s53, 5
v_xor_b32 v6, s61, v6
v_add_u32 v6, 98304, v6
v_lshlrev_b32 v7, 4, v1
v_add_u32 v4, 65536, v7
s_lshl_b32 s60, s3, 2
s_add_u32 s60, s60, s52
s_sub_u32 s60, s60, 4
s_mul_i32 s60, s60, 1536
v_and_b32 v12, 31, v1
v_lshl_add_u32 v7, v12, 5, s60
v_lshrrev_b32 v12, 5, v1
v_lshl_add_u32 v7, v12, 4, v7
v_and_b32 v12, 15, v1
v_lshl_add_u32 v2, v12, 5, s60
v_lshrrev_b32 v12, 4, v1
v_lshl_add_u32 v2, v12, 3, v2
s_sub_u32 s60, s3, s55
s_and_b32 s60, s60, 7
s_add_u32 s61, s60, 1
s_mul_i32 s64, s61, 37
s_lshr_b32 s64, s64, 8
s_mul_i32 s64, s64, 7
s_sub_u32 s61, s61, s64
s_lshl_b32 s76, s61, 7
s_add_u32 s61, s60, 2
s_mul_i32 s64, s61, 37
s_lshr_b32 s64, s64, 8
s_mul_i32 s64, s64, 7
s_sub_u32 s61, s61, s64
s_lshl_b32 s77, s61, 7
s_add_u32 s61, s60, 3
s_mul_i32 s64, s61, 37
s_lshr_b32 s64, s64, 8
s_mul_i32 s64, s64, 7
s_sub_u32 s61, s61, s64
s_lshl_b32 s78, s61, 7
s_add_u32 s61, s60, 4
s_mul_i32 s64, s61, 37
s_lshr_b32 s64, s64, 8
s_mul_i32 s64, s64, 7
s_sub_u32 s61, s61, s64
s_lshl_b32 s79, s61, 7
s_add_u32 s61, s60, 5
s_mul_i32 s64, s61, 37
s_lshr_b32 s64, s64, 8
s_mul_i32 s64, s64, 7
s_sub_u32 s61, s61, s64
s_lshl_b32 s80, s61, 7
s_add_u32 s61, s60, 6
s_mul_i32 s64, s61, 37
s_lshr_b32 s64, s64, 8
s_mul_i32 s64, s64, 7
s_sub_u32 s61, s61, s64
s_lshl_b32 s81, s61, 7
s_add_u32 s61, s60, 7
s_mul_i32 s64, s61, 37
s_lshr_b32 s64, s64, 8
s_mul_i32 s64, s64, 7
s_sub_u32 s61, s61, s64
s_lshl_b32 s82, s61, 7
s_waitcnt vmcnt(8)
s_setprio 0
s_barrier
s_add_u32 m0, s53, 98304
s_add_u32 s54, s76, 172032
buffer_load_dwordx4 v5, s[36:39], s54 offen  lds
s_add_u32 m0, s53, 102400
s_add_u32 s54, s77, 172032
buffer_load_dwordx4 v5, s[36:39], s54 offen  lds
s_add_u32 m0, s53, 106496
s_add_u32 s54, s78, 172032
buffer_load_dwordx4 v5, s[36:39], s54 offen  lds
s_add_u32 m0, s53, 110592
s_add_u32 s54, s79, 172032
buffer_load_dwordx4 v5, s[36:39], s54 offen  lds
s_add_u32 m0, s53, 114688
s_add_u32 s54, s80, 172032
buffer_load_dwordx4 v5, s[36:39], s54 offen  lds
s_add_u32 m0, s53, 118784
s_add_u32 s54, s81, 172032
buffer_load_dwordx4 v5, s[36:39], s54 offen  lds
s_add_u32 m0, s53, 122880
s_add_u32 s54, s82, 172032
buffer_load_dwordx4 v5, s[36:39], s54 offen  lds
s_add_u32 m0, s53, 126976
s_add_u32 s54, s76, 200704
buffer_load_dwordx4 v5, s[36:39], s54 offen  lds
s_add_u32 m0, s53, 131072
s_add_u32 s54, s77, 200704
buffer_load_dwordx4 v5, s[36:39], s54 offen  lds
s_add_u32 m0, s53, 135168
s_add_u32 s54, s78, 200704
buffer_load_dwordx4 v5, s[36:39], s54 offen  lds
s_add_u32 m0, s53, 139264
s_add_u32 s54, s79, 200704
buffer_load_dwordx4 v5, s[36:39], s54 offen  lds
s_add_u32 m0, s53, 143360
s_add_u32 s54, s80, 200704
buffer_load_dwordx4 v5, s[36:39], s54 offen  lds
s_add_u32 m0, s53, 147456
s_add_u32 s54, s81, 200704
buffer_load_dwordx4 v5, s[36:39], s54 offen  lds
s_add_u32 m0, s53, 151552
s_add_u32 s54, s82, 200704
buffer_load_dwordx4 v5, s[36:39], s54 offen  lds
s_waitcnt vmcnt(4)
s_add_u32 m0, s53, 0
s_mov_b32 s54, 131456
buffer_load_dwordx4 v3, s[28:31], s54 offen nt lds
s_add_u32 m0, s53, 4096
s_mov_b32 s54, 147840
buffer_load_dwordx4 v3, s[28:31], s54 offen nt lds
s_add_u32 m0, s53, 8192
s_mov_b32 s54, 164224
buffer_load_dwordx4 v3, s[28:31], s54 offen nt lds
s_add_u32 m0, s53, 12288
s_mov_b32 s54, 180608
buffer_load_dwordx4 v3, s[28:31], s54 offen nt lds
s_add_u32 m0, s53, 16384
s_mov_b32 s54, 196992
buffer_load_dwordx4 v3, s[28:31], s54 offen nt lds
s_add_u32 m0, s53, 20480
s_mov_b32 s54, 213376
buffer_load_dwordx4 v3, s[28:31], s54 offen nt lds
s_add_u32 m0, s53, 24576
s_mov_b32 s54, 229760
buffer_load_dwordx4 v3, s[28:31], s54 offen nt lds
s_add_u32 m0, s53, 28672
s_mov_b32 s54, 246144
buffer_load_dwordx4 v3, s[28:31], s54 offen nt lds
s_waitcnt vmcnt(8)
s_barrier
ds_read_b64_tr_b16 v[184:185], v6 offset:0
ds_read_b64_tr_b16 v[186:187], v6 offset:2048
ds_read_b64_tr_b16 v[188:189], v6 offset:28672
ds_read_b64_tr_b16 v[190:191], v6 offset:30720
ds_read_b64_tr_b16 v[192:193], v6 offset:4096
ds_read_b64_tr_b16 v[194:195], v6 offset:6144
ds_read_b64_tr_b16 v[196:197], v6 offset:32768
ds_read_b64_tr_b16 v[198:199], v6 offset:34816
ds_read_b64_tr_b16 v[200:201], v6 offset:8192
ds_read_b64_tr_b16 v[202:203], v6 offset:10240
ds_read_b64_tr_b16 v[204:205], v6 offset:36864
ds_read_b64_tr_b16 v[206:207], v6 offset:38912
ds_read_b64_tr_b16 v[208:209], v6 offset:12288
ds_read_b64_tr_b16 v[210:211], v6 offset:14336
ds_read_b64_tr_b16 v[212:213], v6 offset:40960
ds_read_b64_tr_b16 v[214:215], v6 offset:43008
ds_read_b64_tr_b16 v[216:217], v6 offset:16384
ds_read_b64_tr_b16 v[218:219], v6 offset:18432
ds_read_b64_tr_b16 v[220:221], v6 offset:45056
ds_read_b64_tr_b16 v[222:223], v6 offset:47104
ds_read_b64_tr_b16 v[224:225], v6 offset:20480
ds_read_b64_tr_b16 v[226:227], v6 offset:22528
ds_read_b64_tr_b16 v[228:229], v6 offset:49152
ds_read_b64_tr_b16 v[230:231], v6 offset:51200
ds_read_b64_tr_b16 v[232:233], v6 offset:24576
ds_read_b64_tr_b16 v[234:235], v6 offset:26624
ds_read_b64_tr_b16 v[236:237], v6 offset:53248
ds_read_b64_tr_b16 v[238:239], v6 offset:55296
s_waitcnt lgkmcnt(0)
s_barrier
s_add_u32 m0, s53, 98304
s_add_u32 s54, s76, 401408
buffer_load_dwordx4 v5, s[36:39], s54 offen  lds
s_add_u32 m0, s53, 102400
s_add_u32 s54, s77, 401408
buffer_load_dwordx4 v5, s[36:39], s54 offen  lds
s_add_u32 m0, s53, 106496
s_add_u32 s54, s78, 401408
buffer_load_dwordx4 v5, s[36:39], s54 offen  lds
s_add_u32 m0, s53, 110592
s_add_u32 s54, s79, 401408
buffer_load_dwordx4 v5, s[36:39], s54 offen  lds
s_add_u32 m0, s53, 114688
s_add_u32 s54, s80, 401408
buffer_load_dwordx4 v5, s[36:39], s54 offen  lds
s_add_u32 m0, s53, 118784
s_add_u32 s54, s81, 401408
buffer_load_dwordx4 v5, s[36:39], s54 offen  lds
s_add_u32 m0, s53, 122880
s_add_u32 s54, s82, 401408
buffer_load_dwordx4 v5, s[36:39], s54 offen  lds
s_add_u32 m0, s53, 126976
s_add_u32 s54, s76, 430080
buffer_load_dwordx4 v5, s[36:39], s54 offen  lds
s_add_u32 m0, s53, 131072
s_add_u32 s54, s77, 430080
buffer_load_dwordx4 v5, s[36:39], s54 offen  lds
s_add_u32 m0, s53, 135168
s_add_u32 s54, s78, 430080
buffer_load_dwordx4 v5, s[36:39], s54 offen  lds
s_add_u32 m0, s53, 139264
s_add_u32 s54, s79, 430080
buffer_load_dwordx4 v5, s[36:39], s54 offen  lds
s_add_u32 m0, s53, 143360
s_add_u32 s54, s80, 430080
buffer_load_dwordx4 v5, s[36:39], s54 offen  lds
s_add_u32 m0, s53, 147456
s_add_u32 s54, s81, 430080
buffer_load_dwordx4 v5, s[36:39], s54 offen  lds
s_add_u32 m0, s53, 151552
s_add_u32 s54, s82, 430080
buffer_load_dwordx4 v5, s[36:39], s54 offen  lds
s_waitcnt vmcnt(14)
s_barrier
s_add_u32 m0, s53, 32768
s_mov_b32 s54, 0
buffer_load_dwordx4 v3, s[28:31], s54 offen nt lds
s_add_u32 m0, s53, 36864
s_mov_b32 s54, 16384
buffer_load_dwordx4 v3, s[28:31], s54 offen nt lds
s_add_u32 m0, s53, 40960
s_mov_b32 s54, 32768
buffer_load_dwordx4 v3, s[28:31], s54 offen nt lds
s_add_u32 m0, s53, 45056
s_mov_b32 s54, 49152
buffer_load_dwordx4 v3, s[28:31], s54 offen nt lds
s_add_u32 m0, s53, 49152
s_mov_b32 s54, 65536
buffer_load_dwordx4 v3, s[28:31], s54 offen nt lds
s_add_u32 m0, s53, 53248
s_mov_b32 s54, 81920
buffer_load_dwordx4 v3, s[28:31], s54 offen nt lds
s_add_u32 m0, s53, 57344
s_mov_b32 s54, 98304
buffer_load_dwordx4 v3, s[28:31], s54 offen nt lds
s_add_u32 m0, s53, 61440
s_mov_b32 s54, 114688
buffer_load_dwordx4 v3, s[28:31], s54 offen nt lds
s_waitcnt vmcnt(8)
s_barrier
ds_read_b64_tr_b16 v[128:129], v6 offset:0
ds_read_b64_tr_b16 v[130:131], v6 offset:2048
ds_read_b64_tr_b16 v[132:133], v6 offset:28672
ds_read_b64_tr_b16 v[134:135], v6 offset:30720
ds_read_b64_tr_b16 v[136:137], v6 offset:4096
ds_read_b64_tr_b16 v[138:139], v6 offset:6144
ds_read_b64_tr_b16 v[140:141], v6 offset:32768
ds_read_b64_tr_b16 v[142:143], v6 offset:34816
ds_read_b64_tr_b16 v[144:145], v6 offset:8192
ds_read_b64_tr_b16 v[146:147], v6 offset:10240
ds_read_b64_tr_b16 v[148:149], v6 offset:36864
ds_read_b64_tr_b16 v[150:151], v6 offset:38912
ds_read_b64_tr_b16 v[152:153], v6 offset:12288
ds_read_b64_tr_b16 v[154:155], v6 offset:14336
ds_read_b64_tr_b16 v[156:157], v6 offset:40960
ds_read_b64_tr_b16 v[158:159], v6 offset:43008
ds_read_b64_tr_b16 v[160:161], v6 offset:16384
ds_read_b64_tr_b16 v[162:163], v6 offset:18432
ds_read_b64_tr_b16 v[164:165], v6 offset:45056
ds_read_b64_tr_b16 v[166:167], v6 offset:47104
ds_read_b64_tr_b16 v[168:169], v6 offset:20480
ds_read_b64_tr_b16 v[170:171], v6 offset:22528
ds_read_b64_tr_b16 v[172:173], v6 offset:49152
ds_read_b64_tr_b16 v[174:175], v6 offset:51200
ds_read_b64_tr_b16 v[176:177], v6 offset:24576
ds_read_b64_tr_b16 v[178:179], v6 offset:26624
ds_read_b64_tr_b16 v[180:181], v6 offset:53248
ds_read_b64_tr_b16 v[182:183], v6 offset:55296
s_waitcnt lgkmcnt(0)
s_barrier
s_waitcnt vmcnt(0)
s_add_u32 m0, s53, 98304
s_add_u32 s54, s76, 0
buffer_load_dwordx4 v5, s[36:39], s54 offen  lds
s_add_u32 m0, s53, 102400
s_add_u32 s54, s77, 0
buffer_load_dwordx4 v5, s[36:39], s54 offen  lds
s_add_u32 m0, s53, 106496
s_add_u32 s54, s78, 0
buffer_load_dwordx4 v5, s[36:39], s54 offen  lds
s_barrier
ds_read_b128 v[100:103], v4 offset:6144
ds_read_b128 v[104:107], v4 offset:0
ds_read_b128 v[108:111], v4 offset:1024
ds_read_b128 v[112:115], v4 offset:7168
ds_read_b128 v[116:119], v4 offset:8192
ds_read_b128 v[120:123], v4 offset:2048
s_add_u32 m0, s53, 110592
s_add_u32 s54, s79, 0
buffer_load_dwordx4 v5, s[36:39], s54 offen  lds
s_add_u32 m0, s53, 114688
s_add_u32 s54, s80, 0
buffer_load_dwordx4 v5, s[36:39], s54 offen  lds
s_waitcnt lgkmcnt(5)
v_mfma_f32_16x16x32_bf16 v[16:19], v[184:187], v[100:103], 0
s_waitcnt lgkmcnt(4)
v_mfma_f32_16x16x32_bf16 v[16:19], v[188:191], v[104:107], v[16:19]
s_waitcnt lgkmcnt(3)
v_mfma_f32_16x16x32_bf16 v[20:23], v[188:191], v[108:111], 0
s_waitcnt lgkmcnt(2)
v_mfma_f32_16x16x32_bf16 v[20:23], v[184:187], v[112:115], v[20:23]
s_waitcnt lgkmcnt(1)
v_mfma_f32_16x16x32_bf16 v[24:27], v[184:187], v[116:119], 0
s_waitcnt lgkmcnt(0)
v_mfma_f32_16x16x32_bf16 v[24:27], v[188:191], v[120:123], v[24:27]
s_add_u32 m0, s53, 118784
s_add_u32 s54, s81, 0
buffer_load_dwordx4 v5, s[36:39], s54 offen  lds
v_mfma_f32_16x16x32_bf16 v[28:31], v[192:195], v[100:103], 0
v_mfma_f32_16x16x32_bf16 v[28:31], v[196:199], v[104:107], v[28:31]
v_mfma_f32_16x16x32_bf16 v[32:35], v[196:199], v[108:111], 0
s_add_u32 m0, s53, 122880
s_add_u32 s54, s82, 0
buffer_load_dwordx4 v5, s[36:39], s54 offen  lds
v_mfma_f32_16x16x32_bf16 v[32:35], v[192:195], v[112:115], v[32:35]
v_mfma_f32_16x16x32_bf16 v[36:39], v[192:195], v[116:119], 0
v_mfma_f32_16x16x32_bf16 v[36:39], v[196:199], v[120:123], v[36:39]
s_add_u32 m0, s53, 126976
s_add_u32 s54, s76, 28672
buffer_load_dwordx4 v5, s[36:39], s54 offen  lds
v_mfma_f32_16x16x32_bf16 v[40:43], v[200:203], v[100:103], 0
v_mfma_f32_16x16x32_bf16 v[40:43], v[204:207], v[104:107], v[40:43]
v_mfma_f32_16x16x32_bf16 v[44:47], v[204:207], v[108:111], 0
s_add_u32 m0, s53, 131072
s_add_u32 s54, s77, 28672
buffer_load_dwordx4 v5, s[36:39], s54 offen  lds
v_mfma_f32_16x16x32_bf16 v[44:47], v[200:203], v[112:115], v[44:47]
v_mfma_f32_16x16x32_bf16 v[48:51], v[200:203], v[116:119], 0
v_mfma_f32_16x16x32_bf16 v[48:51], v[204:207], v[120:123], v[48:51]
v_mfma_f32_16x16x32_bf16 v[52:55], v[208:211], v[100:103], 0
v_mfma_f32_16x16x32_bf16 v[52:55], v[212:215], v[104:107], v[52:55]
v_mfma_f32_16x16x32_bf16 v[56:59], v[212:215], v[108:111], 0
s_add_u32 m0, s53, 135168
s_add_u32 s54, s78, 28672
buffer_load_dwordx4 v5, s[36:39], s54 offen  lds
v_mfma_f32_16x16x32_bf16 v[56:59], v[208:211], v[112:115], v[56:59]
v_mfma_f32_16x16x32_bf16 v[60:63], v[208:211], v[116:119], 0
v_mfma_f32_16x16x32_bf16 v[60:63], v[212:215], v[120:123], v[60:63]
s_add_u32 m0, s53, 139264
s_add_u32 s54, s79, 28672
buffer_load_dwordx4 v5, s[36:39], s54 offen  lds
v_mfma_f32_16x16x32_bf16 v[64:67], v[216:219], v[100:103], 0
v_mfma_f32_16x16x32_bf16 v[64:67], v[220:223], v[104:107], v[64:67]
v_mfma_f32_16x16x32_bf16 v[68:71], v[220:223], v[108:111], 0
s_add_u32 m0, s53, 143360
s_add_u32 s54, s80, 28672
buffer_load_dwordx4 v5, s[36:39], s54 offen  lds
v_mfma_f32_16x16x32_bf16 v[68:71], v[216:219], v[112:115], v[68:71]
v_mfma_f32_16x16x32_bf16 v[72:75], v[216:219], v[116:119], 0
v_mfma_f32_16x16x32_bf16 v[72:75], v[220:223], v[120:123], v[72:75]
s_add_u32 m0, s53, 147456
s_add_u32 s54, s81, 28672
buffer_load_dwordx4 v5, s[36:39], s54 offen  lds
v_mfma_f32_16x16x32_bf16 v[76:79], v[224:227], v[100:103], 0
v_mfma_f32_16x16x32_bf16 v[76:79], v[228:231], v[104:107], v[76:79]
v_mfma_f32_16x16x32_bf16 v[80:83], v[228:231], v[108:111], 0
s_add_u32 m0, s53, 151552
s_add_u32 s54, s82, 28672
buffer_load_dwordx4 v5, s[36:39], s54 offen  lds
s_barrier
s_add_u32 m0, s53, 0
s_mov_b32 s54, 131072
buffer_load_dwordx4 v3, s[28:31], s54 offen nt lds
s_add_u32 m0, s53, 4096
s_mov_b32 s54, 147456
buffer_load_dwordx4 v3, s[28:31], s54 offen nt lds
v_mfma_f32_16x16x32_bf16 v[80:83], v[224:227], v[112:115], v[80:83]
v_mfma_f32_16x16x32_bf16 v[84:87], v[224:227], v[116:119], 0
v_mfma_f32_16x16x32_bf16 v[84:87], v[228:231], v[120:123], v[84:87]
s_add_u32 m0, s53, 8192
s_mov_b32 s54, 163840
buffer_load_dwordx4 v3, s[28:31], s54 offen nt lds
s_add_u32 m0, s53, 12288
s_mov_b32 s54, 180224
buffer_load_dwordx4 v3, s[28:31], s54 offen nt lds
v_mfma_f32_16x16x32_bf16 v[88:91], v[232:235], v[100:103], 0
v_mfma_f32_16x16x32_bf16 v[88:91], v[236:239], v[104:107], v[88:91]
v_mfma_f32_16x16x32_bf16 v[92:95], v[236:239], v[108:111], 0
s_add_u32 m0, s53, 16384
s_mov_b32 s54, 196608
buffer_load_dwordx4 v3, s[28:31], s54 offen nt lds
s_add_u32 m0, s53, 20480
s_mov_b32 s54, 212992
buffer_load_dwordx4 v3, s[28:31], s54 offen nt lds
v_mfma_f32_16x16x32_bf16 v[92:95], v[232:235], v[112:115], v[92:95]
v_mfma_f32_16x16x32_bf16 v[96:99], v[232:235], v[116:119], 0
v_mfma_f32_16x16x32_bf16 v[96:99], v[236:239], v[120:123], v[96:99]
s_add_u32 m0, s53, 24576
s_mov_b32 s54, 229376
buffer_load_dwordx4 v3, s[28:31], s54 offen nt lds
s_add_u32 m0, s53, 28672
s_mov_b32 s54, 245760
buffer_load_dwordx4 v3, s[28:31], s54 offen nt lds
s_waitcnt vmcnt(8)
s_barrier
ds_read_b128 v[240:243], v4 offset:18432
ds_read_b128 v[244:247], v4 offset:12288
ds_read_b128 v[248:251], v4 offset:13312
ds_read_b128 v[252:255], v4 offset:19456
ds_read_b128 v[124:127], v4 offset:20480
ds_read_b128 v[12:15], v4 offset:14336
ds_read_b64_tr_b16 v[184:185], v6 offset:0
ds_read_b64_tr_b16 v[186:187], v6 offset:2048
ds_read_b64_tr_b16 v[188:189], v6 offset:28672
ds_read_b64_tr_b16 v[190:191], v6 offset:30720
ds_read_b64_tr_b16 v[192:193], v6 offset:4096
ds_read_b64_tr_b16 v[194:195], v6 offset:6144
ds_read_b64_tr_b16 v[196:197], v6 offset:32768
ds_read_b64_tr_b16 v[198:199], v6 offset:34816
ds_read_b64_tr_b16 v[200:201], v6 offset:8192
ds_read_b64_tr_b16 v[202:203], v6 offset:10240
ds_read_b64_tr_b16 v[204:205], v6 offset:36864
ds_read_b64_tr_b16 v[206:207], v6 offset:38912
ds_read_b64_tr_b16 v[208:209], v6 offset:12288
ds_read_b64_tr_b16 v[210:211], v6 offset:14336
ds_read_b64_tr_b16 v[212:213], v6 offset:40960
ds_read_b64_tr_b16 v[214:215], v6 offset:43008
ds_read_b64_tr_b16 v[216:217], v6 offset:16384
ds_read_b64_tr_b16 v[218:219], v6 offset:18432
ds_read_b64_tr_b16 v[220:221], v6 offset:45056
ds_read_b64_tr_b16 v[222:223], v6 offset:47104
ds_read_b64_tr_b16 v[224:225], v6 offset:20480
ds_read_b64_tr_b16 v[226:227], v6 offset:22528
ds_read_b64_tr_b16 v[228:229], v6 offset:49152
ds_read_b64_tr_b16 v[230:231], v6 offset:51200
ds_read_b64_tr_b16 v[232:233], v6 offset:24576
ds_read_b64_tr_b16 v[234:235], v6 offset:26624
ds_read_b64_tr_b16 v[236:237], v6 offset:53248
ds_read_b64_tr_b16 v[238:239], v6 offset:55296
s_waitcnt lgkmcnt(0)
s_barrier
s_add_u32 m0, s53, 98304
s_add_u32 s54, s76, 229376
buffer_load_dwordx4 v5, s[36:39], s54 offen  lds
s_add_u32 m0, s53, 102400
s_add_u32 s54, s77, 229376
buffer_load_dwordx4 v5, s[36:39], s54 offen  lds
s_add_u32 m0, s53, 106496
s_add_u32 s54, s78, 229376
buffer_load_dwordx4 v5, s[36:39], s54 offen  lds
s_add_u32 m0, s53, 110592
s_add_u32 s54, s79, 229376
buffer_load_dwordx4 v5, s[36:39], s54 offen  lds
s_add_u32 m0, s53, 114688
s_add_u32 s54, s80, 229376
buffer_load_dwordx4 v5, s[36:39], s54 offen  lds
s_add_u32 m0, s53, 118784
s_add_u32 s54, s81, 229376
buffer_load_dwordx4 v5, s[36:39], s54 offen  lds
s_add_u32 m0, s53, 122880
s_add_u32 s54, s82, 229376
buffer_load_dwordx4 v5, s[36:39], s54 offen  lds
v_mfma_f32_16x16x32_bf16 v[16:19], v[128:131], v[240:243], v[16:19]
v_mfma_f32_16x16x32_bf16 v[16:19], v[132:135], v[244:247], v[16:19]
v_mfma_f32_16x16x32_bf16 v[20:23], v[132:135], v[248:251], v[20:23]
v_mfma_f32_16x16x32_bf16 v[20:23], v[128:131], v[252:255], v[20:23]
v_mfma_f32_16x16x32_bf16 v[24:27], v[128:131], v[124:127], v[24:27]
v_mfma_f32_16x16x32_bf16 v[24:27], v[132:135], v[12:15], v[24:27]
s_add_u32 m0, s53, 126976
s_add_u32 s54, s76, 258048
buffer_load_dwordx4 v5, s[36:39], s54 offen  lds
v_mfma_f32_16x16x32_bf16 v[28:31], v[136:139], v[240:243], v[28:31]
v_mfma_f32_16x16x32_bf16 v[28:31], v[140:143], v[244:247], v[28:31]
v_mfma_f32_16x16x32_bf16 v[32:35], v[140:143], v[248:251], v[32:35]
v_mfma_f32_16x16x32_bf16 v[32:35], v[136:139], v[252:255], v[32:35]
v_mfma_f32_16x16x32_bf16 v[36:39], v[136:139], v[124:127], v[36:39]
v_mfma_f32_16x16x32_bf16 v[36:39], v[140:143], v[12:15], v[36:39]
s_add_u32 m0, s53, 131072
s_add_u32 s54, s77, 258048
buffer_load_dwordx4 v5, s[36:39], s54 offen  lds
v_mfma_f32_16x16x32_bf16 v[40:43], v[144:147], v[240:243], v[40:43]
v_mfma_f32_16x16x32_bf16 v[40:43], v[148:151], v[244:247], v[40:43]
v_mfma_f32_16x16x32_bf16 v[44:47], v[148:151], v[248:251], v[44:47]
v_mfma_f32_16x16x32_bf16 v[44:47], v[144:147], v[252:255], v[44:47]
v_mfma_f32_16x16x32_bf16 v[48:51], v[144:147], v[124:127], v[48:51]
v_mfma_f32_16x16x32_bf16 v[48:51], v[148:151], v[12:15], v[48:51]
s_add_u32 m0, s53, 135168
s_add_u32 s54, s78, 258048
buffer_load_dwordx4 v5, s[36:39], s54 offen  lds
v_mfma_f32_16x16x32_bf16 v[52:55], v[152:155], v[240:243], v[52:55]
v_mfma_f32_16x16x32_bf16 v[52:55], v[156:159], v[244:247], v[52:55]
v_mfma_f32_16x16x32_bf16 v[56:59], v[156:159], v[248:251], v[56:59]
v_mfma_f32_16x16x32_bf16 v[56:59], v[152:155], v[252:255], v[56:59]
v_mfma_f32_16x16x32_bf16 v[60:63], v[152:155], v[124:127], v[60:63]
v_mfma_f32_16x16x32_bf16 v[60:63], v[156:159], v[12:15], v[60:63]
s_add_u32 m0, s53, 139264
s_add_u32 s54, s79, 258048
buffer_load_dwordx4 v5, s[36:39], s54 offen  lds
v_mfma_f32_16x16x32_bf16 v[64:67], v[160:163], v[240:243], v[64:67]
v_mfma_f32_16x16x32_bf16 v[64:67], v[164:167], v[244:247], v[64:67]
v_mfma_f32_16x16x32_bf16 v[68:71], v[164:167], v[248:251], v[68:71]
v_mfma_f32_16x16x32_bf16 v[68:71], v[160:163], v[252:255], v[68:71]
v_mfma_f32_16x16x32_bf16 v[72:75], v[160:163], v[124:127], v[72:75]
v_mfma_f32_16x16x32_bf16 v[72:75], v[164:167], v[12:15], v[72:75]
s_add_u32 m0, s53, 143360
s_add_u32 s54, s80, 258048
buffer_load_dwordx4 v5, s[36:39], s54 offen  lds
v_mfma_f32_16x16x32_bf16 v[76:79], v[168:171], v[240:243], v[76:79]
v_mfma_f32_16x16x32_bf16 v[76:79], v[172:175], v[244:247], v[76:79]
v_mfma_f32_16x16x32_bf16 v[80:83], v[172:175], v[248:251], v[80:83]
v_mfma_f32_16x16x32_bf16 v[80:83], v[168:171], v[252:255], v[80:83]
v_mfma_f32_16x16x32_bf16 v[84:87], v[168:171], v[124:127], v[84:87]
v_mfma_f32_16x16x32_bf16 v[84:87], v[172:175], v[12:15], v[84:87]
s_add_u32 m0, s53, 147456
s_add_u32 s54, s81, 258048
buffer_load_dwordx4 v5, s[36:39], s54 offen  lds
v_mfma_f32_16x16x32_bf16 v[88:91], v[176:179], v[240:243], v[88:91]
v_mfma_f32_16x16x32_bf16 v[88:91], v[180:183], v[244:247], v[88:91]
v_mfma_f32_16x16x32_bf16 v[92:95], v[180:183], v[248:251], v[92:95]
v_mfma_f32_16x16x32_bf16 v[92:95], v[176:179], v[252:255], v[92:95]
v_mfma_f32_16x16x32_bf16 v[96:99], v[176:179], v[124:127], v[96:99]
v_mfma_f32_16x16x32_bf16 v[96:99], v[180:183], v[12:15], v[96:99]
s_add_u32 m0, s53, 151552
s_add_u32 s54, s82, 258048
buffer_load_dwordx4 v5, s[36:39], s54 offen  lds
s_waitcnt vmcnt(14)
s_barrier
s_add_u32 m0, s53, 32768
s_mov_b32 s54, 128
buffer_load_dwordx4 v3, s[28:31], s54 offen nt lds
s_add_u32 m0, s53, 36864
s_mov_b32 s54, 16512
buffer_load_dwordx4 v3, s[28:31], s54 offen nt lds
s_add_u32 m0, s53, 40960
s_mov_b32 s54, 32896
buffer_load_dwordx4 v3, s[28:31], s54 offen nt lds
s_add_u32 m0, s53, 45056
s_mov_b32 s54, 49280
buffer_load_dwordx4 v3, s[28:31], s54 offen nt lds
s_add_u32 m0, s53, 49152
s_mov_b32 s54, 65664
buffer_load_dwordx4 v3, s[28:31], s54 offen nt lds
s_add_u32 m0, s53, 53248
s_mov_b32 s54, 82048
buffer_load_dwordx4 v3, s[28:31], s54 offen nt lds
s_add_u32 m0, s53, 57344
s_mov_b32 s54, 98432
buffer_load_dwordx4 v3, s[28:31], s54 offen nt lds
s_add_u32 m0, s53, 61440
s_mov_b32 s54, 114816
buffer_load_dwordx4 v3, s[28:31], s54 offen nt lds
s_waitcnt vmcnt(8)
s_barrier
ds_read_b64_tr_b16 v[100:101], v6 offset:0
ds_read_b64_tr_b16 v[102:103], v6 offset:2048
ds_read_b64_tr_b16 v[112:113], v6 offset:28672
ds_read_b64_tr_b16 v[114:115], v6 offset:30720
ds_read_b64_tr_b16 v[116:117], v6 offset:4096
ds_read_b64_tr_b16 v[118:119], v6 offset:6144
ds_read_b64_tr_b16 v[104:105], v6 offset:32768
ds_read_b64_tr_b16 v[106:107], v6 offset:34816
ds_read_b64_tr_b16 v[108:109], v6 offset:8192
ds_read_b64_tr_b16 v[110:111], v6 offset:10240
ds_read_b64_tr_b16 v[120:121], v6 offset:36864
ds_read_b64_tr_b16 v[122:123], v6 offset:38912
ds_read_b64_tr_b16 v[128:129], v6 offset:12288
ds_read_b64_tr_b16 v[130:131], v6 offset:14336
ds_read_b64_tr_b16 v[132:133], v6 offset:40960
ds_read_b64_tr_b16 v[134:135], v6 offset:43008
ds_read_b64_tr_b16 v[136:137], v6 offset:16384
ds_read_b64_tr_b16 v[138:139], v6 offset:18432
ds_read_b64_tr_b16 v[140:141], v6 offset:45056
ds_read_b64_tr_b16 v[142:143], v6 offset:47104
ds_read_b64_tr_b16 v[144:145], v6 offset:20480
ds_read_b64_tr_b16 v[146:147], v6 offset:22528
ds_read_b64_tr_b16 v[148:149], v6 offset:49152
ds_read_b64_tr_b16 v[150:151], v6 offset:51200
ds_read_b64_tr_b16 v[152:153], v6 offset:24576
ds_read_b64_tr_b16 v[154:155], v6 offset:26624
ds_read_b64_tr_b16 v[156:157], v6 offset:53248
ds_read_b64_tr_b16 v[158:159], v6 offset:55296
s_waitcnt lgkmcnt(0)
s_barrier
s_waitcnt vmcnt(0)
s_add_u32 m0, s53, 98304
s_add_u32 s54, s76, 57344
buffer_load_dwordx4 v5, s[36:39], s54 offen  lds
s_add_u32 m0, s53, 102400
s_add_u32 s54, s77, 57344
buffer_load_dwordx4 v5, s[36:39], s54 offen  lds
s_add_u32 m0, s53, 106496
s_add_u32 s54, s78, 57344
buffer_load_dwordx4 v5, s[36:39], s54 offen  lds
s_barrier
ds_read_b128 v[160:163], v4 offset:6144
ds_read_b128 v[164:167], v4 offset:0
ds_read_b128 v[168:171], v4 offset:1024
ds_read_b128 v[172:175], v4 offset:7168
ds_read_b128 v[176:179], v4 offset:8192
ds_read_b128 v[180:183], v4 offset:2048
s_add_u32 m0, s53, 110592
s_add_u32 s54, s79, 57344
buffer_load_dwordx4 v5, s[36:39], s54 offen  lds
s_add_u32 m0, s53, 114688
s_add_u32 s54, s80, 57344
buffer_load_dwordx4 v5, s[36:39], s54 offen  lds
s_waitcnt lgkmcnt(5)
v_mfma_f32_16x16x32_bf16 v[16:19], v[184:187], v[160:163], v[16:19]
s_waitcnt lgkmcnt(4)
v_mfma_f32_16x16x32_bf16 v[16:19], v[188:191], v[164:167], v[16:19]
s_waitcnt lgkmcnt(3)
v_mfma_f32_16x16x32_bf16 v[20:23], v[188:191], v[168:171], v[20:23]
s_waitcnt lgkmcnt(2)
v_mfma_f32_16x16x32_bf16 v[20:23], v[184:187], v[172:175], v[20:23]
s_waitcnt lgkmcnt(1)
v_mfma_f32_16x16x32_bf16 v[24:27], v[184:187], v[176:179], v[24:27]
s_waitcnt lgkmcnt(0)
v_mfma_f32_16x16x32_bf16 v[24:27], v[188:191], v[180:183], v[24:27]
s_add_u32 m0, s53, 118784
s_add_u32 s54, s81, 57344
buffer_load_dwordx4 v5, s[36:39], s54 offen  lds
v_mfma_f32_16x16x32_bf16 v[28:31], v[192:195], v[160:163], v[28:31]
v_mfma_f32_16x16x32_bf16 v[28:31], v[196:199], v[164:167], v[28:31]
v_mfma_f32_16x16x32_bf16 v[32:35], v[196:199], v[168:171], v[32:35]
s_add_u32 m0, s53, 122880
s_add_u32 s54, s82, 57344
buffer_load_dwordx4 v5, s[36:39], s54 offen  lds
v_mfma_f32_16x16x32_bf16 v[32:35], v[192:195], v[172:175], v[32:35]
v_mfma_f32_16x16x32_bf16 v[36:39], v[192:195], v[176:179], v[36:39]
v_mfma_f32_16x16x32_bf16 v[36:39], v[196:199], v[180:183], v[36:39]
s_add_u32 m0, s53, 126976
s_add_u32 s54, s76, 86016
buffer_load_dwordx4 v5, s[36:39], s54 offen  lds
v_mfma_f32_16x16x32_bf16 v[40:43], v[200:203], v[160:163], v[40:43]
v_mfma_f32_16x16x32_bf16 v[40:43], v[204:207], v[164:167], v[40:43]
v_mfma_f32_16x16x32_bf16 v[44:47], v[204:207], v[168:171], v[44:47]
s_add_u32 m0, s53, 131072
s_add_u32 s54, s77, 86016
buffer_load_dwordx4 v5, s[36:39], s54 offen  lds
v_mfma_f32_16x16x32_bf16 v[44:47], v[200:203], v[172:175], v[44:47]
v_mfma_f32_16x16x32_bf16 v[48:51], v[200:203], v[176:179], v[48:51]
v_mfma_f32_16x16x32_bf16 v[48:51], v[204:207], v[180:183], v[48:51]
v_mfma_f32_16x16x32_bf16 v[52:55], v[208:211], v[160:163], v[52:55]
v_mfma_f32_16x16x32_bf16 v[52:55], v[212:215], v[164:167], v[52:55]
v_mfma_f32_16x16x32_bf16 v[56:59], v[212:215], v[168:171], v[56:59]
s_add_u32 m0, s53, 135168
s_add_u32 s54, s78, 86016
buffer_load_dwordx4 v5, s[36:39], s54 offen  lds
v_mfma_f32_16x16x32_bf16 v[56:59], v[208:211], v[172:175], v[56:59]
v_mfma_f32_16x16x32_bf16 v[60:63], v[208:211], v[176:179], v[60:63]
v_mfma_f32_16x16x32_bf16 v[60:63], v[212:215], v[180:183], v[60:63]
s_add_u32 m0, s53, 139264
s_add_u32 s54, s79, 86016
buffer_load_dwordx4 v5, s[36:39], s54 offen  lds
v_mfma_f32_16x16x32_bf16 v[64:67], v[216:219], v[160:163], v[64:67]
v_mfma_f32_16x16x32_bf16 v[64:67], v[220:223], v[164:167], v[64:67]
v_mfma_f32_16x16x32_bf16 v[68:71], v[220:223], v[168:171], v[68:71]
s_add_u32 m0, s53, 143360
s_add_u32 s54, s80, 86016
buffer_load_dwordx4 v5, s[36:39], s54 offen  lds
v_mfma_f32_16x16x32_bf16 v[68:71], v[216:219], v[172:175], v[68:71]
v_mfma_f32_16x16x32_bf16 v[72:75], v[216:219], v[176:179], v[72:75]
v_mfma_f32_16x16x32_bf16 v[72:75], v[220:223], v[180:183], v[72:75]
s_add_u32 m0, s53, 147456
s_add_u32 s54, s81, 86016
buffer_load_dwordx4 v5, s[36:39], s54 offen  lds
v_mfma_f32_16x16x32_bf16 v[76:79], v[224:227], v[160:163], v[76:79]
v_mfma_f32_16x16x32_bf16 v[76:79], v[228:231], v[164:167], v[76:79]
v_mfma_f32_16x16x32_bf16 v[80:83], v[228:231], v[168:171], v[80:83]
s_add_u32 m0, s53, 151552
s_add_u32 s54, s82, 86016
buffer_load_dwordx4 v5, s[36:39], s54 offen  lds
s_barrier
s_add_u32 m0, s53, 0
s_mov_b32 s54, 131200
buffer_load_dwordx4 v3, s[28:31], s54 offen nt lds
s_add_u32 m0, s53, 4096
s_mov_b32 s54, 147584
buffer_load_dwordx4 v3, s[28:31], s54 offen nt lds
v_mfma_f32_16x16x32_bf16 v[80:83], v[224:227], v[172:175], v[80:83]
v_mfma_f32_16x16x32_bf16 v[84:87], v[224:227], v[176:179], v[84:87]
v_mfma_f32_16x16x32_bf16 v[84:87], v[228:231], v[180:183], v[84:87]
s_add_u32 m0, s53, 8192
s_mov_b32 s54, 163968
buffer_load_dwordx4 v3, s[28:31], s54 offen nt lds
s_add_u32 m0, s53, 12288
s_mov_b32 s54, 180352
buffer_load_dwordx4 v3, s[28:31], s54 offen nt lds
v_mfma_f32_16x16x32_bf16 v[88:91], v[232:235], v[160:163], v[88:91]
v_mfma_f32_16x16x32_bf16 v[88:91], v[236:239], v[164:167], v[88:91]
v_mfma_f32_16x16x32_bf16 v[92:95], v[236:239], v[168:171], v[92:95]
s_add_u32 m0, s53, 16384
s_mov_b32 s54, 196736
buffer_load_dwordx4 v3, s[28:31], s54 offen nt lds
s_add_u32 m0, s53, 20480
s_mov_b32 s54, 213120
buffer_load_dwordx4 v3, s[28:31], s54 offen nt lds
v_mfma_f32_16x16x32_bf16 v[92:95], v[232:235], v[172:175], v[92:95]
v_mfma_f32_16x16x32_bf16 v[96:99], v[232:235], v[176:179], v[96:99]
v_mfma_f32_16x16x32_bf16 v[96:99], v[236:239], v[180:183], v[96:99]
s_add_u32 m0, s53, 24576
s_mov_b32 s54, 229504
buffer_load_dwordx4 v3, s[28:31], s54 offen nt lds
s_add_u32 m0, s53, 28672
s_mov_b32 s54, 245888
buffer_load_dwordx4 v3, s[28:31], s54 offen nt lds
s_waitcnt vmcnt(8)
s_barrier
ds_read_b128 v[240:243], v4 offset:18432
ds_read_b128 v[252:255], v4 offset:12288
ds_read_b128 v[124:127], v4 offset:13312
ds_read_b128 v[244:247], v4 offset:19456
ds_read_b128 v[248:251], v4 offset:20480
ds_read_b128 v[12:15], v4 offset:14336
ds_read_b64_tr_b16 v[184:185], v6 offset:0
ds_read_b64_tr_b16 v[186:187], v6 offset:2048
ds_read_b64_tr_b16 v[188:189], v6 offset:28672
ds_read_b64_tr_b16 v[190:191], v6 offset:30720
ds_read_b64_tr_b16 v[192:193], v6 offset:4096
ds_read_b64_tr_b16 v[194:195], v6 offset:6144
ds_read_b64_tr_b16 v[196:197], v6 offset:32768
ds_read_b64_tr_b16 v[198:199], v6 offset:34816
ds_read_b64_tr_b16 v[200:201], v6 offset:8192
ds_read_b64_tr_b16 v[202:203], v6 offset:10240
ds_read_b64_tr_b16 v[204:205], v6 offset:36864
ds_read_b64_tr_b16 v[206:207], v6 offset:38912
ds_read_b64_tr_b16 v[208:209], v6 offset:12288
ds_read_b64_tr_b16 v[210:211], v6 offset:14336
ds_read_b64_tr_b16 v[212:213], v6 offset:40960
ds_read_b64_tr_b16 v[214:215], v6 offset:43008
ds_read_b64_tr_b16 v[216:217], v6 offset:16384
ds_read_b64_tr_b16 v[218:219], v6 offset:18432
ds_read_b64_tr_b16 v[220:221], v6 offset:45056
ds_read_b64_tr_b16 v[222:223], v6 offset:47104
ds_read_b64_tr_b16 v[224:225], v6 offset:20480
ds_read_b64_tr_b16 v[226:227], v6 offset:22528
ds_read_b64_tr_b16 v[228:229], v6 offset:49152
ds_read_b64_tr_b16 v[230:231], v6 offset:51200
ds_read_b64_tr_b16 v[232:233], v6 offset:24576
ds_read_b64_tr_b16 v[234:235], v6 offset:26624
ds_read_b64_tr_b16 v[236:237], v6 offset:53248
ds_read_b64_tr_b16 v[238:239], v6 offset:55296
s_waitcnt lgkmcnt(0)
s_barrier
s_add_u32 m0, s53, 98304
s_add_u32 s54, s76, 286720
buffer_load_dwordx4 v5, s[36:39], s54 offen  lds
s_add_u32 m0, s53, 102400
s_add_u32 s54, s77, 286720
buffer_load_dwordx4 v5, s[36:39], s54 offen  lds
s_add_u32 m0, s53, 106496
s_add_u32 s54, s78, 286720
buffer_load_dwordx4 v5, s[36:39], s54 offen  lds
s_add_u32 m0, s53, 110592
s_add_u32 s54, s79, 286720
buffer_load_dwordx4 v5, s[36:39], s54 offen  lds
s_add_u32 m0, s53, 114688
s_add_u32 s54, s80, 286720
buffer_load_dwordx4 v5, s[36:39], s54 offen  lds
s_add_u32 m0, s53, 118784
s_add_u32 s54, s81, 286720
buffer_load_dwordx4 v5, s[36:39], s54 offen  lds
s_add_u32 m0, s53, 122880
s_add_u32 s54, s82, 286720
buffer_load_dwordx4 v5, s[36:39], s54 offen  lds
s_add_u32 m0, s53, 126976
s_add_u32 s54, s76, 315392
buffer_load_dwordx4 v5, s[36:39], s54 offen  lds
s_add_u32 m0, s53, 131072
s_add_u32 s54, s77, 315392
buffer_load_dwordx4 v5, s[36:39], s54 offen  lds
s_add_u32 m0, s53, 135168
s_add_u32 s54, s78, 315392
buffer_load_dwordx4 v5, s[36:39], s54 offen  lds
v_mfma_f32_16x16x32_bf16 v[16:19], v[100:103], v[240:243], v[16:19]
v_mfma_f32_16x16x32_bf16 v[16:19], v[112:115], v[252:255], v[16:19]
v_mfma_f32_16x16x32_bf16 v[20:23], v[112:115], v[124:127], v[20:23]
v_mfma_f32_16x16x32_bf16 v[20:23], v[100:103], v[244:247], v[20:23]
v_mfma_f32_16x16x32_bf16 v[24:27], v[100:103], v[248:251], v[24:27]
v_mfma_f32_16x16x32_bf16 v[24:27], v[112:115], v[12:15], v[24:27]
v_mfma_f32_16x16x32_bf16 v[28:31], v[116:119], v[240:243], v[28:31]
v_mfma_f32_16x16x32_bf16 v[28:31], v[104:107], v[252:255], v[28:31]
v_mfma_f32_16x16x32_bf16 v[32:35], v[104:107], v[124:127], v[32:35]
v_mfma_f32_16x16x32_bf16 v[32:35], v[116:119], v[244:247], v[32:35]
v_mfma_f32_16x16x32_bf16 v[36:39], v[116:119], v[248:251], v[36:39]
v_mfma_f32_16x16x32_bf16 v[36:39], v[104:107], v[12:15], v[36:39]
s_add_u32 m0, s53, 139264
s_add_u32 s54, s79, 315392
buffer_load_dwordx4 v5, s[36:39], s54 offen  lds
v_mfma_f32_16x16x32_bf16 v[40:43], v[108:111], v[240:243], v[40:43]
v_mfma_f32_16x16x32_bf16 v[40:43], v[120:123], v[252:255], v[40:43]
v_mfma_f32_16x16x32_bf16 v[44:47], v[120:123], v[124:127], v[44:47]
v_mfma_f32_16x16x32_bf16 v[44:47], v[108:111], v[244:247], v[44:47]
v_mfma_f32_16x16x32_bf16 v[48:51], v[108:111], v[248:251], v[48:51]
v_mfma_f32_16x16x32_bf16 v[48:51], v[120:123], v[12:15], v[48:51]
v_mfma_f32_16x16x32_bf16 v[52:55], v[128:131], v[240:243], v[52:55]
v_mfma_f32_16x16x32_bf16 v[52:55], v[132:135], v[252:255], v[52:55]
v_mfma_f32_16x16x32_bf16 v[56:59], v[132:135], v[124:127], v[56:59]
s_add_u32 m0, s53, 143360
s_add_u32 s54, s80, 315392
buffer_load_dwordx4 v5, s[36:39], s54 offen  lds
v_mfma_f32_16x16x32_bf16 v[56:59], v[128:131], v[244:247], v[56:59]
v_mfma_f32_16x16x32_bf16 v[60:63], v[128:131], v[248:251], v[60:63]
v_mfma_f32_16x16x32_bf16 v[60:63], v[132:135], v[12:15], v[60:63]
v_mfma_f32_16x16x32_bf16 v[64:67], v[136:139], v[240:243], v[64:67]
v_mfma_f32_16x16x32_bf16 v[64:67], v[140:143], v[252:255], v[64:67]
v_mfma_f32_16x16x32_bf16 v[68:71], v[140:143], v[124:127], v[68:71]
v_mfma_f32_16x16x32_bf16 v[68:71], v[136:139], v[244:247], v[68:71]
v_mfma_f32_16x16x32_bf16 v[72:75], v[136:139], v[248:251], v[72:75]
v_mfma_f32_16x16x32_bf16 v[72:75], v[140:143], v[12:15], v[72:75]
v_mfma_f32_16x16x32_bf16 v[76:79], v[144:147], v[240:243], v[76:79]
v_mfma_f32_16x16x32_bf16 v[76:79], v[148:151], v[252:255], v[76:79]
v_mfma_f32_16x16x32_bf16 v[80:83], v[148:151], v[124:127], v[80:83]
s_add_u32 m0, s53, 147456
s_add_u32 s54, s81, 315392
buffer_load_dwordx4 v5, s[36:39], s54 offen  lds
v_mfma_f32_16x16x32_bf16 v[80:83], v[144:147], v[244:247], v[80:83]
v_mfma_f32_16x16x32_bf16 v[84:87], v[144:147], v[248:251], v[84:87]
v_mfma_f32_16x16x32_bf16 v[84:87], v[148:151], v[12:15], v[84:87]
v_mfma_f32_16x16x32_bf16 v[88:91], v[152:155], v[240:243], v[88:91]
v_mfma_f32_16x16x32_bf16 v[88:91], v[156:159], v[252:255], v[88:91]
v_mfma_f32_16x16x32_bf16 v[92:95], v[156:159], v[124:127], v[92:95]
v_mfma_f32_16x16x32_bf16 v[92:95], v[152:155], v[244:247], v[92:95]
v_mfma_f32_16x16x32_bf16 v[96:99], v[152:155], v[248:251], v[96:99]
v_mfma_f32_16x16x32_bf16 v[96:99], v[156:159], v[12:15], v[96:99]
s_add_u32 m0, s53, 151552
s_add_u32 s54, s82, 315392
buffer_load_dwordx4 v5, s[36:39], s54 offen  lds
s_waitcnt vmcnt(14)
s_barrier
s_add_u32 m0, s53, 32768
s_mov_b32 s54, 256
buffer_load_dwordx4 v3, s[28:31], s54 offen nt lds
s_add_u32 m0, s53, 36864
s_mov_b32 s54, 16640
buffer_load_dwordx4 v3, s[28:31], s54 offen nt lds
s_add_u32 m0, s53, 40960
s_mov_b32 s54, 33024
buffer_load_dwordx4 v3, s[28:31], s54 offen nt lds
s_add_u32 m0, s53, 45056
s_mov_b32 s54, 49408
buffer_load_dwordx4 v3, s[28:31], s54 offen nt lds
s_add_u32 m0, s53, 49152
s_mov_b32 s54, 65792
buffer_load_dwordx4 v3, s[28:31], s54 offen nt lds
s_add_u32 m0, s53, 53248
s_mov_b32 s54, 82176
buffer_load_dwordx4 v3, s[28:31], s54 offen nt lds
s_add_u32 m0, s53, 57344
s_mov_b32 s54, 98560
buffer_load_dwordx4 v3, s[28:31], s54 offen nt lds
s_add_u32 m0, s53, 61440
s_mov_b32 s54, 114944
buffer_load_dwordx4 v3, s[28:31], s54 offen nt lds
s_waitcnt vmcnt(8)
s_barrier
ds_read_b64_tr_b16 v[160:161], v6 offset:0
ds_read_b64_tr_b16 v[162:163], v6 offset:2048
ds_read_b64_tr_b16 v[172:173], v6 offset:28672
ds_read_b64_tr_b16 v[174:175], v6 offset:30720
ds_read_b64_tr_b16 v[176:177], v6 offset:4096
ds_read_b64_tr_b16 v[178:179], v6 offset:6144
ds_read_b64_tr_b16 v[164:165], v6 offset:32768
ds_read_b64_tr_b16 v[166:167], v6 offset:34816
ds_read_b64_tr_b16 v[168:169], v6 offset:8192
ds_read_b64_tr_b16 v[170:171], v6 offset:10240
ds_read_b64_tr_b16 v[180:181], v6 offset:36864
ds_read_b64_tr_b16 v[182:183], v6 offset:38912
ds_read_b64_tr_b16 v[100:101], v6 offset:12288
ds_read_b64_tr_b16 v[102:103], v6 offset:14336
ds_read_b64_tr_b16 v[112:113], v6 offset:40960
ds_read_b64_tr_b16 v[114:115], v6 offset:43008
ds_read_b64_tr_b16 v[116:117], v6 offset:16384
ds_read_b64_tr_b16 v[118:119], v6 offset:18432
ds_read_b64_tr_b16 v[104:105], v6 offset:45056
ds_read_b64_tr_b16 v[106:107], v6 offset:47104
ds_read_b64_tr_b16 v[108:109], v6 offset:20480
ds_read_b64_tr_b16 v[110:111], v6 offset:22528
ds_read_b64_tr_b16 v[120:121], v6 offset:49152
ds_read_b64_tr_b16 v[122:123], v6 offset:51200
ds_read_b64_tr_b16 v[128:129], v6 offset:24576
ds_read_b64_tr_b16 v[130:131], v6 offset:26624
ds_read_b64_tr_b16 v[132:133], v6 offset:53248
ds_read_b64_tr_b16 v[134:135], v6 offset:55296
s_waitcnt lgkmcnt(0)
s_barrier
s_waitcnt vmcnt(0)
s_add_u32 m0, s53, 98304
s_add_u32 s54, s76, 114688
buffer_load_dwordx4 v5, s[36:39], s54 offen  lds
s_add_u32 m0, s53, 102400
s_add_u32 s54, s77, 114688
buffer_load_dwordx4 v5, s[36:39], s54 offen  lds
s_add_u32 m0, s53, 106496
s_add_u32 s54, s78, 114688
buffer_load_dwordx4 v5, s[36:39], s54 offen  lds
s_barrier
ds_read_b128 v[136:139], v4 offset:6144
ds_read_b128 v[140:143], v4 offset:0
ds_read_b128 v[144:147], v4 offset:1024
ds_read_b128 v[148:151], v4 offset:7168
ds_read_b128 v[152:155], v4 offset:8192
ds_read_b128 v[156:159], v4 offset:2048
s_add_u32 m0, s53, 110592
s_add_u32 s54, s79, 114688
buffer_load_dwordx4 v5, s[36:39], s54 offen  lds
s_add_u32 m0, s53, 114688
s_add_u32 s54, s80, 114688
buffer_load_dwordx4 v5, s[36:39], s54 offen  lds
s_waitcnt lgkmcnt(5)
v_mfma_f32_16x16x32_bf16 v[16:19], v[184:187], v[136:139], v[16:19]
s_waitcnt lgkmcnt(4)
v_mfma_f32_16x16x32_bf16 v[16:19], v[188:191], v[140:143], v[16:19]
s_waitcnt lgkmcnt(3)
v_mfma_f32_16x16x32_bf16 v[20:23], v[188:191], v[144:147], v[20:23]
s_waitcnt lgkmcnt(2)
v_mfma_f32_16x16x32_bf16 v[20:23], v[184:187], v[148:151], v[20:23]
s_waitcnt lgkmcnt(1)
v_mfma_f32_16x16x32_bf16 v[24:27], v[184:187], v[152:155], v[24:27]
s_waitcnt lgkmcnt(0)
v_mfma_f32_16x16x32_bf16 v[24:27], v[188:191], v[156:159], v[24:27]
s_add_u32 m0, s53, 118784
s_add_u32 s54, s81, 114688
buffer_load_dwordx4 v5, s[36:39], s54 offen  lds
v_mfma_f32_16x16x32_bf16 v[28:31], v[192:195], v[136:139], v[28:31]
v_mfma_f32_16x16x32_bf16 v[28:31], v[196:199], v[140:143], v[28:31]
v_mfma_f32_16x16x32_bf16 v[32:35], v[196:199], v[144:147], v[32:35]
s_add_u32 m0, s53, 122880
s_add_u32 s54, s82, 114688
buffer_load_dwordx4 v5, s[36:39], s54 offen  lds
v_mfma_f32_16x16x32_bf16 v[32:35], v[192:195], v[148:151], v[32:35]
v_mfma_f32_16x16x32_bf16 v[36:39], v[192:195], v[152:155], v[36:39]
v_mfma_f32_16x16x32_bf16 v[36:39], v[196:199], v[156:159], v[36:39]
s_add_u32 m0, s53, 126976
s_add_u32 s54, s76, 143360
buffer_load_dwordx4 v5, s[36:39], s54 offen  lds
v_mfma_f32_16x16x32_bf16 v[40:43], v[200:203], v[136:139], v[40:43]
v_mfma_f32_16x16x32_bf16 v[40:43], v[204:207], v[140:143], v[40:43]
v_mfma_f32_16x16x32_bf16 v[44:47], v[204:207], v[144:147], v[44:47]
s_add_u32 m0, s53, 131072
s_add_u32 s54, s77, 143360
buffer_load_dwordx4 v5, s[36:39], s54 offen  lds
v_mfma_f32_16x16x32_bf16 v[44:47], v[200:203], v[148:151], v[44:47]
v_mfma_f32_16x16x32_bf16 v[48:51], v[200:203], v[152:155], v[48:51]
v_mfma_f32_16x16x32_bf16 v[48:51], v[204:207], v[156:159], v[48:51]
v_mfma_f32_16x16x32_bf16 v[52:55], v[208:211], v[136:139], v[52:55]
v_mfma_f32_16x16x32_bf16 v[52:55], v[212:215], v[140:143], v[52:55]
v_mfma_f32_16x16x32_bf16 v[56:59], v[212:215], v[144:147], v[56:59]
s_add_u32 m0, s53, 135168
s_add_u32 s54, s78, 143360
buffer_load_dwordx4 v5, s[36:39], s54 offen  lds
v_mfma_f32_16x16x32_bf16 v[56:59], v[208:211], v[148:151], v[56:59]
v_mfma_f32_16x16x32_bf16 v[60:63], v[208:211], v[152:155], v[60:63]
v_mfma_f32_16x16x32_bf16 v[60:63], v[212:215], v[156:159], v[60:63]
s_add_u32 m0, s53, 139264
s_add_u32 s54, s79, 143360
buffer_load_dwordx4 v5, s[36:39], s54 offen  lds
v_mfma_f32_16x16x32_bf16 v[64:67], v[216:219], v[136:139], v[64:67]
v_mfma_f32_16x16x32_bf16 v[64:67], v[220:223], v[140:143], v[64:67]
v_mfma_f32_16x16x32_bf16 v[68:71], v[220:223], v[144:147], v[68:71]
s_add_u32 m0, s53, 143360
s_add_u32 s54, s80, 143360
buffer_load_dwordx4 v5, s[36:39], s54 offen  lds
v_mfma_f32_16x16x32_bf16 v[68:71], v[216:219], v[148:151], v[68:71]
v_mfma_f32_16x16x32_bf16 v[72:75], v[216:219], v[152:155], v[72:75]
v_mfma_f32_16x16x32_bf16 v[72:75], v[220:223], v[156:159], v[72:75]
s_add_u32 m0, s53, 147456
s_add_u32 s54, s81, 143360
buffer_load_dwordx4 v5, s[36:39], s54 offen  lds
v_mfma_f32_16x16x32_bf16 v[76:79], v[224:227], v[136:139], v[76:79]
v_mfma_f32_16x16x32_bf16 v[76:79], v[228:231], v[140:143], v[76:79]
v_mfma_f32_16x16x32_bf16 v[80:83], v[228:231], v[144:147], v[80:83]
s_add_u32 m0, s53, 151552
s_add_u32 s54, s82, 143360
buffer_load_dwordx4 v5, s[36:39], s54 offen  lds
s_barrier
s_add_u32 m0, s53, 0
s_mov_b32 s54, 131328
buffer_load_dwordx4 v3, s[28:31], s54 offen nt lds
s_add_u32 m0, s53, 4096
s_mov_b32 s54, 147712
buffer_load_dwordx4 v3, s[28:31], s54 offen nt lds
v_mfma_f32_16x16x32_bf16 v[80:83], v[224:227], v[148:151], v[80:83]
v_mfma_f32_16x16x32_bf16 v[84:87], v[224:227], v[152:155], v[84:87]
v_mfma_f32_16x16x32_bf16 v[84:87], v[228:231], v[156:159], v[84:87]
s_add_u32 m0, s53, 8192
s_mov_b32 s54, 164096
buffer_load_dwordx4 v3, s[28:31], s54 offen nt lds
s_add_u32 m0, s53, 12288
s_mov_b32 s54, 180480
buffer_load_dwordx4 v3, s[28:31], s54 offen nt lds
v_mfma_f32_16x16x32_bf16 v[88:91], v[232:235], v[136:139], v[88:91]
v_mfma_f32_16x16x32_bf16 v[88:91], v[236:239], v[140:143], v[88:91]
v_mfma_f32_16x16x32_bf16 v[92:95], v[236:239], v[144:147], v[92:95]
s_add_u32 m0, s53, 16384
s_mov_b32 s54, 196864
buffer_load_dwordx4 v3, s[28:31], s54 offen nt lds
s_add_u32 m0, s53, 20480
s_mov_b32 s54, 213248
buffer_load_dwordx4 v3, s[28:31], s54 offen nt lds
v_mfma_f32_16x16x32_bf16 v[92:95], v[232:235], v[148:151], v[92:95]
v_mfma_f32_16x16x32_bf16 v[96:99], v[232:235], v[152:155], v[96:99]
v_mfma_f32_16x16x32_bf16 v[96:99], v[236:239], v[156:159], v[96:99]
s_add_u32 m0, s53, 24576
s_mov_b32 s54, 229632
buffer_load_dwordx4 v3, s[28:31], s54 offen nt lds
s_add_u32 m0, s53, 28672
s_mov_b32 s54, 246016
buffer_load_dwordx4 v3, s[28:31], s54 offen nt lds
s_waitcnt vmcnt(8)
s_barrier
ds_read_b128 v[240:243], v4 offset:18432
ds_read_b128 v[244:247], v4 offset:12288
ds_read_b128 v[248:251], v4 offset:13312
ds_read_b128 v[252:255], v4 offset:19456
ds_read_b128 v[124:127], v4 offset:20480
ds_read_b128 v[12:15], v4 offset:14336
ds_read_b64_tr_b16 v[184:185], v6 offset:0
ds_read_b64_tr_b16 v[186:187], v6 offset:2048
ds_read_b64_tr_b16 v[188:189], v6 offset:28672
ds_read_b64_tr_b16 v[190:191], v6 offset:30720
ds_read_b64_tr_b16 v[192:193], v6 offset:4096
ds_read_b64_tr_b16 v[194:195], v6 offset:6144
ds_read_b64_tr_b16 v[196:197], v6 offset:32768
ds_read_b64_tr_b16 v[198:199], v6 offset:34816
ds_read_b64_tr_b16 v[200:201], v6 offset:8192
ds_read_b64_tr_b16 v[202:203], v6 offset:10240
ds_read_b64_tr_b16 v[204:205], v6 offset:36864
ds_read_b64_tr_b16 v[206:207], v6 offset:38912
ds_read_b64_tr_b16 v[208:209], v6 offset:12288
ds_read_b64_tr_b16 v[210:211], v6 offset:14336
ds_read_b64_tr_b16 v[212:213], v6 offset:40960
ds_read_b64_tr_b16 v[214:215], v6 offset:43008
ds_read_b64_tr_b16 v[216:217], v6 offset:16384
ds_read_b64_tr_b16 v[218:219], v6 offset:18432
ds_read_b64_tr_b16 v[220:221], v6 offset:45056
ds_read_b64_tr_b16 v[222:223], v6 offset:47104
ds_read_b64_tr_b16 v[224:225], v6 offset:20480
ds_read_b64_tr_b16 v[226:227], v6 offset:22528
ds_read_b64_tr_b16 v[228:229], v6 offset:49152
ds_read_b64_tr_b16 v[230:231], v6 offset:51200
ds_read_b64_tr_b16 v[232:233], v6 offset:24576
ds_read_b64_tr_b16 v[234:235], v6 offset:26624
ds_read_b64_tr_b16 v[236:237], v6 offset:53248
ds_read_b64_tr_b16 v[238:239], v6 offset:55296
s_waitcnt lgkmcnt(0)
s_barrier
s_add_u32 m0, s53, 98304
s_add_u32 s54, s76, 344064
buffer_load_dwordx4 v5, s[36:39], s54 offen  lds
s_add_u32 m0, s53, 126976
s_add_u32 s54, s76, 372736
buffer_load_dwordx4 v5, s[36:39], s54 offen  lds
v_mfma_f32_16x16x32_bf16 v[16:19], v[160:163], v[240:243], v[16:19]
v_mfma_f32_16x16x32_bf16 v[16:19], v[172:175], v[244:247], v[16:19]
v_mfma_f32_16x16x32_bf16 v[20:23], v[172:175], v[248:251], v[20:23]
v_mfma_f32_16x16x32_bf16 v[20:23], v[160:163], v[252:255], v[20:23]
v_mfma_f32_16x16x32_bf16 v[24:27], v[160:163], v[124:127], v[24:27]
v_mfma_f32_16x16x32_bf16 v[24:27], v[172:175], v[12:15], v[24:27]
s_add_u32 m0, s53, 102400
s_add_u32 s54, s77, 344064
buffer_load_dwordx4 v5, s[36:39], s54 offen  lds
v_mfma_f32_16x16x32_bf16 v[28:31], v[176:179], v[240:243], v[28:31]
v_mfma_f32_16x16x32_bf16 v[28:31], v[164:167], v[244:247], v[28:31]
v_mfma_f32_16x16x32_bf16 v[32:35], v[164:167], v[248:251], v[32:35]
v_mfma_f32_16x16x32_bf16 v[32:35], v[176:179], v[252:255], v[32:35]
v_mfma_f32_16x16x32_bf16 v[36:39], v[176:179], v[124:127], v[36:39]
v_mfma_f32_16x16x32_bf16 v[36:39], v[164:167], v[12:15], v[36:39]
s_add_u32 m0, s53, 131072
s_add_u32 s54, s77, 372736
buffer_load_dwordx4 v5, s[36:39], s54 offen  lds
v_mfma_f32_16x16x32_bf16 v[40:43], v[168:171], v[240:243], v[40:43]
v_mfma_f32_16x16x32_bf16 v[40:43], v[180:183], v[244:247], v[40:43]
v_mfma_f32_16x16x32_bf16 v[44:47], v[180:183], v[248:251], v[44:47]
s_add_u32 m0, s53, 106496
s_add_u32 s54, s78, 344064
buffer_load_dwordx4 v5, s[36:39], s54 offen  lds
v_mfma_f32_16x16x32_bf16 v[44:47], v[168:171], v[252:255], v[44:47]
v_mfma_f32_16x16x32_bf16 v[48:51], v[168:171], v[124:127], v[48:51]
v_mfma_f32_16x16x32_bf16 v[48:51], v[180:183], v[12:15], v[48:51]
v_mfma_f32_16x16x32_bf16 v[52:55], v[100:103], v[240:243], v[52:55]
v_mfma_f32_16x16x32_bf16 v[52:55], v[112:115], v[244:247], v[52:55]
v_mfma_f32_16x16x32_bf16 v[56:59], v[112:115], v[248:251], v[56:59]
s_add_u32 m0, s53, 135168
s_add_u32 s54, s78, 372736
buffer_load_dwordx4 v5, s[36:39], s54 offen  lds
v_mfma_f32_16x16x32_bf16 v[56:59], v[100:103], v[252:255], v[56:59]
v_mfma_f32_16x16x32_bf16 v[60:63], v[100:103], v[124:127], v[60:63]
v_mfma_f32_16x16x32_bf16 v[60:63], v[112:115], v[12:15], v[60:63]
v_mfma_f32_16x16x32_bf16 v[64:67], v[116:119], v[240:243], v[64:67]
v_mfma_f32_16x16x32_bf16 v[64:67], v[104:107], v[244:247], v[64:67]
v_mfma_f32_16x16x32_bf16 v[68:71], v[104:107], v[248:251], v[68:71]
s_add_u32 m0, s53, 110592
s_add_u32 s54, s79, 344064
buffer_load_dwordx4 v5, s[36:39], s54 offen  lds
v_mfma_f32_16x16x32_bf16 v[68:71], v[116:119], v[252:255], v[68:71]
v_mfma_f32_16x16x32_bf16 v[72:75], v[116:119], v[124:127], v[72:75]
v_mfma_f32_16x16x32_bf16 v[72:75], v[104:107], v[12:15], v[72:75]
s_add_u32 m0, s53, 139264
s_add_u32 s54, s79, 372736
buffer_load_dwordx4 v5, s[36:39], s54 offen  lds
s_waitcnt vmcnt(8)
s_barrier
v_mfma_f32_16x16x32_bf16 v[76:79], v[108:111], v[240:243], v[76:79]
v_mfma_f32_16x16x32_bf16 v[76:79], v[120:123], v[244:247], v[76:79]
v_mfma_f32_16x16x32_bf16 v[80:83], v[120:123], v[248:251], v[80:83]
v_mfma_f32_16x16x32_bf16 v[80:83], v[108:111], v[252:255], v[80:83]
v_mfma_f32_16x16x32_bf16 v[84:87], v[108:111], v[124:127], v[84:87]
v_mfma_f32_16x16x32_bf16 v[84:87], v[120:123], v[12:15], v[84:87]
v_mfma_f32_16x16x32_bf16 v[88:91], v[128:131], v[240:243], v[88:91]
v_mfma_f32_16x16x32_bf16 v[88:91], v[132:135], v[244:247], v[88:91]
v_mfma_f32_16x16x32_bf16 v[92:95], v[132:135], v[248:251], v[92:95]
v_mfma_f32_16x16x32_bf16 v[92:95], v[128:131], v[252:255], v[92:95]
v_mfma_f32_16x16x32_bf16 v[96:99], v[128:131], v[124:127], v[96:99]
v_mfma_f32_16x16x32_bf16 v[96:99], v[132:135], v[12:15], v[96:99]
s_sub_u32 s56, s3, s55
s_and_b32 s56, s56, 7
s_mul_i32 s60, s3, 6144
s_sub_u32 s60, 155648, s60
v_add_u32 v3, s60, v7
s_add_u32 s60, s60, 1024
v_add_u32 v5, s60, v2
s_lshl_b32 s60, s3, 7
v_and_b32 v8, 7, v1
v_lshl_add_u32 v8, v8, 2, s60
s_lshl_b32 s65, 1, s3
s_xor_b32 s65, s65, 0xff
s_waitcnt vmcnt(0)
s_barrier
ds_read_b64_tr_b16 v[136:137], v6 offset:0
ds_read_b64_tr_b16 v[138:139], v6 offset:2048
ds_read_b64_tr_b16 v[148:149], v6 offset:28672
ds_read_b64_tr_b16 v[150:151], v6 offset:30720
ds_read_b64_tr_b16 v[152:153], v6 offset:4096
ds_read_b64_tr_b16 v[154:155], v6 offset:6144
ds_read_b64_tr_b16 v[140:141], v6 offset:32768
ds_read_b64_tr_b16 v[142:143], v6 offset:34816
ds_read_b64_tr_b16 v[144:145], v6 offset:8192
ds_read_b64_tr_b16 v[146:147], v6 offset:10240
ds_read_b64_tr_b16 v[156:157], v6 offset:36864
ds_read_b64_tr_b16 v[158:159], v6 offset:38912
ds_read_b64_tr_b16 v[160:161], v6 offset:12288
ds_read_b64_tr_b16 v[162:163], v6 offset:14336
ds_read_b64_tr_b16 v[172:173], v6 offset:40960
ds_read_b64_tr_b16 v[174:175], v6 offset:43008
buffer_load_dword v10, v8, s[48:51], 0 offen sc1
s_barrier
ds_read_b128 v[176:179], v4 offset:6144
ds_read_b128 v[164:167], v4 offset:0
ds_read_b128 v[168:171], v4 offset:18432
ds_read_b128 v[180:183], v4 offset:12288
ds_read_b128 v[100:103], v4 offset:13312
ds_read_b128 v[112:115], v4 offset:19456
ds_read_b128 v[116:119], v4 offset:1024
ds_read_b128 v[104:107], v4 offset:7168
ds_read_b128 v[108:111], v4 offset:8192
ds_read_b128 v[120:123], v4 offset:2048
ds_read_b128 v[128:131], v4 offset:20480
ds_read_b128 v[132:135], v4 offset:14336
s_waitcnt lgkmcnt(11)
v_mfma_f32_16x16x32_bf16 v[16:19], v[184:187], v[176:179], v[16:19]
s_waitcnt lgkmcnt(10)
v_mfma_f32_16x16x32_bf16 v[16:19], v[188:191], v[164:167], v[16:19]
s_waitcnt lgkmcnt(9)
v_mfma_f32_16x16x32_bf16 v[16:19], v[136:139], v[168:171], v[16:19]
s_waitcnt lgkmcnt(8)
v_mfma_f32_16x16x32_bf16 v[16:19], v[148:151], v[180:183], v[16:19]
s_waitcnt lgkmcnt(7)
v_mfma_f32_16x16x32_bf16 v[20:23], v[148:151], v[100:103], v[20:23]
s_waitcnt lgkmcnt(6)
v_mfma_f32_16x16x32_bf16 v[20:23], v[136:139], v[112:115], v[20:23]
s_waitcnt lgkmcnt(5)
v_mfma_f32_16x16x32_bf16 v[20:23], v[188:191], v[116:119], v[20:23]
s_waitcnt lgkmcnt(4)
v_mfma_f32_16x16x32_bf16 v[20:23], v[184:187], v[104:107], v[20:23]
s_waitcnt lgkmcnt(3)
v_mfma_f32_16x16x32_bf16 v[24:27], v[184:187], v[108:111], v[24:27]
s_waitcnt lgkmcnt(2)
v_mfma_f32_16x16x32_bf16 v[24:27], v[188:191], v[120:123], v[24:27]
s_waitcnt lgkmcnt(1)
v_mfma_f32_16x16x32_bf16 v[24:27], v[136:139], v[128:131], v[24:27]
s_waitcnt lgkmcnt(0)
v_mfma_f32_16x16x32_bf16 v[24:27], v[148:151], v[132:135], v[24:27]
v_mfma_f32_16x16x32_bf16 v[28:31], v[192:195], v[176:179], v[28:31]
v_cvt_pk_bf16_f32 v16, v16, v17
v_cvt_pk_bf16_f32 v17, v18, v19
v_mfma_f32_16x16x32_bf16 v[28:31], v[196:199], v[164:167], v[28:31]
v_cvt_pk_bf16_f32 v18, v20, v21
v_cvt_pk_bf16_f32 v19, v22, v23
v_mfma_f32_16x16x32_bf16 v[28:31], v[152:155], v[168:171], v[28:31]
s_mul_i32 s54, s76, 384
v_mfma_f32_16x16x32_bf16 v[28:31], v[140:143], v[180:183], v[28:31]
v_cvt_pk_bf16_f32 v24, v24, v25
v_cvt_pk_bf16_f32 v25, v26, v27
v_mfma_f32_16x16x32_bf16 v[32:35], v[140:143], v[100:103], v[32:35]
v_permlane16_swap_b32 v16, v18
v_permlane16_swap_b32 v17, v19
v_mfma_f32_16x16x32_bf16 v[32:35], v[152:155], v[112:115], v[32:35]
s_movk_i32 s64, 200
L_go0:
s_waitcnt vmcnt(0)
v_cmp_eq_u32 vcc, 0, v10
s_nop 0
s_and_b32 s60, vcc_lo, s65
s_cbranch_scc0 L_go1
s_sleep 2
buffer_load_dword v10, v8, s[48:51], 0 offen sc1
s_sub_u32 s64, s64, 1
s_cbranch_scc0 L_go0
L_go1:
buffer_store_dwordx4 v[16:19], v7, s[40:43], s54 offen sc1
buffer_store_dwordx2 v[24:25], v2, s[40:43], s54 offen offset:1024 sc1
L_r0:
v_mfma_f32_16x16x32_bf16 v[32:35], v[196:199], v[116:119], v[32:35]
v_mfma_f32_16x16x32_bf16 v[32:35], v[192:195], v[104:107], v[32:35]
v_mfma_f32_16x16x32_bf16 v[36:39], v[192:195], v[108:111], v[36:39]
v_mfma_f32_16x16x32_bf16 v[36:39], v[196:199], v[120:123], v[36:39]
v_mfma_f32_16x16x32_bf16 v[36:39], v[152:155], v[128:131], v[36:39]
v_mfma_f32_16x16x32_bf16 v[36:39], v[140:143], v[132:135], v[36:39]
v_mfma_f32_16x16x32_bf16 v[40:43], v[200:203], v[176:179], v[40:43]
v_cvt_pk_bf16_f32 v28, v28, v29
v_cvt_pk_bf16_f32 v29, v30, v31
v_mfma_f32_16x16x32_bf16 v[40:43], v[204:207], v[164:167], v[40:43]
v_cvt_pk_bf16_f32 v30, v32, v33
v_cvt_pk_bf16_f32 v31, v34, v35
v_mfma_f32_16x16x32_bf16 v[40:43], v[144:147], v[168:171], v[40:43]
s_mul_i32 s54, s77, 384
v_mfma_f32_16x16x32_bf16 v[40:43], v[156:159], v[180:183], v[40:43]
v_cvt_pk_bf16_f32 v36, v36, v37
v_cvt_pk_bf16_f32 v37, v38, v39
v_mfma_f32_16x16x32_bf16 v[44:47], v[156:159], v[100:103], v[44:47]
v_permlane16_swap_b32 v28, v30
v_permlane16_swap_b32 v29, v31
v_mfma_f32_16x16x32_bf16 v[44:47], v[144:147], v[112:115], v[44:47]
buffer_store_dwordx4 v[28:31], v7, s[40:43], s54 offen sc1
buffer_store_dwordx2 v[36:37], v2, s[40:43], s54 offen offset:1024 sc1
L_r1:
v_mfma_f32_16x16x32_bf16 v[44:47], v[204:207], v[116:119], v[44:47]
v_mfma_f32_16x16x32_bf16 v[44:47], v[200:203], v[104:107], v[44:47]
v_mfma_f32_16x16x32_bf16 v[48:51], v[200:203], v[108:111], v[48:51]
v_mfma_f32_16x16x32_bf16 v[48:51], v[204:207], v[120:123], v[48:51]
v_mfma_f32_16x16x32_bf16 v[48:51], v[144:147], v[128:131], v[48:51]
v_mfma_f32_16x16x32_bf16 v[48:51], v[156:159], v[132:135], v[48:51]
v_mfma_f32_16x16x32_bf16 v[52:55], v[208:211], v[176:179], v[52:55]
v_cvt_pk_bf16_f32 v40, v40, v41
v_cvt_pk_bf16_f32 v41, v42, v43
v_mfma_f32_16x16x32_bf16 v[52:55], v[212:215], v[164:167], v[52:55]
v_cvt_pk_bf16_f32 v42, v44, v45
v_cvt_pk_bf16_f32 v43, v46, v47
v_mfma_f32_16x16x32_bf16 v[52:55], v[160:163], v[168:171], v[52:55]
s_mul_i32 s54, s78, 384
v_mfma_f32_16x16x32_bf16 v[52:55], v[172:175], v[180:183], v[52:55]
v_cvt_pk_bf16_f32 v48, v48, v49
v_cvt_pk_bf16_f32 v49, v50, v51
v_mfma_f32_16x16x32_bf16 v[56:59], v[172:175], v[100:103], v[56:59]
v_permlane16_swap_b32 v40, v42
v_permlane16_swap_b32 v41, v43
v_mfma_f32_16x16x32_bf16 v[56:59], v[160:163], v[112:115], v[56:59]
buffer_store_dwordx4 v[40:43], v7, s[40:43], s54 offen sc1
buffer_store_dwordx2 v[48:49], v2, s[40:43], s54 offen offset:1024 sc1
L_r2:
v_mfma_f32_16x16x32_bf16 v[56:59], v[212:215], v[116:119], v[56:59]
s_barrier
v_mfma_f32_16x16x32_bf16 v[56:59], v[208:211], v[104:107], v[56:59]
ds_read_b64_tr_b16 v[240:241], v6 offset:16384
ds_read_b64_tr_b16 v[242:243], v6 offset:18432
v_mfma_f32_16x16x32_bf16 v[60:63], v[208:211], v[108:111], v[60:63]
ds_read_b64_tr_b16 v[252:253], v6 offset:45056
ds_read_b64_tr_b16 v[254:255], v6 offset:47104
v_mfma_f32_16x16x32_bf16 v[60:63], v[212:215], v[120:123], v[60:63]
ds_read_b64_tr_b16 v[124:125], v6 offset:20480
ds_read_b64_tr_b16 v[126:127], v6 offset:22528
v_mfma_f32_16x16x32_bf16 v[60:63], v[160:163], v[128:131], v[60:63]
ds_read_b64_tr_b16 v[244:245], v6 offset:49152
ds_read_b64_tr_b16 v[246:247], v6 offset:51200
v_mfma_f32_16x16x32_bf16 v[60:63], v[172:175], v[132:135], v[60:63]
ds_read_b64_tr_b16 v[248:249], v6 offset:24576
ds_read_b64_tr_b16 v[250:251], v6 offset:26624
v_mfma_f32_16x16x32_bf16 v[64:67], v[216:219], v[176:179], v[64:67]
ds_read_b64_tr_b16 v[12:13], v6 offset:53248
ds_read_b64_tr_b16 v[14:15], v6 offset:55296
v_mfma_f32_16x16x32_bf16 v[64:67], v[220:223], v[164:167], v[64:67]
v_cvt_pk_bf16_f32 v52, v52, v53
v_cvt_pk_bf16_f32 v53, v54, v55
s_waitcnt lgkmcnt(10)
v_mfma_f32_16x16x32_bf16 v[64:67], v[240:243], v[168:171], v[64:67]
v_cvt_pk_bf16_f32 v54, v56, v57
v_cvt_pk_bf16_f32 v55, v58, v59
s_waitcnt lgkmcnt(8)
v_mfma_f32_16x16x32_bf16 v[64:67], v[252:255], v[180:183], v[64:67]
s_mul_i32 s54, s79, 384
v_mfma_f32_16x16x32_bf16 v[68:71], v[252:255], v[100:103], v[68:71]
v_cvt_pk_bf16_f32 v60, v60, v61
v_cvt_pk_bf16_f32 v61, v62, v63
v_mfma_f32_16x16x32_bf16 v[68:71], v[240:243], v[112:115], v[68:71]
v_permlane16_swap_b32 v52, v54
v_permlane16_swap_b32 v53, v55
v_mfma_f32_16x16x32_bf16 v[68:71], v[220:223], v[116:119], v[68:71]
buffer_store_dwordx4 v[52:55], v7, s[40:43], s54 offen sc1
buffer_store_dwordx2 v[60:61], v2, s[40:43], s54 offen offset:1024 sc1
L_r3:
v_mfma_f32_16x16x32_bf16 v[68:71], v[216:219], v[104:107], v[68:71]
v_mfma_f32_16x16x32_bf16 v[72:75], v[216:219], v[108:111], v[72:75]
v_mfma_f32_16x16x32_bf16 v[72:75], v[220:223], v[120:123], v[72:75]
v_mfma_f32_16x16x32_bf16 v[72:75], v[240:243], v[128:131], v[72:75]
v_mfma_f32_16x16x32_bf16 v[72:75], v[252:255], v[132:135], v[72:75]
v_mfma_f32_16x16x32_bf16 v[76:79], v[224:227], v[176:179], v[76:79]
v_cvt_pk_bf16_f32 v64, v64, v65
v_cvt_pk_bf16_f32 v65, v66, v67
v_mfma_f32_16x16x32_bf16 v[76:79], v[228:231], v[164:167], v[76:79]
v_cvt_pk_bf16_f32 v66, v68, v69
v_cvt_pk_bf16_f32 v67, v70, v71
s_waitcnt lgkmcnt(6)
v_mfma_f32_16x16x32_bf16 v[76:79], v[124:127], v[168:171], v[76:79]
s_mul_i32 s54, s80, 384
s_waitcnt lgkmcnt(4)
v_mfma_f32_16x16x32_bf16 v[76:79], v[244:247], v[180:183], v[76:79]
v_cvt_pk_bf16_f32 v72, v72, v73
v_cvt_pk_bf16_f32 v73, v74, v75
v_mfma_f32_16x16x32_bf16 v[80:83], v[244:247], v[100:103], v[80:83]
v_permlane16_swap_b32 v64, v66
v_permlane16_swap_b32 v65, v67
v_mfma_f32_16x16x32_bf16 v[80:83], v[124:127], v[112:115], v[80:83]
buffer_store_dwordx4 v[64:67], v7, s[40:43], s54 offen sc1
buffer_store_dwordx2 v[72:73], v2, s[40:43], s54 offen offset:1024 sc1
L_r4:
v_mfma_f32_16x16x32_bf16 v[80:83], v[228:231], v[116:119], v[80:83]
v_mfma_f32_16x16x32_bf16 v[80:83], v[224:227], v[104:107], v[80:83]
v_mfma_f32_16x16x32_bf16 v[84:87], v[224:227], v[108:111], v[84:87]
v_mfma_f32_16x16x32_bf16 v[84:87], v[228:231], v[120:123], v[84:87]
v_mfma_f32_16x16x32_bf16 v[84:87], v[124:127], v[128:131], v[84:87]
v_mfma_f32_16x16x32_bf16 v[84:87], v[244:247], v[132:135], v[84:87]
v_mfma_f32_16x16x32_bf16 v[88:91], v[232:235], v[176:179], v[88:91]
v_cvt_pk_bf16_f32 v76, v76, v77
v_cvt_pk_bf16_f32 v77, v78, v79
v_mfma_f32_16x16x32_bf16 v[88:91], v[236:239], v[164:167], v[88:91]
v_cvt_pk_bf16_f32 v78, v80, v81
v_cvt_pk_bf16_f32 v79, v82, v83
s_waitcnt lgkmcnt(2)
v_mfma_f32_16x16x32_bf16 v[88:91], v[248:251], v[168:171], v[88:91]
s_mul_i32 s54, s81, 384
s_waitcnt lgkmcnt(0)
v_mfma_f32_16x16x32_bf16 v[88:91], v[12:15], v[180:183], v[88:91]
v_cvt_pk_bf16_f32 v84, v84, v85
v_cvt_pk_bf16_f32 v85, v86, v87
v_mfma_f32_16x16x32_bf16 v[92:95], v[12:15], v[100:103], v[92:95]
v_permlane16_swap_b32 v76, v78
v_permlane16_swap_b32 v77, v79
v_mfma_f32_16x16x32_bf16 v[92:95], v[248:251], v[112:115], v[92:95]
buffer_store_dwordx4 v[76:79], v7, s[40:43], s54 offen sc1
buffer_store_dwordx2 v[84:85], v2, s[40:43], s54 offen offset:1024 sc1
L_r5:
v_mfma_f32_16x16x32_bf16 v[92:95], v[236:239], v[116:119], v[92:95]
v_mfma_f32_16x16x32_bf16 v[92:95], v[232:235], v[104:107], v[92:95]
v_mfma_f32_16x16x32_bf16 v[96:99], v[232:235], v[108:111], v[96:99]
v_mfma_f32_16x16x32_bf16 v[96:99], v[236:239], v[120:123], v[96:99]
v_mfma_f32_16x16x32_bf16 v[96:99], v[248:251], v[128:131], v[96:99]
v_mfma_f32_16x16x32_bf16 v[96:99], v[12:15], v[132:135], v[96:99]
v_cvt_pk_bf16_f32 v88, v88, v89
v_cvt_pk_bf16_f32 v89, v90, v91
s_nop 1
v_cvt_pk_bf16_f32 v90, v92, v93
v_cvt_pk_bf16_f32 v91, v94, v95
s_mul_i32 s54, s82, 384
s_nop 0
v_cvt_pk_bf16_f32 v96, v96, v97
v_cvt_pk_bf16_f32 v97, v98, v99
v_permlane16_swap_b32 v88, v90
v_permlane16_swap_b32 v89, v91
s_cmp_lg_u32 s56, 7
s_cbranch_scc1 L_p6
buffer_store_dwordx4 v[88:91], v7, s[40:43], s54 offen sc1
buffer_store_dwordx2 v[96:97], v2, s[40:43], s54 offen offset:1024 sc1
L_r6:
s_waitcnt vmcnt(0) lgkmcnt(0)
s_barrier
s_sub_u32 s56, s3, s55
s_and_b32 s56, s56, 7
s_and_b32 s64, s52, 3
s_lshl_b32 s64, s64, 2
s_add_u32 s64, s64, 32
v_lshrrev_b32 v131, 4, v1
v_add_u32 v131, s64, v131
v_and_b32 v129, 15, v1
v_lshlrev_b32 v129, 3, v129
v_mul_u32_u24 v130, 896, v131
s_lshl_b32 s60, s56, 7
v_add3_u32 v130, v130, v129, s60
v_lshrrev_b32 v132, 5, v129
v_mul_u32_u24 v132, 1504, v132
v_lshl_add_u32 v132, v131, 5, v132
v_add_u32 v132, v132, v129
s_mul_i32 s60, s56, 49152
v_add_u32 v128, s60, v132
v_add_u32 v132, 155648, v132
s_lshl_b32 s60, s3, 7
v_and_b32 v129, 7, v1
v_lshl_add_u32 v129, v129, 2, s60
s_mul_i32 s65, s55, 43008
s_add_u32 s44, s14, s65
s_addc_u32 s45, s15, 0
s_and_b32 s45, s45, 0xffff
s_mov_b32 s46, 43008
s_mov_b32 s47, 0x20000
s_cmp_eq_u32 s56, 7
s_cbranch_scc1 L_finP
s_lshl_b32 s65, 1, s3
s_cmp_lg_u32 s3, 0
s_cbranch_scc1 L_oP0
ds_read_b64 v[136:137], v132
L_oP0:
s_cmp_lg_u32 s3, 1
s_cbranch_scc1 L_oP1
ds_read_b64 v[138:139], v132
L_oP1:
s_cmp_lg_u32 s3, 2
s_cbranch_scc1 L_oP2
ds_read_b64 v[140:141], v132
L_oP2:
s_cmp_lg_u32 s3, 3
s_cbranch_scc1 L_oP3
ds_read_b64 v[142:143], v132
L_oP3:
s_cmp_lg_u32 s3, 4
s_cbranch_scc1 L_oP4
ds_read_b64 v[144:145], v132
L_oP4:
s_cmp_lg_u32 s3, 5
s_cbranch_scc1 L_oP5
ds_read_b64 v[146:147], v132
L_oP5:
s_cmp_lg_u32 s3, 6
s_cbranch_scc1 L_oP6
ds_read_b64 v[148:149], v132
L_oP6:
s_cmp_lg_u32 s3, 7
s_cbranch_scc1 L_oP7
ds_read_b64 v[150:151], v132
L_oP7:
L_pollP:
s_sleep 1
buffer_load_dword v131, v129, s[48:51], 0 offen sc1
s_sub_u32 s57, s57, 1
s_cbranch_scc1 L_end
L_chkP:
s_waitcnt vmcnt(0)
v_cmp_eq_u32 vcc, 2, v131
s_nop 0
s_andn2_b32 s60, vcc_lo, s65
s_and_b32 s60, s60, 0xff
s_cbranch_scc0 L_pollP
s_bitcmp1_b32 s60, 0
s_cbranch_scc0 L_lP0
s_mov_b32 s54, 0
buffer_load_dwordx2 v[136:137], v128, s[40:43], s54 offen sc1
L_lP0:
s_bitcmp1_b32 s60, 1
s_cbranch_scc0 L_lP1
s_mov_b32 s54, 6144
buffer_load_dwordx2 v[138:139], v128, s[40:43], s54 offen sc1
L_lP1:
s_bitcmp1_b32 s60, 2
s_cbranch_scc0 L_lP2
s_mov_b32 s54, 12288
buffer_load_dwordx2 v[140:141], v128, s[40:43], s54 offen sc1
L_lP2:
s_bitcmp1_b32 s60, 3
s_cbranch_scc0 L_lP3
s_mov_b32 s54, 18432
buffer_load_dwordx2 v[142:143], v128, s[40:43], s54 offen sc1
L_lP3:
s_bitcmp1_b32 s60, 4
s_cbranch_scc0 L_lP4
s_mov_b32 s54, 24576
buffer_load_dwordx2 v[144:145], v128, s[40:43], s54 offen sc1
L_lP4:
s_bitcmp1_b32 s60, 5
s_cbranch_scc0 L_lP5
s_mov_b32 s54, 30720
buffer_load_dwordx2 v[146:147], v128, s[40:43], s54 offen sc1
L_lP5:
s_bitcmp1_b32 s60, 6
s_cbranch_scc0 L_lP6
s_mov_b32 s54, 36864
buffer_load_dwordx2 v[148:149], v128, s[40:43], s54 offen sc1
L_lP6:
s_bitcmp1_b32 s60, 7
s_cbranch_scc0 L_lP7
s_mov_b32 s54, 43008
buffer_load_dwordx2 v[150:151], v128, s[40:43], s54 offen sc1
L_lP7:
s_or_b32 s65, s65, s60
s_cmp_lg_u32 s65, 0xff
s_cbranch_scc1 L_pollP
s_waitcnt vmcnt(0) lgkmcnt(0)
v_lshlrev_b32 v152, 16, v136
v_and_b32 v153, 0xffff0000, v136
v_lshlrev_b32 v154, 16, v137
v_and_b32 v155, 0xffff0000, v137
v_lshlrev_b32 v156, 16, v138
v_and_b32 v157, 0xffff0000, v138
v_pk_add_f32 v[152:153], v[152:153], v[156:157]
v_lshlrev_b32 v156, 16, v139
v_and_b32 v157, 0xffff0000, v139
v_pk_add_f32 v[154:155], v[154:155], v[156:157]
v_lshlrev_b32 v156, 16, v140
v_and_b32 v157, 0xffff0000, v140
v_pk_add_f32 v[152:153], v[152:153], v[156:157]
v_lshlrev_b32 v156, 16, v141
v_and_b32 v157, 0xffff0000, v141
v_pk_add_f32 v[154:155], v[154:155], v[156:157]
v_lshlrev_b32 v156, 16, v142
v_and_b32 v157, 0xffff0000, v142
v_pk_add_f32 v[152:153], v[152:153], v[156:157]
v_lshlrev_b32 v156, 16, v143
v_and_b32 v157, 0xffff0000, v143
v_pk_add_f32 v[154:155], v[154:155], v[156:157]
v_lshlrev_b32 v156, 16, v144
v_and_b32 v157, 0xffff0000, v144
v_pk_add_f32 v[152:153], v[152:153], v[156:157]
v_lshlrev_b32 v156, 16, v145
v_and_b32 v157, 0xffff0000, v145
v_pk_add_f32 v[154:155], v[154:155], v[156:157]
v_lshlrev_b32 v156, 16, v146
v_and_b32 v157, 0xffff0000, v146
v_pk_add_f32 v[152:153], v[152:153], v[156:157]
v_lshlrev_b32 v156, 16, v147
v_and_b32 v157, 0xffff0000, v147
v_pk_add_f32 v[154:155], v[154:155], v[156:157]
v_lshlrev_b32 v156, 16, v148
v_and_b32 v157, 0xffff0000, v148
v_pk_add_f32 v[152:153], v[152:153], v[156:157]
v_lshlrev_b32 v156, 16, v149
v_and_b32 v157, 0xffff0000, v149
v_pk_add_f32 v[154:155], v[154:155], v[156:157]
v_lshlrev_b32 v156, 16, v150
v_and_b32 v157, 0xffff0000, v150
v_pk_add_f32 v[152:153], v[152:153], v[156:157]
v_lshlrev_b32 v156, 16, v151
v_and_b32 v157, 0xffff0000, v151
v_pk_add_f32 v[154:155], v[154:155], v[156:157]
v_cvt_pk_bf16_f32 v136, v152, v153
v_cvt_pk_bf16_f32 v137, v154, v155
buffer_store_dwordx2 v[136:137], v130, s[44:47], 0 offen sc1
L_finP:
s_endpgm
L_p6:
ds_write_b128 v3, v[88:91]
ds_write_b64 v5, v[96:97]
s_branch L_r6
.p2align 6
s_nop 0
s_nop 0
L_attn:
v_and_b32 v12, 15, v1
v_lshlrev_b32 v3, 7, v12
v_and_b32 v12, 6, v1
v_lshrrev_b32 v13, 4, v1
v_xor_b32 v12, v12, v13
v_lshl_add_u32 v3, v12, 4, v3
s_and_b32 s60, s52, 1
s_lshl_b32 s60, s60, 14
v_add_u32 v3, s60, v3
v_xor_b32 v4, 64, v3
v_add_u32 v5, 0x10000, v3
v_add_u32 v6, 0x10000, v4
v_lshlrev_b32 v7, 4, v1
v_add_u32 v7, 155648, v7
s_lshr_b32 s56, s52, 1
s_mov_b32 s58, 0x3db8aa3b
s_mov_b32 s59, 0x3db8aa3b
s_mul_i32 s60, s55, 14336
s_lshl_b32 s61, s52, 9
s_add_u32 s60, s60, s61
s_mul_i32 s61, s52, 3072
s_add_u32 s60, s60, s61
s_mul_i32 s61, s3, 458752
s_add_u32 s60, s60, s61
s_add_u32 s4, s12, s60
s_addc_u32 s5, s13, 0
s_waitcnt vmcnt(0)
s_barrier
s_load_dwordx2 s[6:7], s[4:5], 60
s_load_dwordx2 s[6:7], s[4:5], 188
s_load_dwordx2 s[6:7], s[4:5], 316
s_load_dwordx2 s[6:7], s[4:5], 444
s_barrier
s_barrier
s_load_dwordx2 s[6:7], s[4:5], 572
s_load_dwordx2 s[6:7], s[4:5], 700
s_load_dwordx2 s[6:7], s[4:5], 828
s_load_dwordx2 s[6:7], s[4:5], 956
s_barrier
s_mov_b32 s44, s16
s_and_b32 s45, s17, 0xffff
s_mov_b32 s46, 256
s_mov_b32 s47, 0x20000
v_lshlrev_b32 v12, 4, v1
s_lshl_b32 s61, s55, 3
v_mov_b32 v13, s61
v_mov_b32 v14, 1
v_mov_b32 v232, 0
v_mov_b32 v233, 0
v_mov_b32 v234, 0
v_mov_b32 v235, 0
s_sub_u32 s61, s3, s55
s_and_b32 s61, s61, 7
s_lshl_b32 s60, s52, 3
s_or_b32 s60, s60, s61
s_cmp_lg_u32 s60, 7
s_cbranch_scc1 L_ib0
buffer_store_dwordx4 v[232:235], v12, s[48:51], 0 offen sc1
L_ib0:
s_load_dwordx2 s[6:7], s[4:5], 1084
s_load_dwordx2 s[6:7], s[4:5], 1212
s_load_dwordx2 s[6:7], s[4:5], 1340
s_load_dwordx2 s[6:7], s[4:5], 1468
s_barrier
s_barrier
s_cmp_lg_u32 s56, 0
s_cbranch_scc1 L_z1
ds_read_b128 v[208:211], v7 offset:0
ds_read_b128 v[220:223], v7 offset:3072
ds_read_b128 v[224:227], v7 offset:4096
ds_read_b128 v[212:215], v7 offset:1024
ds_read_b128 v[216:219], v7 offset:2048
ds_read_b128 v[228:231], v7 offset:5120
ds_read_b128 v[232:235], v3 offset:0
ds_read_b128 v[236:239], v4 offset:0
ds_read_b128 v[240:243], v3 offset:2048
ds_read_b128 v[244:247], v4 offset:2048
ds_read_b128 v[248:251], v3 offset:4096
ds_read_b128 v[252:255], v4 offset:4096
s_waitcnt lgkmcnt(5)
v_mfma_f32_16x16x32_bf16 v[16:19], v[232:235], v[208:211], 0
s_waitcnt lgkmcnt(4)
v_mfma_f32_16x16x32_bf16 v[16:19], v[236:239], v[220:223], v[16:19]
v_mfma_f32_16x16x32_bf16 v[20:23], v[236:239], v[224:227], 0
v_mfma_f32_16x16x32_bf16 v[20:23], v[232:235], v[212:215], v[20:23]
v_mfma_f32_16x16x32_bf16 v[24:27], v[232:235], v[216:219], 0
ds_read_b128 v[232:235], v3 offset:6144
v_mfma_f32_16x16x32_bf16 v[24:27], v[236:239], v[228:231], v[24:27]
ds_read_b128 v[236:239], v4 offset:6144
s_waitcnt lgkmcnt(5)
v_mfma_f32_16x16x32_bf16 v[28:31], v[240:243], v[208:211], 0
s_waitcnt lgkmcnt(4)
v_mfma_f32_16x16x32_bf16 v[28:31], v[244:247], v[220:223], v[28:31]
v_mfma_f32_16x16x32_bf16 v[32:35], v[244:247], v[224:227], 0
v_mfma_f32_16x16x32_bf16 v[32:35], v[240:243], v[212:215], v[32:35]
v_mfma_f32_16x16x32_bf16 v[36:39], v[240:243], v[216:219], 0
ds_read_b128 v[240:243], v3 offset:8192
v_mfma_f32_16x16x32_bf16 v[36:39], v[244:247], v[228:231], v[36:39]
ds_read_b128 v[244:247], v4 offset:8192
s_waitcnt lgkmcnt(5)
v_mfma_f32_16x16x32_bf16 v[40:43], v[248:251], v[208:211], 0
s_waitcnt lgkmcnt(4)
v_mfma_f32_16x16x32_bf16 v[40:43], v[252:255], v[220:223], v[40:43]
v_mfma_f32_16x16x32_bf16 v[44:47], v[252:255], v[224:227], 0
v_mfma_f32_16x16x32_bf16 v[44:47], v[248:251], v[212:215], v[44:47]
v_mfma_f32_16x16x32_bf16 v[48:51], v[248:251], v[216:219], 0
ds_read_b128 v[248:251], v3 offset:10240
v_mfma_f32_16x16x32_bf16 v[48:51], v[252:255], v[228:231], v[48:51]
ds_read_b128 v[252:255], v4 offset:10240
s_waitcnt lgkmcnt(5)
v_mfma_f32_16x16x32_bf16 v[52:55], v[232:235], v[208:211], 0
s_waitcnt lgkmcnt(4)
v_mfma_f32_16x16x32_bf16 v[52:55], v[236:239], v[220:223], v[52:55]
v_mfma_f32_16x16x32_bf16 v[56:59], v[236:239], v[224:227], 0
v_mfma_f32_16x16x32_bf16 v[56:59], v[232:235], v[212:215], v[56:59]
v_mfma_f32_16x16x32_bf16 v[60:63], v[232:235], v[216:219], 0
ds_read_b128 v[232:235], v3 offset:12288
v_mfma_f32_16x16x32_bf16 v[60:63], v[236:239], v[228:231], v[60:63]
ds_read_b128 v[236:239], v4 offset:12288
s_waitcnt lgkmcnt(5)
v_mfma_f32_16x16x32_bf16 v[64:67], v[240:243], v[208:211], 0
s_waitcnt lgkmcnt(4)
v_mfma_f32_16x16x32_bf16 v[64:67], v[244:247], v[220:223], v[64:67]
v_mfma_f32_16x16x32_bf16 v[68:71], v[244:247], v[224:227], 0
v_mfma_f32_16x16x32_bf16 v[68:71], v[240:243], v[212:215], v[68:71]
v_mfma_f32_16x16x32_bf16 v[72:75], v[240:243], v[216:219], 0
ds_read_b128 v[240:243], v3 offset:14336
v_mfma_f32_16x16x32_bf16 v[72:75], v[244:247], v[228:231], v[72:75]
ds_read_b128 v[244:247], v4 offset:14336
s_waitcnt lgkmcnt(0)
s_barrier
v_mfma_f32_16x16x32_bf16 v[76:79], v[248:251], v[208:211], 0
v_mfma_f32_16x16x32_bf16 v[76:79], v[252:255], v[220:223], v[76:79]
v_mfma_f32_16x16x32_bf16 v[80:83], v[252:255], v[224:227], 0
v_mfma_f32_16x16x32_bf16 v[80:83], v[248:251], v[212:215], v[80:83]
v_mfma_f32_16x16x32_bf16 v[84:87], v[248:251], v[216:219], 0
v_mfma_f32_16x16x32_bf16 v[84:87], v[252:255], v[228:231], v[84:87]
v_mfma_f32_16x16x32_bf16 v[88:91], v[232:235], v[208:211], 0
v_mfma_f32_16x16x32_bf16 v[88:91], v[236:239], v[220:223], v[88:91]
v_mfma_f32_16x16x32_bf16 v[92:95], v[236:239], v[224:227], 0
v_mfma_f32_16x16x32_bf16 v[92:95], v[232:235], v[212:215], v[92:95]
v_mfma_f32_16x16x32_bf16 v[96:99], v[232:235], v[216:219], 0
v_mfma_f32_16x16x32_bf16 v[96:99], v[236:239], v[228:231], v[96:99]
v_mfma_f32_16x16x32_bf16 v[100:103], v[240:243], v[208:211], 0
v_mfma_f32_16x16x32_bf16 v[100:103], v[244:247], v[220:223], v[100:103]
v_mfma_f32_16x16x32_bf16 v[104:107], v[244:247], v[224:227], 0
v_mfma_f32_16x16x32_bf16 v[104:107], v[240:243], v[212:215], v[104:107]
v_mfma_f32_16x16x32_bf16 v[108:111], v[240:243], v[216:219], 0
v_mfma_f32_16x16x32_bf16 v[108:111], v[244:247], v[228:231], v[108:111]
s_branch L_y1
L_z1:
s_barrier
L_y1:
s_load_dwordx2 s[6:7], s[4:5], 1596
s_load_dwordx2 s[6:7], s[4:5], 1724
s_load_dwordx2 s[6:7], s[4:5], 1852
s_load_dwordx2 s[6:7], s[4:5], 1980
s_barrier
s_barrier
s_cmp_lg_u32 s56, 1
s_cbranch_scc1 L_z2
ds_read_b128 v[208:211], v7 offset:0
ds_read_b128 v[220:223], v7 offset:3072
ds_read_b128 v[224:227], v7 offset:4096
ds_read_b128 v[212:215], v7 offset:1024
ds_read_b128 v[216:219], v7 offset:2048
ds_read_b128 v[228:231], v7 offset:5120
ds_read_b128 v[232:235], v3 offset:0
ds_read_b128 v[236:239], v4 offset:0
ds_read_b128 v[240:243], v3 offset:2048
ds_read_b128 v[244:247], v4 offset:2048
ds_read_b128 v[248:251], v3 offset:4096
ds_read_b128 v[252:255], v4 offset:4096
s_waitcnt lgkmcnt(5)
v_mfma_f32_16x16x32_bf16 v[16:19], v[232:235], v[208:211], 0
s_waitcnt lgkmcnt(4)
v_mfma_f32_16x16x32_bf16 v[16:19], v[236:239], v[220:223], v[16:19]
v_mfma_f32_16x16x32_bf16 v[20:23], v[236:239], v[224:227], 0
v_mfma_f32_16x16x32_bf16 v[20:23], v[232:235], v[212:215], v[20:23]
v_mfma_f32_16x16x32_bf16 v[24:27], v[232:235], v[216:219], 0
ds_read_b128 v[232:235], v3 offset:6144
v_mfma_f32_16x16x32_bf16 v[24:27], v[236:239], v[228:231], v[24:27]
ds_read_b128 v[236:239], v4 offset:6144
s_waitcnt lgkmcnt(5)
v_mfma_f32_16x16x32_bf16 v[28:31], v[240:243], v[208:211], 0
s_waitcnt lgkmcnt(4)
v_mfma_f32_16x16x32_bf16 v[28:31], v[244:247], v[220:223], v[28:31]
v_mfma_f32_16x16x32_bf16 v[32:35], v[244:247], v[224:227], 0
v_mfma_f32_16x16x32_bf16 v[32:35], v[240:243], v[212:215], v[32:35]
v_mfma_f32_16x16x32_bf16 v[36:39], v[240:243], v[216:219], 0
ds_read_b128 v[240:243], v3 offset:8192
v_mfma_f32_16x16x32_bf16 v[36:39], v[244:247], v[228:231], v[36:39]
ds_read_b128 v[244:247], v4 offset:8192
s_waitcnt lgkmcnt(5)
v_mfma_f32_16x16x32_bf16 v[40:43], v[248:251], v[208:211], 0
s_waitcnt lgkmcnt(4)
v_mfma_f32_16x16x32_bf16 v[40:43], v[252:255], v[220:223], v[40:43]
v_mfma_f32_16x16x32_bf16 v[44:47], v[252:255], v[224:227], 0
v_mfma_f32_16x16x32_bf16 v[44:47], v[248:251], v[212:215], v[44:47]
v_mfma_f32_16x16x32_bf16 v[48:51], v[248:251], v[216:219], 0
ds_read_b128 v[248:251], v3 offset:10240
v_mfma_f32_16x16x32_bf16 v[48:51], v[252:255], v[228:231], v[48:51]
ds_read_b128 v[252:255], v4 offset:10240
s_waitcnt lgkmcnt(5)
v_mfma_f32_16x16x32_bf16 v[52:55], v[232:235], v[208:211], 0
s_waitcnt lgkmcnt(4)
v_mfma_f32_16x16x32_bf16 v[52:55], v[236:239], v[220:223], v[52:55]
v_mfma_f32_16x16x32_bf16 v[56:59], v[236:239], v[224:227], 0
v_mfma_f32_16x16x32_bf16 v[56:59], v[232:235], v[212:215], v[56:59]
v_mfma_f32_16x16x32_bf16 v[60:63], v[232:235], v[216:219], 0
ds_read_b128 v[232:235], v3 offset:12288
v_mfma_f32_16x16x32_bf16 v[60:63], v[236:239], v[228:231], v[60:63]
ds_read_b128 v[236:239], v4 offset:12288
s_waitcnt lgkmcnt(5)
v_mfma_f32_16x16x32_bf16 v[64:67], v[240:243], v[208:211], 0
s_waitcnt lgkmcnt(4)
v_mfma_f32_16x16x32_bf16 v[64:67], v[244:247], v[220:223], v[64:67]
v_mfma_f32_16x16x32_bf16 v[68:71], v[244:247], v[224:227], 0
v_mfma_f32_16x16x32_bf16 v[68:71], v[240:243], v[212:215], v[68:71]
v_mfma_f32_16x16x32_bf16 v[72:75], v[240:243], v[216:219], 0
ds_read_b128 v[240:243], v3 offset:14336
v_mfma_f32_16x16x32_bf16 v[72:75], v[244:247], v[228:231], v[72:75]
ds_read_b128 v[244:247], v4 offset:14336
s_waitcnt lgkmcnt(0)
s_barrier
v_mfma_f32_16x16x32_bf16 v[76:79], v[248:251], v[208:211], 0
v_mfma_f32_16x16x32_bf16 v[76:79], v[252:255], v[220:223], v[76:79]
v_mfma_f32_16x16x32_bf16 v[80:83], v[252:255], v[224:227], 0
v_mfma_f32_16x16x32_bf16 v[80:83], v[248:251], v[212:215], v[80:83]
v_mfma_f32_16x16x32_bf16 v[84:87], v[248:251], v[216:219], 0
v_mfma_f32_16x16x32_bf16 v[84:87], v[252:255], v[228:231], v[84:87]
v_mfma_f32_16x16x32_bf16 v[88:91], v[232:235], v[208:211], 0
v_mfma_f32_16x16x32_bf16 v[88:91], v[236:239], v[220:223], v[88:91]
v_mfma_f32_16x16x32_bf16 v[92:95], v[236:239], v[224:227], 0
v_mfma_f32_16x16x32_bf16 v[92:95], v[232:235], v[212:215], v[92:95]
v_mfma_f32_16x16x32_bf16 v[96:99], v[232:235], v[216:219], 0
v_mfma_f32_16x16x32_bf16 v[96:99], v[236:239], v[228:231], v[96:99]
v_mfma_f32_16x16x32_bf16 v[100:103], v[240:243], v[208:211], 0
v_mfma_f32_16x16x32_bf16 v[100:103], v[244:247], v[220:223], v[100:103]
v_mfma_f32_16x16x32_bf16 v[104:107], v[244:247], v[224:227], 0
v_mfma_f32_16x16x32_bf16 v[104:107], v[240:243], v[212:215], v[104:107]
v_mfma_f32_16x16x32_bf16 v[108:111], v[240:243], v[216:219], 0
v_mfma_f32_16x16x32_bf16 v[108:111], v[244:247], v[228:231], v[108:111]
s_branch L_y2
L_z2:
s_barrier
L_y2:
s_sub_u32 s61, s3, s55
s_and_b32 s61, s61, 7
s_lshl_b32 s60, s52, 3
s_or_b32 s60, s60, s61
s_cmp_lg_u32 s60, 7
s_cbranch_scc1 L_ib1
s_waitcnt vmcnt(0)
s_mov_b64 exec, 1
buffer_store_dword v14, v13, s[44:47], 0 offen sc1
s_mov_b64 exec, -1
L_ib1:
s_load_dwordx2 s[6:7], s[4:5], 2108
s_load_dwordx2 s[6:7], s[4:5], 2236
s_load_dwordx2 s[6:7], s[4:5], 2364
s_load_dwordx2 s[6:7], s[4:5], 2492
s_barrier
s_barrier
ds_read_b128 v[232:235], v3 offset:32768
ds_read_b128 v[236:239], v4 offset:32768
ds_read_b128 v[240:243], v3 offset:34816
ds_read_b128 v[244:247], v4 offset:34816
ds_read_b128 v[248:251], v3 offset:36864
ds_read_b128 v[252:255], v4 offset:36864
s_waitcnt lgkmcnt(5)
v_mfma_f32_16x16x32_bf16 v[112:115], v[232:235], v[208:211], 0
s_waitcnt lgkmcnt(4)
v_mfma_f32_16x16x32_bf16 v[112:115], v[236:239], v[220:223], v[112:115]
v_mfma_f32_16x16x32_bf16 v[116:119], v[236:239], v[224:227], 0
v_mfma_f32_16x16x32_bf16 v[116:119], v[232:235], v[212:215], v[116:119]
v_mfma_f32_16x16x32_bf16 v[120:123], v[232:235], v[216:219], 0
ds_read_b128 v[232:235], v3 offset:38912
v_mfma_f32_16x16x32_bf16 v[120:123], v[236:239], v[228:231], v[120:123]
ds_read_b128 v[236:239], v4 offset:38912
s_waitcnt lgkmcnt(5)
v_mfma_f32_16x16x32_bf16 v[124:127], v[240:243], v[208:211], 0
s_waitcnt lgkmcnt(4)
v_mfma_f32_16x16x32_bf16 v[124:127], v[244:247], v[220:223], v[124:127]
v_mfma_f32_16x16x32_bf16 v[128:131], v[244:247], v[224:227], 0
v_mfma_f32_16x16x32_bf16 v[128:131], v[240:243], v[212:215], v[128:131]
v_mfma_f32_16x16x32_bf16 v[132:135], v[240:243], v[216:219], 0
ds_read_b128 v[240:243], v3 offset:40960
v_mfma_f32_16x16x32_bf16 v[132:135], v[244:247], v[228:231], v[132:135]
ds_read_b128 v[244:247], v4 offset:40960
s_waitcnt lgkmcnt(5)
v_mfma_f32_16x16x32_bf16 v[136:139], v[248:251], v[208:211], 0
s_waitcnt lgkmcnt(4)
v_mfma_f32_16x16x32_bf16 v[136:139], v[252:255], v[220:223], v[136:139]
v_mfma_f32_16x16x32_bf16 v[140:143], v[252:255], v[224:227], 0
v_mfma_f32_16x16x32_bf16 v[140:143], v[248:251], v[212:215], v[140:143]
v_mfma_f32_16x16x32_bf16 v[144:147], v[248:251], v[216:219], 0
ds_read_b128 v[248:251], v3 offset:43008
v_mfma_f32_16x16x32_bf16 v[144:147], v[252:255], v[228:231], v[144:147]
ds_read_b128 v[252:255], v4 offset:43008
s_waitcnt lgkmcnt(5)
v_mfma_f32_16x16x32_bf16 v[148:151], v[232:235], v[208:211], 0
s_waitcnt lgkmcnt(4)
v_mfma_f32_16x16x32_bf16 v[148:151], v[236:239], v[220:223], v[148:151]
v_mfma_f32_16x16x32_bf16 v[152:155], v[236:239], v[224:227], 0
v_mfma_f32_16x16x32_bf16 v[152:155], v[232:235], v[212:215], v[152:155]
v_mfma_f32_16x16x32_bf16 v[156:159], v[232:235], v[216:219], 0
ds_read_b128 v[232:235], v3 offset:45056
v_mfma_f32_16x16x32_bf16 v[156:159], v[236:239], v[228:231], v[156:159]
ds_read_b128 v[236:239], v4 offset:45056
s_waitcnt lgkmcnt(5)
v_mfma_f32_16x16x32_bf16 v[160:163], v[240:243], v[208:211], 0
s_waitcnt lgkmcnt(4)
v_mfma_f32_16x16x32_bf16 v[160:163], v[244:247], v[220:223], v[160:163]
v_mfma_f32_16x16x32_bf16 v[164:167], v[244:247], v[224:227], 0
v_mfma_f32_16x16x32_bf16 v[164:167], v[240:243], v[212:215], v[164:167]
v_mfma_f32_16x16x32_bf16 v[168:171], v[240:243], v[216:219], 0
ds_read_b128 v[240:243], v3 offset:47104
v_mfma_f32_16x16x32_bf16 v[168:171], v[244:247], v[228:231], v[168:171]
ds_read_b128 v[244:247], v4 offset:47104
s_waitcnt lgkmcnt(5)
v_mfma_f32_16x16x32_bf16 v[172:175], v[248:251], v[208:211], 0
s_waitcnt lgkmcnt(4)
v_mfma_f32_16x16x32_bf16 v[172:175], v[252:255], v[220:223], v[172:175]
v_mfma_f32_16x16x32_bf16 v[176:179], v[252:255], v[224:227], 0
v_mfma_f32_16x16x32_bf16 v[176:179], v[248:251], v[212:215], v[176:179]
v_mfma_f32_16x16x32_bf16 v[180:183], v[248:251], v[216:219], 0
v_mfma_f32_16x16x32_bf16 v[180:183], v[252:255], v[228:231], v[180:183]
s_waitcnt lgkmcnt(3)
v_mfma_f32_16x16x32_bf16 v[184:187], v[232:235], v[208:211], 0
s_waitcnt lgkmcnt(2)
v_mfma_f32_16x16x32_bf16 v[184:187], v[236:239], v[220:223], v[184:187]
v_mfma_f32_16x16x32_bf16 v[188:191], v[236:239], v[224:227], 0
v_mfma_f32_16x16x32_bf16 v[188:191], v[232:235], v[212:215], v[188:191]
v_mfma_f32_16x16x32_bf16 v[192:195], v[232:235], v[216:219], 0
v_mfma_f32_16x16x32_bf16 v[192:195], v[236:239], v[228:231], v[192:195]
s_waitcnt lgkmcnt(1)
v_mfma_f32_16x16x32_bf16 v[196:199], v[240:243], v[208:211], 0
s_waitcnt lgkmcnt(0)
v_mfma_f32_16x16x32_bf16 v[196:199], v[244:247], v[220:223], v[196:199]
v_mfma_f32_16x16x32_bf16 v[200:203], v[244:247], v[224:227], 0
v_mfma_f32_16x16x32_bf16 v[200:203], v[240:243], v[212:215], v[200:203]
v_mfma_f32_16x16x32_bf16 v[204:207], v[240:243], v[216:219], 0
v_mfma_f32_16x16x32_bf16 v[204:207], v[244:247], v[228:231], v[204:207]
s_barrier
s_cmp_lg_u32 s56, 0
s_cbranch_scc1 L_q2
ds_read_b128 v[208:211], v7 offset:0
ds_read_b128 v[220:223], v7 offset:3072
ds_read_b128 v[224:227], v7 offset:4096
ds_read_b128 v[212:215], v7 offset:1024
ds_read_b128 v[216:219], v7 offset:2048
ds_read_b128 v[228:231], v7 offset:5120
L_q2:
s_waitcnt lgkmcnt(0)
s_load_dwordx2 s[6:7], s[4:5], 2620
s_load_dwordx2 s[6:7], s[4:5], 2748
s_load_dwordx2 s[6:7], s[4:5], 2876
s_load_dwordx2 s[6:7], s[4:5], 3004
s_barrier
s_barrier
s_cmp_lg_u32 s56, 1
s_cbranch_scc1 L_q3
ds_read_b128 v[208:211], v7 offset:0
ds_read_b128 v[220:223], v7 offset:3072
ds_read_b128 v[224:227], v7 offset:4096
ds_read_b128 v[212:215], v7 offset:1024
ds_read_b128 v[216:219], v7 offset:2048
ds_read_b128 v[228:231], v7 offset:5120
L_q3:
ds_read_b128 v[232:235], v5 offset:0
ds_read_b128 v[236:239], v6 offset:0
ds_read_b128 v[240:243], v5 offset:2048
ds_read_b128 v[244:247], v6 offset:2048
ds_read_b128 v[248:251], v5 offset:4096
ds_read_b128 v[252:255], v6 offset:4096
s_waitcnt lgkmcnt(5)
v_mfma_f32_16x16x32_bf16 v[16:19], v[232:235], v[208:211], v[16:19]
s_waitcnt lgkmcnt(4)
v_mfma_f32_16x16x32_bf16 v[16:19], v[236:239], v[220:223], v[16:19]
v_mfma_f32_16x16x32_bf16 v[20:23], v[236:239], v[224:227], v[20:23]
v_mfma_f32_16x16x32_bf16 v[20:23], v[232:235], v[212:215], v[20:23]
v_mfma_f32_16x16x32_bf16 v[24:27], v[232:235], v[216:219], v[24:27]
ds_read_b128 v[232:235], v5 offset:6144
v_mfma_f32_16x16x32_bf16 v[24:27], v[236:239], v[228:231], v[24:27]
ds_read_b128 v[236:239], v6 offset:6144
s_waitcnt lgkmcnt(5)
v_mfma_f32_16x16x32_bf16 v[28:31], v[240:243], v[208:211], v[28:31]
s_waitcnt lgkmcnt(4)
v_mfma_f32_16x16x32_bf16 v[28:31], v[244:247], v[220:223], v[28:31]
v_mfma_f32_16x16x32_bf16 v[32:35], v[244:247], v[224:227], v[32:35]
v_mfma_f32_16x16x32_bf16 v[32:35], v[240:243], v[212:215], v[32:35]
v_mfma_f32_16x16x32_bf16 v[36:39], v[240:243], v[216:219], v[36:39]
ds_read_b128 v[240:243], v5 offset:8192
v_mfma_f32_16x16x32_bf16 v[36:39], v[244:247], v[228:231], v[36:39]
ds_read_b128 v[244:247], v6 offset:8192
s_waitcnt lgkmcnt(5)
v_mfma_f32_16x16x32_bf16 v[40:43], v[248:251], v[208:211], v[40:43]
s_waitcnt lgkmcnt(4)
v_mfma_f32_16x16x32_bf16 v[40:43], v[252:255], v[220:223], v[40:43]
v_mfma_f32_16x16x32_bf16 v[44:47], v[252:255], v[224:227], v[44:47]
v_mfma_f32_16x16x32_bf16 v[44:47], v[248:251], v[212:215], v[44:47]
v_mfma_f32_16x16x32_bf16 v[48:51], v[248:251], v[216:219], v[48:51]
ds_read_b128 v[248:251], v5 offset:10240
v_mfma_f32_16x16x32_bf16 v[48:51], v[252:255], v[228:231], v[48:51]
ds_read_b128 v[252:255], v6 offset:10240
s_waitcnt lgkmcnt(5)
v_mfma_f32_16x16x32_bf16 v[52:55], v[232:235], v[208:211], v[52:55]
s_waitcnt lgkmcnt(4)
v_mfma_f32_16x16x32_bf16 v[52:55], v[236:239], v[220:223], v[52:55]
v_mfma_f32_16x16x32_bf16 v[56:59], v[236:239], v[224:227], v[56:59]
v_mfma_f32_16x16x32_bf16 v[56:59], v[232:235], v[212:215], v[56:59]
v_mfma_f32_16x16x32_bf16 v[60:63], v[232:235], v[216:219], v[60:63]
ds_read_b128 v[232:235], v5 offset:12288
v_mfma_f32_16x16x32_bf16 v[60:63], v[236:239], v[228:231], v[60:63]
ds_read_b128 v[236:239], v6 offset:12288
s_waitcnt lgkmcnt(5)
v_mfma_f32_16x16x32_bf16 v[64:67], v[240:243], v[208:211], v[64:67]
s_waitcnt lgkmcnt(4)
v_mfma_f32_16x16x32_bf16 v[64:67], v[244:247], v[220:223], v[64:67]
v_mfma_f32_16x16x32_bf16 v[68:71], v[244:247], v[224:227], v[68:71]
v_mfma_f32_16x16x32_bf16 v[68:71], v[240:243], v[212:215], v[68:71]
v_mfma_f32_16x16x32_bf16 v[72:75], v[240:243], v[216:219], v[72:75]
ds_read_b128 v[240:243], v5 offset:14336
v_mfma_f32_16x16x32_bf16 v[72:75], v[244:247], v[228:231], v[72:75]
ds_read_b128 v[244:247], v6 offset:14336
s_waitcnt lgkmcnt(0)
s_barrier
v_mfma_f32_16x16x32_bf16 v[76:79], v[248:251], v[208:211], v[76:79]
v_mfma_f32_16x16x32_bf16 v[76:79], v[252:255], v[220:223], v[76:79]
v_mfma_f32_16x16x32_bf16 v[80:83], v[252:255], v[224:227], v[80:83]
v_mfma_f32_16x16x32_bf16 v[80:83], v[248:251], v[212:215], v[80:83]
v_mfma_f32_16x16x32_bf16 v[84:87], v[248:251], v[216:219], v[84:87]
v_mfma_f32_16x16x32_bf16 v[84:87], v[252:255], v[228:231], v[84:87]
v_mfma_f32_16x16x32_bf16 v[88:91], v[232:235], v[208:211], v[88:91]
v_mfma_f32_16x16x32_bf16 v[88:91], v[236:239], v[220:223], v[88:91]
v_mfma_f32_16x16x32_bf16 v[92:95], v[236:239], v[224:227], v[92:95]
v_mfma_f32_16x16x32_bf16 v[92:95], v[232:235], v[212:215], v[92:95]
v_mfma_f32_16x16x32_bf16 v[96:99], v[232:235], v[216:219], v[96:99]
v_mfma_f32_16x16x32_bf16 v[96:99], v[236:239], v[228:231], v[96:99]
v_mfma_f32_16x16x32_bf16 v[100:103], v[240:243], v[208:211], v[100:103]
v_mfma_f32_16x16x32_bf16 v[100:103], v[244:247], v[220:223], v[100:103]
v_mfma_f32_16x16x32_bf16 v[104:107], v[244:247], v[224:227], v[104:107]
v_mfma_f32_16x16x32_bf16 v[104:107], v[240:243], v[212:215], v[104:107]
v_mfma_f32_16x16x32_bf16 v[108:111], v[240:243], v[216:219], v[108:111]
v_mfma_f32_16x16x32_bf16 v[108:111], v[244:247], v[228:231], v[108:111]
s_load_dwordx2 s[6:7], s[4:5], 3132
s_load_dwordx2 s[6:7], s[4:5], 3260
s_load_dwordx2 s[6:7], s[4:5], 3388
s_load_dwordx2 s[6:7], s[4:5], 3516
s_barrier
s_barrier
ds_read_b128 v[232:235], v3 offset:0
ds_read_b128 v[236:239], v4 offset:0
ds_read_b128 v[240:243], v3 offset:2048
ds_read_b128 v[244:247], v4 offset:2048
ds_read_b128 v[248:251], v3 offset:4096
ds_read_b128 v[252:255], v4 offset:4096
s_waitcnt lgkmcnt(5)
v_mfma_f32_16x16x32_bf16 v[112:115], v[232:235], v[208:211], v[112:115]
s_waitcnt lgkmcnt(4)
v_mfma_f32_16x16x32_bf16 v[112:115], v[236:239], v[220:223], v[112:115]
v_mfma_f32_16x16x32_bf16 v[116:119], v[236:239], v[224:227], v[116:119]
v_mfma_f32_16x16x32_bf16 v[116:119], v[232:235], v[212:215], v[116:119]
v_mfma_f32_16x16x32_bf16 v[120:123], v[232:235], v[216:219], v[120:123]
ds_read_b128 v[232:235], v3 offset:6144
v_mfma_f32_16x16x32_bf16 v[120:123], v[236:239], v[228:231], v[120:123]
ds_read_b128 v[236:239], v4 offset:6144
s_waitcnt lgkmcnt(5)
v_mfma_f32_16x16x32_bf16 v[124:127], v[240:243], v[208:211], v[124:127]
s_waitcnt lgkmcnt(4)
v_mfma_f32_16x16x32_bf16 v[124:127], v[244:247], v[220:223], v[124:127]
v_mfma_f32_16x16x32_bf16 v[128:131], v[244:247], v[224:227], v[128:131]
v_mfma_f32_16x16x32_bf16 v[128:131], v[240:243], v[212:215], v[128:131]
v_mfma_f32_16x16x32_bf16 v[132:135], v[240:243], v[216:219], v[132:135]
ds_read_b128 v[240:243], v3 offset:8192
v_mfma_f32_16x16x32_bf16 v[132:135], v[244:247], v[228:231], v[132:135]
ds_read_b128 v[244:247], v4 offset:8192
s_waitcnt lgkmcnt(5)
v_mfma_f32_16x16x32_bf16 v[136:139], v[248:251], v[208:211], v[136:139]
s_waitcnt lgkmcnt(4)
v_mfma_f32_16x16x32_bf16 v[136:139], v[252:255], v[220:223], v[136:139]
v_mfma_f32_16x16x32_bf16 v[140:143], v[252:255], v[224:227], v[140:143]
v_mfma_f32_16x16x32_bf16 v[140:143], v[248:251], v[212:215], v[140:143]
v_mfma_f32_16x16x32_bf16 v[144:147], v[248:251], v[216:219], v[144:147]
ds_read_b128 v[248:251], v3 offset:10240
v_mfma_f32_16x16x32_bf16 v[144:147], v[252:255], v[228:231], v[144:147]
ds_read_b128 v[252:255], v4 offset:10240
s_waitcnt lgkmcnt(5)
v_mfma_f32_16x16x32_bf16 v[148:151], v[232:235], v[208:211], v[148:151]
s_waitcnt lgkmcnt(4)
v_mfma_f32_16x16x32_bf16 v[148:151], v[236:239], v[220:223], v[148:151]
v_mfma_f32_16x16x32_bf16 v[152:155], v[236:239], v[224:227], v[152:155]
v_mfma_f32_16x16x32_bf16 v[152:155], v[232:235], v[212:215], v[152:155]
v_mfma_f32_16x16x32_bf16 v[156:159], v[232:235], v[216:219], v[156:159]
ds_read_b128 v[232:235], v3 offset:12288
v_mfma_f32_16x16x32_bf16 v[156:159], v[236:239], v[228:231], v[156:159]
ds_read_b128 v[236:239], v4 offset:12288
s_waitcnt lgkmcnt(5)
v_mfma_f32_16x16x32_bf16 v[160:163], v[240:243], v[208:211], v[160:163]
s_waitcnt lgkmcnt(4)
v_mfma_f32_16x16x32_bf16 v[160:163], v[244:247], v[220:223], v[160:163]
v_mfma_f32_16x16x32_bf16 v[164:167], v[244:247], v[224:227], v[164:167]
v_mfma_f32_16x16x32_bf16 v[164:167], v[240:243], v[212:215], v[164:167]
v_mfma_f32_16x16x32_bf16 v[168:171], v[240:243], v[216:219], v[168:171]
ds_read_b128 v[240:243], v3 offset:14336
v_mfma_f32_16x16x32_bf16 v[168:171], v[244:247], v[228:231], v[168:171]
ds_read_b128 v[244:247], v4 offset:14336
s_waitcnt lgkmcnt(0)
s_barrier
v_mfma_f32_16x16x32_bf16 v[172:175], v[248:251], v[208:211], v[172:175]
v_mfma_f32_16x16x32_bf16 v[172:175], v[252:255], v[220:223], v[172:175]
v_mfma_f32_16x16x32_bf16 v[176:179], v[252:255], v[224:227], v[176:179]
v_mfma_f32_16x16x32_bf16 v[176:179], v[248:251], v[212:215], v[176:179]
v_mfma_f32_16x16x32_bf16 v[180:183], v[248:251], v[216:219], v[180:183]
v_mfma_f32_16x16x32_bf16 v[180:183], v[252:255], v[228:231], v[180:183]
v_mfma_f32_16x16x32_bf16 v[184:187], v[232:235], v[208:211], v[184:187]
v_mfma_f32_16x16x32_bf16 v[184:187], v[236:239], v[220:223], v[184:187]
v_mfma_f32_16x16x32_bf16 v[188:191], v[236:239], v[224:227], v[188:191]
v_mfma_f32_16x16x32_bf16 v[188:191], v[232:235], v[212:215], v[188:191]
v_mfma_f32_16x16x32_bf16 v[192:195], v[232:235], v[216:219], v[192:195]
v_mfma_f32_16x16x32_bf16 v[192:195], v[236:239], v[228:231], v[192:195]
v_mfma_f32_16x16x32_bf16 v[196:199], v[240:243], v[208:211], v[196:199]
v_mfma_f32_16x16x32_bf16 v[196:199], v[244:247], v[220:223], v[196:199]
v_mfma_f32_16x16x32_bf16 v[200:203], v[244:247], v[224:227], v[200:203]
v_mfma_f32_16x16x32_bf16 v[200:203], v[240:243], v[212:215], v[200:203]
v_mfma_f32_16x16x32_bf16 v[204:207], v[240:243], v[216:219], v[204:207]
v_mfma_f32_16x16x32_bf16 v[204:207], v[244:247], v[228:231], v[204:207]
s_cmp_lg_u32 s56, 0
s_cbranch_scc1 L_q4
ds_read_b128 v[208:211], v7 offset:0
ds_read_b128 v[220:223], v7 offset:3072
ds_read_b128 v[224:227], v7 offset:4096
ds_read_b128 v[212:215], v7 offset:1024
ds_read_b128 v[216:219], v7 offset:2048
ds_read_b128 v[228:231], v7 offset:5120
L_q4:
s_waitcnt lgkmcnt(0)
s_barrier
s_barrier
s_cmp_lg_u32 s56, 1
s_cbranch_scc1 L_q5
ds_read_b128 v[208:211], v7 offset:0
ds_read_b128 v[220:223], v7 offset:3072
ds_read_b128 v[224:227], v7 offset:4096
ds_read_b128 v[212:215], v7 offset:1024
ds_read_b128 v[216:219], v7 offset:2048
ds_read_b128 v[228:231], v7 offset:5120
L_q5:
ds_read_b128 v[232:235], v3 offset:32768
ds_read_b128 v[236:239], v4 offset:32768
ds_read_b128 v[240:243], v3 offset:34816
ds_read_b128 v[244:247], v4 offset:34816
ds_read_b128 v[248:251], v3 offset:36864
ds_read_b128 v[252:255], v4 offset:36864
s_waitcnt lgkmcnt(5)
v_mfma_f32_16x16x32_bf16 v[16:19], v[232:235], v[208:211], v[16:19]
s_waitcnt lgkmcnt(4)
v_mfma_f32_16x16x32_bf16 v[16:19], v[236:239], v[220:223], v[16:19]
v_mfma_f32_16x16x32_bf16 v[20:23], v[236:239], v[224:227], v[20:23]
v_mfma_f32_16x16x32_bf16 v[20:23], v[232:235], v[212:215], v[20:23]
v_mfma_f32_16x16x32_bf16 v[24:27], v[232:235], v[216:219], v[24:27]
ds_read_b128 v[232:235], v3 offset:38912
v_mfma_f32_16x16x32_bf16 v[24:27], v[236:239], v[228:231], v[24:27]
ds_read_b128 v[236:239], v4 offset:38912
s_waitcnt lgkmcnt(5)
v_mfma_f32_16x16x32_bf16 v[28:31], v[240:243], v[208:211], v[28:31]
s_waitcnt lgkmcnt(4)
v_mfma_f32_16x16x32_bf16 v[28:31], v[244:247], v[220:223], v[28:31]
v_mfma_f32_16x16x32_bf16 v[32:35], v[244:247], v[224:227], v[32:35]
v_mfma_f32_16x16x32_bf16 v[32:35], v[240:243], v[212:215], v[32:35]
v_mfma_f32_16x16x32_bf16 v[36:39], v[240:243], v[216:219], v[36:39]
ds_read_b128 v[240:243], v3 offset:40960
v_mfma_f32_16x16x32_bf16 v[36:39], v[244:247], v[228:231], v[36:39]
ds_read_b128 v[244:247], v4 offset:40960
s_waitcnt lgkmcnt(5)
v_mfma_f32_16x16x32_bf16 v[40:43], v[248:251], v[208:211], v[40:43]
s_waitcnt lgkmcnt(4)
v_mfma_f32_16x16x32_bf16 v[40:43], v[252:255], v[220:223], v[40:43]
v_mfma_f32_16x16x32_bf16 v[44:47], v[252:255], v[224:227], v[44:47]
v_mfma_f32_16x16x32_bf16 v[44:47], v[248:251], v[212:215], v[44:47]
v_mfma_f32_16x16x32_bf16 v[48:51], v[248:251], v[216:219], v[48:51]
ds_read_b128 v[248:251], v3 offset:43008
v_mfma_f32_16x16x32_bf16 v[48:51], v[252:255], v[228:231], v[48:51]
ds_read_b128 v[252:255], v4 offset:43008
s_waitcnt lgkmcnt(5)
v_mfma_f32_16x16x32_bf16 v[52:55], v[232:235], v[208:211], v[52:55]
s_waitcnt lgkmcnt(4)
v_mfma_f32_16x16x32_bf16 v[52:55], v[236:239], v[220:223], v[52:55]
v_mfma_f32_16x16x32_bf16 v[56:59], v[236:239], v[224:227], v[56:59]
v_mfma_f32_16x16x32_bf16 v[56:59], v[232:235], v[212:215], v[56:59]
v_mfma_f32_16x16x32_bf16 v[60:63], v[232:235], v[216:219], v[60:63]
ds_read_b128 v[232:235], v3 offset:45056
v_mfma_f32_16x16x32_bf16 v[60:63], v[236:239], v[228:231], v[60:63]
ds_read_b128 v[236:239], v4 offset:45056
s_waitcnt lgkmcnt(5)
v_mfma_f32_16x16x32_bf16 v[64:67], v[240:243], v[208:211], v[64:67]
s_waitcnt lgkmcnt(4)
v_mfma_f32_16x16x32_bf16 v[64:67], v[244:247], v[220:223], v[64:67]
v_mfma_f32_16x16x32_bf16 v[68:71], v[244:247], v[224:227], v[68:71]
v_mfma_f32_16x16x32_bf16 v[68:71], v[240:243], v[212:215], v[68:71]
v_mfma_f32_16x16x32_bf16 v[72:75], v[240:243], v[216:219], v[72:75]
ds_read_b128 v[240:243], v3 offset:47104
v_mfma_f32_16x16x32_bf16 v[72:75], v[244:247], v[228:231], v[72:75]
ds_read_b128 v[244:247], v4 offset:47104
s_waitcnt lgkmcnt(5)
v_mfma_f32_16x16x32_bf16 v[76:79], v[248:251], v[208:211], v[76:79]
s_waitcnt lgkmcnt(4)
v_mfma_f32_16x16x32_bf16 v[76:79], v[252:255], v[220:223], v[76:79]
v_mfma_f32_16x16x32_bf16 v[80:83], v[252:255], v[224:227], v[80:83]
v_mfma_f32_16x16x32_bf16 v[80:83], v[248:251], v[212:215], v[80:83]
v_mfma_f32_16x16x32_bf16 v[84:87], v[248:251], v[216:219], v[84:87]
v_mfma_f32_16x16x32_bf16 v[84:87], v[252:255], v[228:231], v[84:87]
s_waitcnt lgkmcnt(3)
v_mfma_f32_16x16x32_bf16 v[88:91], v[232:235], v[208:211], v[88:91]
s_waitcnt lgkmcnt(2)
v_mfma_f32_16x16x32_bf16 v[88:91], v[236:239], v[220:223], v[88:91]
v_mfma_f32_16x16x32_bf16 v[92:95], v[236:239], v[224:227], v[92:95]
v_mfma_f32_16x16x32_bf16 v[92:95], v[232:235], v[212:215], v[92:95]
v_mfma_f32_16x16x32_bf16 v[96:99], v[232:235], v[216:219], v[96:99]
v_mfma_f32_16x16x32_bf16 v[96:99], v[236:239], v[228:231], v[96:99]
s_waitcnt lgkmcnt(1)
v_mfma_f32_16x16x32_bf16 v[100:103], v[240:243], v[208:211], v[100:103]
s_waitcnt lgkmcnt(0)
v_mfma_f32_16x16x32_bf16 v[100:103], v[244:247], v[220:223], v[100:103]
v_mfma_f32_16x16x32_bf16 v[104:107], v[244:247], v[224:227], v[104:107]
v_mfma_f32_16x16x32_bf16 v[104:107], v[240:243], v[212:215], v[104:107]
v_mfma_f32_16x16x32_bf16 v[108:111], v[240:243], v[216:219], v[108:111]
v_mfma_f32_16x16x32_bf16 v[108:111], v[244:247], v[228:231], v[108:111]
ds_read_b128 v[232:235], v5 offset:0
ds_read_b128 v[236:239], v6 offset:0
ds_read_b128 v[240:243], v5 offset:2048
ds_read_b128 v[244:247], v6 offset:2048
ds_read_b128 v[248:251], v5 offset:4096
ds_read_b128 v[252:255], v6 offset:4096
s_waitcnt lgkmcnt(5)
v_mfma_f32_16x16x32_bf16 v[112:115], v[232:235], v[208:211], v[112:115]
s_waitcnt lgkmcnt(4)
v_mfma_f32_16x16x32_bf16 v[112:115], v[236:239], v[220:223], v[112:115]
v_mfma_f32_16x16x32_bf16 v[116:119], v[236:239], v[224:227], v[116:119]
v_mfma_f32_16x16x32_bf16 v[116:119], v[232:235], v[212:215], v[116:119]
v_mfma_f32_16x16x32_bf16 v[120:123], v[232:235], v[216:219], v[120:123]
ds_read_b128 v[232:235], v5 offset:6144
v_mfma_f32_16x16x32_bf16 v[120:123], v[236:239], v[228:231], v[120:123]
ds_read_b128 v[236:239], v6 offset:6144
s_waitcnt lgkmcnt(5)
v_mfma_f32_16x16x32_bf16 v[124:127], v[240:243], v[208:211], v[124:127]
s_waitcnt lgkmcnt(4)
v_mfma_f32_16x16x32_bf16 v[124:127], v[244:247], v[220:223], v[124:127]
v_mfma_f32_16x16x32_bf16 v[128:131], v[244:247], v[224:227], v[128:131]
v_mfma_f32_16x16x32_bf16 v[128:131], v[240:243], v[212:215], v[128:131]
v_mfma_f32_16x16x32_bf16 v[132:135], v[240:243], v[216:219], v[132:135]
ds_read_b128 v[240:243], v5 offset:8192
v_mfma_f32_16x16x32_bf16 v[132:135], v[244:247], v[228:231], v[132:135]
ds_read_b128 v[244:247], v6 offset:8192
s_waitcnt lgkmcnt(5)
v_mfma_f32_16x16x32_bf16 v[136:139], v[248:251], v[208:211], v[136:139]
s_waitcnt lgkmcnt(4)
v_mfma_f32_16x16x32_bf16 v[136:139], v[252:255], v[220:223], v[136:139]
v_mfma_f32_16x16x32_bf16 v[140:143], v[252:255], v[224:227], v[140:143]
s_barrier
v_mfma_f32_16x16x32_bf16 v[140:143], v[248:251], v[212:215], v[140:143]
v_mfma_f32_16x16x32_bf16 v[144:147], v[248:251], v[216:219], v[144:147]
ds_read_b128 v[248:251], v5 offset:10240
v_mfma_f32_16x16x32_bf16 v[144:147], v[252:255], v[228:231], v[144:147]
ds_read_b128 v[252:255], v6 offset:10240
s_waitcnt lgkmcnt(5)
v_mfma_f32_16x16x32_bf16 v[148:151], v[232:235], v[208:211], v[148:151]
s_waitcnt lgkmcnt(4)
v_mfma_f32_16x16x32_bf16 v[148:151], v[236:239], v[220:223], v[148:151]
v_mfma_f32_16x16x32_bf16 v[152:155], v[236:239], v[224:227], v[152:155]
v_mfma_f32_16x16x32_bf16 v[152:155], v[232:235], v[212:215], v[152:155]
v_mfma_f32_16x16x32_bf16 v[156:159], v[232:235], v[216:219], v[156:159]
ds_read_b128 v[232:235], v5 offset:12288
v_mfma_f32_16x16x32_bf16 v[156:159], v[236:239], v[228:231], v[156:159]
ds_read_b128 v[236:239], v6 offset:12288
s_waitcnt lgkmcnt(5)
v_mfma_f32_16x16x32_bf16 v[160:163], v[240:243], v[208:211], v[160:163]
s_waitcnt lgkmcnt(4)
v_mfma_f32_16x16x32_bf16 v[160:163], v[244:247], v[220:223], v[160:163]
v_mfma_f32_16x16x32_bf16 v[164:167], v[244:247], v[224:227], v[164:167]
v_mfma_f32_16x16x32_bf16 v[164:167], v[240:243], v[212:215], v[164:167]
v_mfma_f32_16x16x32_bf16 v[168:171], v[240:243], v[216:219], v[168:171]
ds_read_b128 v[240:243], v5 offset:14336
v_mfma_f32_16x16x32_bf16 v[168:171], v[244:247], v[228:231], v[168:171]
ds_read_b128 v[244:247], v6 offset:14336
s_waitcnt lgkmcnt(5)
v_mfma_f32_16x16x32_bf16 v[172:175], v[248:251], v[208:211], v[172:175]
s_waitcnt lgkmcnt(4)
v_mfma_f32_16x16x32_bf16 v[172:175], v[252:255], v[220:223], v[172:175]
v_mfma_f32_16x16x32_bf16 v[176:179], v[252:255], v[224:227], v[176:179]
v_mfma_f32_16x16x32_bf16 v[176:179], v[248:251], v[212:215], v[176:179]
v_mfma_f32_16x16x32_bf16 v[180:183], v[248:251], v[216:219], v[180:183]
v_mfma_f32_16x16x32_bf16 v[180:183], v[252:255], v[228:231], v[180:183]
s_barrier
s_waitcnt lgkmcnt(3)
v_mfma_f32_16x16x32_bf16 v[184:187], v[232:235], v[208:211], v[184:187]
s_waitcnt lgkmcnt(2)
v_mfma_f32_16x16x32_bf16 v[184:187], v[236:239], v[220:223], v[184:187]
v_mfma_f32_16x16x32_bf16 v[188:191], v[236:239], v[224:227], v[188:191]
v_mfma_f32_16x16x32_bf16 v[188:191], v[232:235], v[212:215], v[188:191]
v_mfma_f32_16x16x32_bf16 v[192:195], v[232:235], v[216:219], v[192:195]
v_mfma_f32_16x16x32_bf16 v[192:195], v[236:239], v[228:231], v[192:195]
s_waitcnt lgkmcnt(1)
v_mfma_f32_16x16x32_bf16 v[196:199], v[240:243], v[208:211], v[196:199]
s_waitcnt lgkmcnt(0)
v_mfma_f32_16x16x32_bf16 v[196:199], v[244:247], v[220:223], v[196:199]
v_mfma_f32_16x16x32_bf16 v[200:203], v[244:247], v[224:227], v[200:203]
v_mfma_f32_16x16x32_bf16 v[200:203], v[240:243], v[212:215], v[200:203]
v_mfma_f32_16x16x32_bf16 v[204:207], v[240:243], v[216:219], v[204:207]
v_mfma_f32_16x16x32_bf16 v[204:207], v[244:247], v[228:231], v[204:207]
s_barrier
s_cmp_lg_u32 s52, 0
s_cbranch_scc1 L_ib2
s_mov_b64 exec, 1
buffer_load_dword v10, v13, s[44:47], 0 offen sc1
s_mov_b64 exec, -1
L_ib2:
s_cmp_lg_u32 s56, 0
s_cbranch_scc1 L_q6
ds_read_b128 v[208:211], v7 offset:0
ds_read_b128 v[220:223], v7 offset:3072
ds_read_b128 v[224:227], v7 offset:4096
ds_read_b128 v[212:215], v7 offset:1024
ds_read_b128 v[216:219], v7 offset:2048
ds_read_b128 v[228:231], v7 offset:5120
L_q6:
v_subrev_u32 v7, 6144, v7
ds_read_b128 v[232:235], v3 offset:0
ds_read_b128 v[236:239], v4 offset:0
ds_read_b128 v[240:243], v3 offset:2048
ds_read_b128 v[244:247], v4 offset:2048
ds_read_b128 v[248:251], v3 offset:4096
ds_read_b128 v[252:255], v4 offset:4096
s_waitcnt lgkmcnt(0)
s_barrier
s_cmp_lg_u32 s56, 1
s_cbranch_scc1 L_q7
ds_read_b128 v[208:211], v7 offset:0
ds_read_b128 v[220:223], v7 offset:3072
ds_read_b128 v[224:227], v7 offset:4096
ds_read_b128 v[212:215], v7 offset:1024
ds_read_b128 v[216:219], v7 offset:2048
ds_read_b128 v[228:231], v7 offset:5120
L_q7:
s_waitcnt lgkmcnt(5)
v_mfma_f32_16x16x32_bf16 v[16:19], v[232:235], v[208:211], v[16:19]
s_waitcnt lgkmcnt(4)
v_mfma_f32_16x16x32_bf16 v[16:19], v[236:239], v[220:223], v[16:19]
s_waitcnt lgkmcnt(3)
v_mfma_f32_16x16x32_bf16 v[20:23], v[236:239], v[224:227], v[20:23]
s_waitcnt lgkmcnt(2)
v_mfma_f32_16x16x32_bf16 v[20:23], v[232:235], v[212:215], v[20:23]
s_waitcnt lgkmcnt(1)
v_mfma_f32_16x16x32_bf16 v[24:27], v[232:235], v[216:219], v[24:27]
ds_read_b128 v[232:235], v3 offset:6144
s_waitcnt lgkmcnt(1)
v_mfma_f32_16x16x32_bf16 v[24:27], v[236:239], v[228:231], v[24:27]
ds_read_b128 v[236:239], v4 offset:6144
v_mfma_f32_16x16x32_bf16 v[28:31], v[240:243], v[208:211], v[28:31]
v_mfma_f32_16x16x32_bf16 v[28:31], v[244:247], v[220:223], v[28:31]
v_mfma_f32_16x16x32_bf16 v[32:35], v[244:247], v[224:227], v[32:35]
v_mfma_f32_16x16x32_bf16 v[32:35], v[240:243], v[212:215], v[32:35]
v_mfma_f32_16x16x32_bf16 v[36:39], v[240:243], v[216:219], v[36:39]
ds_read_b128 v[240:243], v3 offset:8192
v_mfma_f32_16x16x32_bf16 v[36:39], v[244:247], v[228:231], v[36:39]
ds_read_b128 v[244:247], v4 offset:8192
v_mfma_f32_16x16x32_bf16 v[40:43], v[248:251], v[208:211], v[40:43]
v_max_f32 v13, v16, v17
v_mfma_f32_16x16x32_bf16 v[40:43], v[252:255], v[220:223], v[40:43]
v_max_f32 v15, v20, v21
v_mfma_f32_16x16x32_bf16 v[44:47], v[252:255], v[224:227], v[44:47]
v_max_f32 v9, v24, v25
v_mfma_f32_16x16x32_bf16 v[44:47], v[248:251], v[212:215], v[44:47]
v_max3_f32 v13, v18, v19, v13
v_mfma_f32_16x16x32_bf16 v[48:51], v[248:251], v[216:219], v[48:51]
ds_read_b128 v[248:251], v3 offset:10240
v_max3_f32 v15, v22, v23, v15
v_mfma_f32_16x16x32_bf16 v[48:51], v[252:255], v[228:231], v[48:51]
ds_read_b128 v[252:255], v4 offset:10240
v_max3_f32 v9, v26, v27, v9
s_waitcnt lgkmcnt(5)
v_mfma_f32_16x16x32_bf16 v[52:55], v[232:235], v[208:211], v[52:55]
v_max3_f32 v13, v28, v29, v13
s_waitcnt lgkmcnt(4)
v_mfma_f32_16x16x32_bf16 v[52:55], v[236:239], v[220:223], v[52:55]
v_max3_f32 v15, v32, v33, v15
v_mfma_f32_16x16x32_bf16 v[56:59], v[236:239], v[224:227], v[56:59]
v_max3_f32 v9, v36, v37, v9
v_mfma_f32_16x16x32_bf16 v[56:59], v[232:235], v[212:215], v[56:59]
v_max3_f32 v13, v30, v31, v13
v_mfma_f32_16x16x32_bf16 v[60:63], v[232:235], v[216:219], v[60:63]
ds_read_b128 v[232:235], v3 offset:12288
v_max3_f32 v15, v34, v35, v15
v_mfma_f32_16x16x32_bf16 v[60:63], v[236:239], v[228:231], v[60:63]
ds_read_b128 v[236:239], v4 offset:12288
v_max3_f32 v9, v38, v39, v9
s_waitcnt lgkmcnt(5)
v_mfma_f32_16x16x32_bf16 v[64:67], v[240:243], v[208:211], v[64:67]
v_max3_f32 v13, v40, v41, v13
s_waitcnt lgkmcnt(4)
v_mfma_f32_16x16x32_bf16 v[64:67], v[244:247], v[220:223], v[64:67]
v_max3_f32 v15, v44, v45, v15
v_mfma_f32_16x16x32_bf16 v[68:71], v[244:247], v[224:227], v[68:71]
v_max3_f32 v9, v48, v49, v9
v_mfma_f32_16x16x32_bf16 v[68:71], v[240:243], v[212:215], v[68:71]
v_max3_f32 v13, v42, v43, v13
v_mfma_f32_16x16x32_bf16 v[72:75], v[240:243], v[216:219], v[72:75]
ds_read_b128 v[240:243], v3 offset:14336
v_max3_f32 v15, v46, v47, v15
v_mfma_f32_16x16x32_bf16 v[72:75], v[244:247], v[228:231], v[72:75]
ds_read_b128 v[244:247], v4 offset:14336
v_max3_f32 v9, v50, v51, v9
s_waitcnt lgkmcnt(5)
v_mfma_f32_16x16x32_bf16 v[76:79], v[248:251], v[208:211], v[76:79]
v_max3_f32 v13, v52, v53, v13
s_waitcnt lgkmcnt(4)
v_mfma_f32_16x16x32_bf16 v[76:79], v[252:255], v[220:223], v[76:79]
v_max3_f32 v15, v56, v57, v15
v_mfma_f32_16x16x32_bf16 v[80:83], v[252:255], v[224:227], v[80:83]
v_max3_f32 v9, v60, v61, v9
v_mfma_f32_16x16x32_bf16 v[80:83], v[248:251], v[212:215], v[80:83]
v_max3_f32 v13, v54, v55, v13
v_mfma_f32_16x16x32_bf16 v[84:87], v[248:251], v[216:219], v[84:87]
v_max3_f32 v15, v58, v59, v15
v_mfma_f32_16x16x32_bf16 v[84:87], v[252:255], v[228:231], v[84:87]
v_max3_f32 v9, v62, v63, v9
s_waitcnt lgkmcnt(3)
v_mfma_f32_16x16x32_bf16 v[88:91], v[232:235], v[208:211], v[88:91]
v_max3_f32 v13, v64, v65, v13
s_waitcnt lgkmcnt(2)
v_mfma_f32_16x16x32_bf16 v[88:91], v[236:239], v[220:223], v[88:91]
v_max3_f32 v15, v68, v69, v15
v_mfma_f32_16x16x32_bf16 v[92:95], v[236:239], v[224:227], v[92:95]
v_max3_f32 v9, v72, v73, v9
v_mfma_f32_16x16x32_bf16 v[92:95], v[232:235], v[212:215], v[92:95]
v_max3_f32 v13, v66, v67, v13
v_mfma_f32_16x16x32_bf16 v[96:99], v[232:235], v[216:219], v[96:99]
v_max3_f32 v15, v70, v71, v15
v_mfma_f32_16x16x32_bf16 v[96:99], v[236:239], v[228:231], v[96:99]
v_max3_f32 v9, v74, v75, v9
s_waitcnt lgkmcnt(1)
v_mfma_f32_16x16x32_bf16 v[100:103], v[240:243], v[208:211], v[100:103]
v_max3_f32 v13, v76, v77, v13
s_waitcnt lgkmcnt(0)
v_mfma_f32_16x16x32_bf16 v[100:103], v[244:247], v[220:223], v[100:103]
v_max3_f32 v15, v80, v81, v15
v_mfma_f32_16x16x32_bf16 v[104:107], v[244:247], v[224:227], v[104:107]
v_max3_f32 v9, v84, v85, v9
v_mfma_f32_16x16x32_bf16 v[104:107], v[240:243], v[212:215], v[104:107]
v_max3_f32 v13, v78, v79, v13
v_mfma_f32_16x16x32_bf16 v[108:111], v[240:243], v[216:219], v[108:111]
v_max3_f32 v15, v82, v83, v15
v_mfma_f32_16x16x32_bf16 v[108:111], v[244:247], v[228:231], v[108:111]
v_max3_f32 v9, v86, v87, v9
s_barrier
ds_read_b128 v[232:235], v3 offset:32768
ds_read_b128 v[236:239], v4 offset:32768
ds_read_b128 v[240:243], v3 offset:34816
ds_read_b128 v[244:247], v4 offset:34816
ds_read_b128 v[248:251], v3 offset:36864
ds_read_b128 v[252:255], v4 offset:36864
s_waitcnt lgkmcnt(5)
v_mfma_f32_16x16x32_bf16 v[112:115], v[232:235], v[208:211], v[112:115]
v_max3_f32 v13, v88, v89, v13
s_waitcnt lgkmcnt(4)
v_mfma_f32_16x16x32_bf16 v[112:115], v[236:239], v[220:223], v[112:115]
v_max3_f32 v15, v92, v93, v15
v_mfma_f32_16x16x32_bf16 v[116:119], v[236:239], v[224:227], v[116:119]
v_max3_f32 v9, v96, v97, v9
v_mfma_f32_16x16x32_bf16 v[116:119], v[232:235], v[212:215], v[116:119]
v_max3_f32 v13, v90, v91, v13
v_mfma_f32_16x16x32_bf16 v[120:123], v[232:235], v[216:219], v[120:123]
ds_read_b128 v[232:235], v3 offset:38912
v_max3_f32 v15, v94, v95, v15
v_mfma_f32_16x16x32_bf16 v[120:123], v[236:239], v[228:231], v[120:123]
ds_read_b128 v[236:239], v4 offset:38912
v_max3_f32 v9, v98, v99, v9
s_waitcnt lgkmcnt(5)
v_mfma_f32_16x16x32_bf16 v[124:127], v[240:243], v[208:211], v[124:127]
v_max3_f32 v13, v100, v101, v13
s_waitcnt lgkmcnt(4)
v_mfma_f32_16x16x32_bf16 v[124:127], v[244:247], v[220:223], v[124:127]
v_max3_f32 v15, v104, v105, v15
v_mfma_f32_16x16x32_bf16 v[128:131], v[244:247], v[224:227], v[128:131]
v_max3_f32 v9, v108, v109, v9
v_mfma_f32_16x16x32_bf16 v[128:131], v[240:243], v[212:215], v[128:131]
v_max3_f32 v13, v102, v103, v13
v_mfma_f32_16x16x32_bf16 v[132:135], v[240:243], v[216:219], v[132:135]
ds_read_b128 v[240:243], v3 offset:40960
v_max3_f32 v15, v106, v107, v15
v_mfma_f32_16x16x32_bf16 v[132:135], v[244:247], v[228:231], v[132:135]
ds_read_b128 v[244:247], v4 offset:40960
v_max3_f32 v9, v110, v111, v9
s_waitcnt lgkmcnt(5)
v_mfma_f32_16x16x32_bf16 v[136:139], v[248:251], v[208:211], v[136:139]
v_max3_f32 v13, v112, v113, v13
s_waitcnt lgkmcnt(4)
v_mfma_f32_16x16x32_bf16 v[136:139], v[252:255], v[220:223], v[136:139]
v_max3_f32 v15, v116, v117, v15
v_mfma_f32_16x16x32_bf16 v[140:143], v[252:255], v[224:227], v[140:143]
v_max3_f32 v9, v120, v121, v9
v_mfma_f32_16x16x32_bf16 v[140:143], v[248:251], v[212:215], v[140:143]
v_max3_f32 v13, v114, v115, v13
v_mfma_f32_16x16x32_bf16 v[144:147], v[248:251], v[216:219], v[144:147]
ds_read_b128 v[248:251], v3 offset:43008
v_max3_f32 v15, v118, v119, v15
v_mfma_f32_16x16x32_bf16 v[144:147], v[252:255], v[228:231], v[144:147]
ds_read_b128 v[252:255], v4 offset:43008
v_max3_f32 v9, v122, v123, v9
s_waitcnt lgkmcnt(5)
v_mfma_f32_16x16x32_bf16 v[148:151], v[232:235], v[208:211], v[148:151]
v_max3_f32 v13, v124, v125, v13
s_waitcnt lgkmcnt(4)
v_mfma_f32_16x16x32_bf16 v[148:151], v[236:239], v[220:223], v[148:151]
v_max3_f32 v15, v128, v129, v15
v_mfma_f32_16x16x32_bf16 v[152:155], v[236:239], v[224:227], v[152:155]
v_max3_f32 v9, v132, v133, v9
v_mfma_f32_16x16x32_bf16 v[152:155], v[232:235], v[212:215], v[152:155]
v_max3_f32 v13, v126, v127, v13
v_mfma_f32_16x16x32_bf16 v[156:159], v[232:235], v[216:219], v[156:159]
ds_read_b128 v[232:235], v3 offset:45056
v_max3_f32 v15, v130, v131, v15
v_mfma_f32_16x16x32_bf16 v[156:159], v[236:239], v[228:231], v[156:159]
ds_read_b128 v[236:239], v4 offset:45056
v_max3_f32 v9, v134, v135, v9
s_waitcnt lgkmcnt(5)
v_mfma_f32_16x16x32_bf16 v[160:163], v[240:243], v[208:211], v[160:163]
v_max3_f32 v13, v136, v137, v13
s_waitcnt lgkmcnt(4)
v_mfma_f32_16x16x32_bf16 v[160:163], v[244:247], v[220:223], v[160:163]
v_max3_f32 v15, v140, v141, v15
v_mfma_f32_16x16x32_bf16 v[164:167], v[244:247], v[224:227], v[164:167]
v_max3_f32 v9, v144, v145, v9
v_mfma_f32_16x16x32_bf16 v[164:167], v[240:243], v[212:215], v[164:167]
v_max3_f32 v13, v138, v139, v13
v_mfma_f32_16x16x32_bf16 v[168:171], v[240:243], v[216:219], v[168:171]
ds_read_b128 v[240:243], v3 offset:47104
v_max3_f32 v15, v142, v143, v15
v_mfma_f32_16x16x32_bf16 v[168:171], v[244:247], v[228:231], v[168:171]
ds_read_b128 v[244:247], v4 offset:47104
v_max3_f32 v9, v146, v147, v9
s_waitcnt lgkmcnt(5)
v_mfma_f32_16x16x32_bf16 v[172:175], v[248:251], v[208:211], v[172:175]
v_max3_f32 v13, v148, v149, v13
v_lshrrev_b32 v12, 5, v1
s_waitcnt lgkmcnt(4)
v_mfma_f32_16x16x32_bf16 v[172:175], v[252:255], v[220:223], v[172:175]
v_max3_f32 v15, v152, v153, v15
v_mul_u32_u24 v7, 1024, v12
v_mfma_f32_16x16x32_bf16 v[176:179], v[252:255], v[224:227], v[176:179]
v_max3_f32 v9, v156, v157, v9
v_bfe_u32 v12, v1, 2, 3
v_mfma_f32_16x16x32_bf16 v[176:179], v[248:251], v[212:215], v[176:179]
v_max3_f32 v13, v150, v151, v13
v_lshl_add_u32 v7, v12, 7, v7
v_mfma_f32_16x16x32_bf16 v[180:183], v[248:251], v[216:219], v[180:183]
v_max3_f32 v15, v154, v155, v15
v_bfe_u32 v12, v1, 3, 2
v_mfma_f32_16x16x32_bf16 v[180:183], v[252:255], v[228:231], v[180:183]
v_max3_f32 v9, v158, v159, v9
v_lshl_add_u32 v7, v12, 5, v7
s_waitcnt lgkmcnt(3)
v_mfma_f32_16x16x32_bf16 v[184:187], v[232:235], v[208:211], v[184:187]
v_max3_f32 v13, v160, v161, v13
v_and_b32 v12, 3, v1
s_waitcnt lgkmcnt(2)
v_mfma_f32_16x16x32_bf16 v[184:187], v[236:239], v[220:223], v[184:187]
v_max3_f32 v15, v164, v165, v15
v_lshl_add_u32 v7, v12, 3, v7
v_mfma_f32_16x16x32_bf16 v[188:191], v[236:239], v[224:227], v[188:191]
v_max3_f32 v9, v168, v169, v9
s_and_b32 s60, s52, 1
v_mfma_f32_16x16x32_bf16 v[188:191], v[232:235], v[212:215], v[188:191]
v_max3_f32 v13, v162, v163, v13
s_lshl_b32 s61, s60, 14
v_mfma_f32_16x16x32_bf16 v[192:195], v[232:235], v[216:219], v[192:195]
v_max3_f32 v15, v166, v167, v15
s_lshl_b32 s60, s60, 6
v_mfma_f32_16x16x32_bf16 v[192:195], v[236:239], v[228:231], v[192:195]
v_max3_f32 v9, v170, v171, v9
s_add_u32 s61, s61, 0x10000
s_waitcnt lgkmcnt(1)
v_mfma_f32_16x16x32_bf16 v[196:199], v[240:243], v[208:211], v[196:199]
v_max3_f32 v13, v172, v173, v13
v_xor_b32 v7, s60, v7
s_waitcnt lgkmcnt(0)
v_mfma_f32_16x16x32_bf16 v[196:199], v[244:247], v[220:223], v[196:199]
v_max3_f32 v15, v176, v177, v15
v_add_u32 v7, s61, v7
v_mfma_f32_16x16x32_bf16 v[200:203], v[244:247], v[224:227], v[200:203]
v_max3_f32 v9, v180, v181, v9
v_xor_b32 v3, 0, v7
v_mfma_f32_16x16x32_bf16 v[200:203], v[240:243], v[212:215], v[200:203]
v_max3_f32 v13, v174, v175, v13
v_xor_b32 v4, 32, v7
v_mfma_f32_16x16x32_bf16 v[204:207], v[240:243], v[216:219], v[204:207]
v_max3_f32 v15, v178, v179, v15
v_xor_b32 v5, 64, v7
v_mfma_f32_16x16x32_bf16 v[204:207], v[244:247], v[228:231], v[204:207]
v_max3_f32 v9, v182, v183, v9
v_xor_b32 v6, 96, v7
v_max3_f32 v13, v184, v185, v13
v_max3_f32 v15, v188, v189, v15
v_max3_f32 v9, v192, v193, v9
v_max3_f32 v13, v186, v187, v13
v_max3_f32 v15, v190, v191, v15
v_max3_f32 v9, v194, v195, v9
v_max3_f32 v13, v196, v197, v13
v_max3_f32 v15, v200, v201, v15
v_max3_f32 v9, v204, v205, v9
v_max3_f32 v13, v198, v199, v13
v_max3_f32 v15, v202, v203, v15
v_max3_f32 v9, v206, v207, v9
v_mov_b32 v0, v13
v_mov_b32 v14, v15
v_mov_b32 v8, v9
v_permlane32_swap_b32 v13, v0
v_permlane32_swap_b32 v15, v14
v_permlane32_swap_b32 v9, v8
v_max_f32 v13, v13, v0
v_max_f32 v15, v15, v14
v_max_f32 v9, v9, v8
v_mov_b32 v0, v13
v_mov_b32 v14, v15
v_mov_b32 v8, v9
v_permlane16_swap_b32 v13, v0
v_permlane16_swap_b32 v15, v14
v_permlane16_swap_b32 v9, v8
v_max_f32 v13, v13, v0
v_max_f32 v15, v15, v14
v_max_f32 v9, v9, v8
v_mul_f32 v0, s58, v13
v_mul_f32 v14, s58, v15
v_mul_f32 v8, s58, v9
v_mov_b32 v252, 0x3f803f80
v_mov_b32 v253, 0x3f803f80
v_mov_b32 v254, 0x3f803f80
v_mov_b32 v255, 0x3f803f80
v_pk_fma_f32 v[16:17], v[16:17], s[58:59], v[0:1] op_sel_hi:[1,1,0] neg_lo:[0,0,1] neg_hi:[0,0,1]
v_pk_fma_f32 v[18:19], v[18:19], s[58:59], v[0:1] op_sel_hi:[1,1,0] neg_lo:[0,0,1] neg_hi:[0,0,1]
v_exp_f32 v16, v16
v_exp_f32 v17, v17
v_pk_fma_f32 v[28:29], v[28:29], s[58:59], v[0:1] op_sel_hi:[1,1,0] neg_lo:[0,0,1] neg_hi:[0,0,1]
v_exp_f32 v18, v18
v_exp_f32 v19, v19
v_pk_fma_f32 v[30:31], v[30:31], s[58:59], v[0:1] op_sel_hi:[1,1,0] neg_lo:[0,0,1] neg_hi:[0,0,1]
v_cvt_pk_bf16_f32 v16, v16, v17
v_exp_f32 v28, v28
v_exp_f32 v29, v29
v_pk_fma_f32 v[20:21], v[20:21], s[58:59], v[14:15] op_sel_hi:[1,1,0] neg_lo:[0,0,1] neg_hi:[0,0,1]
v_cvt_pk_bf16_f32 v17, v18, v19
v_exp_f32 v30, v30
v_exp_f32 v31, v31
v_pk_fma_f32 v[22:23], v[22:23], s[58:59], v[14:15] op_sel_hi:[1,1,0] neg_lo:[0,0,1] neg_hi:[0,0,1]
v_cvt_pk_bf16_f32 v18, v28, v29
v_exp_f32 v20, v20
v_exp_f32 v21, v21
v_pk_fma_f32 v[32:33], v[32:33], s[58:59], v[14:15] op_sel_hi:[1,1,0] neg_lo:[0,0,1] neg_hi:[0,0,1]
v_cvt_pk_bf16_f32 v19, v30, v31
v_exp_f32 v22, v22
v_exp_f32 v23, v23
v_pk_fma_f32 v[34:35], v[34:35], s[58:59], v[14:15] op_sel_hi:[1,1,0] neg_lo:[0,0,1] neg_hi:[0,0,1]
v_cvt_pk_bf16_f32 v20, v20, v21
v_exp_f32 v32, v32
v_exp_f32 v33, v33
v_pk_fma_f32 v[24:25], v[24:25], s[58:59], v[8:9] op_sel_hi:[1,1,0] neg_lo:[0,0,1] neg_hi:[0,0,1]
v_mfma_f32_16x16x32_bf16 v[208:211], v[252:255], v[16:19], 0
v_cvt_pk_bf16_f32 v21, v22, v23
v_exp_f32 v34, v34
v_exp_f32 v35, v35
v_pk_fma_f32 v[26:27], v[26:27], s[58:59], v[8:9] op_sel_hi:[1,1,0] neg_lo:[0,0,1] neg_hi:[0,0,1]
v_cvt_pk_bf16_f32 v22, v32, v33
v_exp_f32 v24, v24
v_exp_f32 v25, v25
v_pk_fma_f32 v[36:37], v[36:37], s[58:59], v[8:9] op_sel_hi:[1,1,0] neg_lo:[0,0,1] neg_hi:[0,0,1]
v_cvt_pk_bf16_f32 v23, v34, v35
v_exp_f32 v26, v26
v_exp_f32 v27, v27
v_pk_fma_f32 v[38:39], v[38:39], s[58:59], v[8:9] op_sel_hi:[1,1,0] neg_lo:[0,0,1] neg_hi:[0,0,1]
v_cvt_pk_bf16_f32 v24, v24, v25
v_exp_f32 v36, v36
v_exp_f32 v37, v37
v_pk_fma_f32 v[40:41], v[40:41], s[58:59], v[0:1] op_sel_hi:[1,1,0] neg_lo:[0,0,1] neg_hi:[0,0,1]
v_mfma_f32_16x16x32_bf16 v[212:215], v[252:255], v[20:23], 0
v_cvt_pk_bf16_f32 v25, v26, v27
v_exp_f32 v38, v38
v_exp_f32 v39, v39
v_pk_fma_f32 v[42:43], v[42:43], s[58:59], v[0:1] op_sel_hi:[1,1,0] neg_lo:[0,0,1] neg_hi:[0,0,1]
v_cvt_pk_bf16_f32 v26, v36, v37
v_exp_f32 v40, v40
v_exp_f32 v41, v41
v_pk_fma_f32 v[52:53], v[52:53], s[58:59], v[0:1] op_sel_hi:[1,1,0] neg_lo:[0,0,1] neg_hi:[0,0,1]
v_cvt_pk_bf16_f32 v27, v38, v39
v_exp_f32 v42, v42
v_exp_f32 v43, v43
v_pk_fma_f32 v[54:55], v[54:55], s[58:59], v[0:1] op_sel_hi:[1,1,0] neg_lo:[0,0,1] neg_hi:[0,0,1]
v_cvt_pk_bf16_f32 v40, v40, v41
v_exp_f32 v52, v52
v_exp_f32 v53, v53
v_pk_fma_f32 v[44:45], v[44:45], s[58:59], v[14:15] op_sel_hi:[1,1,0] neg_lo:[0,0,1] neg_hi:[0,0,1]
v_mfma_f32_16x16x32_bf16 v[216:219], v[252:255], v[24:27], 0
v_cvt_pk_bf16_f32 v41, v42, v43
v_exp_f32 v54, v54
v_exp_f32 v55, v55
v_pk_fma_f32 v[46:47], v[46:47], s[58:59], v[14:15] op_sel_hi:[1,1,0] neg_lo:[0,0,1] neg_hi:[0,0,1]
v_cvt_pk_bf16_f32 v42, v52, v53
v_exp_f32 v44, v44
v_exp_f32 v45, v45
v_pk_fma_f32 v[56:57], v[56:57], s[58:59], v[14:15] op_sel_hi:[1,1,0] neg_lo:[0,0,1] neg_hi:[0,0,1]
v_cvt_pk_bf16_f32 v43, v54, v55
v_exp_f32 v46, v46
v_exp_f32 v47, v47
v_pk_fma_f32 v[58:59], v[58:59], s[58:59], v[14:15] op_sel_hi:[1,1,0] neg_lo:[0,0,1] neg_hi:[0,0,1]
v_cvt_pk_bf16_f32 v44, v44, v45
v_exp_f32 v56, v56
v_exp_f32 v57, v57
v_pk_fma_f32 v[48:49], v[48:49], s[58:59], v[8:9] op_sel_hi:[1,1,0] neg_lo:[0,0,1] neg_hi:[0,0,1]
v_mfma_f32_16x16x32_bf16 v[208:211], v[252:255], v[40:43], v[208:211]
v_cvt_pk_bf16_f32 v45, v46, v47
v_exp_f32 v58, v58
v_exp_f32 v59, v59
v_pk_fma_f32 v[50:51], v[50:51], s[58:59], v[8:9] op_sel_hi:[1,1,0] neg_lo:[0,0,1] neg_hi:[0,0,1]
v_cvt_pk_bf16_f32 v46, v56, v57
v_exp_f32 v48, v48
v_exp_f32 v49, v49
v_pk_fma_f32 v[60:61], v[60:61], s[58:59], v[8:9] op_sel_hi:[1,1,0] neg_lo:[0,0,1] neg_hi:[0,0,1]
v_cvt_pk_bf16_f32 v47, v58, v59
v_exp_f32 v50, v50
v_exp_f32 v51, v51
v_pk_fma_f32 v[62:63], v[62:63], s[58:59], v[8:9] op_sel_hi:[1,1,0] neg_lo:[0,0,1] neg_hi:[0,0,1]
v_cvt_pk_bf16_f32 v48, v48, v49
v_exp_f32 v60, v60
v_exp_f32 v61, v61
v_pk_fma_f32 v[64:65], v[64:65], s[58:59], v[0:1] op_sel_hi:[1,1,0] neg_lo:[0,0,1] neg_hi:[0,0,1]
v_mfma_f32_16x16x32_bf16 v[212:215], v[252:255], v[44:47], v[212:215]
v_cvt_pk_bf16_f32 v49, v50, v51
v_exp_f32 v62, v62
v_exp_f32 v63, v63
v_pk_fma_f32 v[66:67], v[66:67], s[58:59], v[0:1] op_sel_hi:[1,1,0] neg_lo:[0,0,1] neg_hi:[0,0,1]
v_cvt_pk_bf16_f32 v50, v60, v61
v_exp_f32 v64, v64
v_exp_f32 v65, v65
v_pk_fma_f32 v[76:77], v[76:77], s[58:59], v[0:1] op_sel_hi:[1,1,0] neg_lo:[0,0,1] neg_hi:[0,0,1]
v_cvt_pk_bf16_f32 v51, v62, v63
v_exp_f32 v66, v66
v_exp_f32 v67, v67
v_pk_fma_f32 v[78:79], v[78:79], s[58:59], v[0:1] op_sel_hi:[1,1,0] neg_lo:[0,0,1] neg_hi:[0,0,1]
v_cvt_pk_bf16_f32 v64, v64, v65
v_exp_f32 v76, v76
v_exp_f32 v77, v77
v_pk_fma_f32 v[68:69], v[68:69], s[58:59], v[14:15] op_sel_hi:[1,1,0] neg_lo:[0,0,1] neg_hi:[0,0,1]
v_mfma_f32_16x16x32_bf16 v[216:219], v[252:255], v[48:51], v[216:219]
v_cvt_pk_bf16_f32 v65, v66, v67
v_exp_f32 v78, v78
v_exp_f32 v79, v79
v_pk_fma_f32 v[70:71], v[70:71], s[58:59], v[14:15] op_sel_hi:[1,1,0] neg_lo:[0,0,1] neg_hi:[0,0,1]
v_cvt_pk_bf16_f32 v66, v76, v77
v_exp_f32 v68, v68
v_exp_f32 v69, v69
v_pk_fma_f32 v[80:81], v[80:81], s[58:59], v[14:15] op_sel_hi:[1,1,0] neg_lo:[0,0,1] neg_hi:[0,0,1]
v_cvt_pk_bf16_f32 v67, v78, v79
v_exp_f32 v70, v70
v_exp_f32 v71, v71
v_pk_fma_f32 v[82:83], v[82:83], s[58:59], v[14:15] op_sel_hi:[1,1,0] neg_lo:[0,0,1] neg_hi:[0,0,1]
v_cvt_pk_bf16_f32 v68, v68, v69
v_exp_f32 v80, v80
v_exp_f32 v81, v81
v_pk_fma_f32 v[72:73], v[72:73], s[58:59], v[8:9] op_sel_hi:[1,1,0] neg_lo:[0,0,1] neg_hi:[0,0,1]
v_mfma_f32_16x16x32_bf16 v[208:211], v[252:255], v[64:67], v[208:211]
v_cvt_pk_bf16_f32 v69, v70, v71
v_exp_f32 v82, v82
v_exp_f32 v83, v83
v_pk_fma_f32 v[74:75], v[74:75], s[58:59], v[8:9] op_sel_hi:[1,1,0] neg_lo:[0,0,1] neg_hi:[0,0,1]
v_cvt_pk_bf16_f32 v70, v80, v81
v_exp_f32 v72, v72
v_exp_f32 v73, v73
v_pk_fma_f32 v[84:85], v[84:85], s[58:59], v[8:9] op_sel_hi:[1,1,0] neg_lo:[0,0,1] neg_hi:[0,0,1]
v_cvt_pk_bf16_f32 v71, v82, v83
v_exp_f32 v74, v74
v_exp_f32 v75, v75
v_pk_fma_f32 v[86:87], v[86:87], s[58:59], v[8:9] op_sel_hi:[1,1,0] neg_lo:[0,0,1] neg_hi:[0,0,1]
v_cvt_pk_bf16_f32 v72, v72, v73
v_exp_f32 v84, v84
v_exp_f32 v85, v85
v_pk_fma_f32 v[88:89], v[88:89], s[58:59], v[0:1] op_sel_hi:[1,1,0] neg_lo:[0,0,1] neg_hi:[0,0,1]
v_mfma_f32_16x16x32_bf16 v[212:215], v[252:255], v[68:71], v[212:215]
v_cvt_pk_bf16_f32 v73, v74, v75
v_exp_f32 v86, v86
v_exp_f32 v87, v87
v_pk_fma_f32 v[90:91], v[90:91], s[58:59], v[0:1] op_sel_hi:[1,1,0] neg_lo:[0,0,1] neg_hi:[0,0,1]
v_cvt_pk_bf16_f32 v74, v84, v85
v_exp_f32 v88, v88
v_exp_f32 v89, v89
v_pk_fma_f32 v[100:101], v[100:101], s[58:59], v[0:1] op_sel_hi:[1,1,0] neg_lo:[0,0,1] neg_hi:[0,0,1]
v_cvt_pk_bf16_f32 v75, v86, v87
v_exp_f32 v90, v90
v_exp_f32 v91, v91
v_pk_fma_f32 v[102:103], v[102:103], s[58:59], v[0:1] op_sel_hi:[1,1,0] neg_lo:[0,0,1] neg_hi:[0,0,1]
v_cvt_pk_bf16_f32 v88, v88, v89
v_exp_f32 v100, v100
v_exp_f32 v101, v101
v_pk_fma_f32 v[92:93], v[92:93], s[58:59], v[14:15] op_sel_hi:[1,1,0] neg_lo:[0,0,1] neg_hi:[0,0,1]
v_mfma_f32_16x16x32_bf16 v[216:219], v[252:255], v[72:75], v[216:219]
v_cvt_pk_bf16_f32 v89, v90, v91
v_exp_f32 v102, v102
v_exp_f32 v103, v103
v_pk_fma_f32 v[94:95], v[94:95], s[58:59], v[14:15] op_sel_hi:[1,1,0] neg_lo:[0,0,1] neg_hi:[0,0,1]
v_cvt_pk_bf16_f32 v90, v100, v101
v_exp_f32 v92, v92
v_exp_f32 v93, v93
v_pk_fma_f32 v[104:105], v[104:105], s[58:59], v[14:15] op_sel_hi:[1,1,0] neg_lo:[0,0,1] neg_hi:[0,0,1]
v_cvt_pk_bf16_f32 v91, v102, v103
v_exp_f32 v94, v94
v_exp_f32 v95, v95
v_pk_fma_f32 v[106:107], v[106:107], s[58:59], v[14:15] op_sel_hi:[1,1,0] neg_lo:[0,0,1] neg_hi:[0,0,1]
s_barrier
v_cvt_pk_bf16_f32 v92, v92, v93
v_exp_f32 v104, v104
v_exp_f32 v105, v105
v_pk_fma_f32 v[96:97], v[96:97], s[58:59], v[8:9] op_sel_hi:[1,1,0] neg_lo:[0,0,1] neg_hi:[0,0,1]
v_mfma_f32_16x16x32_bf16 v[208:211], v[252:255], v[88:91], v[208:211]
ds_read_b64_tr_b16 v[232:233], v5 offset:0
ds_read_b64_tr_b16 v[234:235], v5 offset:2048
ds_read_b64_tr_b16 v[236:237], v5 offset:4096
ds_read_b64_tr_b16 v[238:239], v5 offset:6144
v_cvt_pk_bf16_f32 v93, v94, v95
v_exp_f32 v106, v106
v_exp_f32 v107, v107
v_pk_fma_f32 v[98:99], v[98:99], s[58:59], v[8:9] op_sel_hi:[1,1,0] neg_lo:[0,0,1] neg_hi:[0,0,1]
v_cvt_pk_bf16_f32 v94, v104, v105
v_exp_f32 v96, v96
v_exp_f32 v97, v97
v_pk_fma_f32 v[108:109], v[108:109], s[58:59], v[8:9] op_sel_hi:[1,1,0] neg_lo:[0,0,1] neg_hi:[0,0,1]
v_cvt_pk_bf16_f32 v95, v106, v107
v_exp_f32 v98, v98
v_exp_f32 v99, v99
v_pk_fma_f32 v[110:111], v[110:111], s[58:59], v[8:9] op_sel_hi:[1,1,0] neg_lo:[0,0,1] neg_hi:[0,0,1]
v_cvt_pk_bf16_f32 v96, v96, v97
v_exp_f32 v108, v108
v_exp_f32 v109, v109
v_pk_fma_f32 v[112:113], v[112:113], s[58:59], v[0:1] op_sel_hi:[1,1,0] neg_lo:[0,0,1] neg_hi:[0,0,1]
v_mfma_f32_16x16x32_bf16 v[212:215], v[252:255], v[92:95], v[212:215]
ds_read_b64_tr_b16 v[240:241], v5 offset:8192
ds_read_b64_tr_b16 v[242:243], v5 offset:10240
ds_read_b64_tr_b16 v[244:245], v5 offset:12288
ds_read_b64_tr_b16 v[246:247], v5 offset:14336
v_cvt_pk_bf16_f32 v97, v98, v99
v_exp_f32 v110, v110
v_exp_f32 v111, v111
v_pk_fma_f32 v[114:115], v[114:115], s[58:59], v[0:1] op_sel_hi:[1,1,0] neg_lo:[0,0,1] neg_hi:[0,0,1]
v_cvt_pk_bf16_f32 v98, v108, v109
v_exp_f32 v112, v112
v_exp_f32 v113, v113
v_pk_fma_f32 v[124:125], v[124:125], s[58:59], v[0:1] op_sel_hi:[1,1,0] neg_lo:[0,0,1] neg_hi:[0,0,1]
v_cvt_pk_bf16_f32 v99, v110, v111
v_exp_f32 v114, v114
v_exp_f32 v115, v115
v_pk_fma_f32 v[126:127], v[126:127], s[58:59], v[0:1] op_sel_hi:[1,1,0] neg_lo:[0,0,1] neg_hi:[0,0,1]
s_waitcnt lgkmcnt(6)
v_mfma_f32_16x16x32_bf16 v[76:79], v[232:235], v[16:19], 0
v_cvt_pk_bf16_f32 v112, v112, v113
v_exp_f32 v124, v124
v_exp_f32 v125, v125
v_pk_fma_f32 v[116:117], v[116:117], s[58:59], v[14:15] op_sel_hi:[1,1,0] neg_lo:[0,0,1] neg_hi:[0,0,1]
v_mfma_f32_16x16x32_bf16 v[80:83], v[232:235], v[20:23], 0
ds_read_b64_tr_b16 v[248:249], v6 offset:0
v_cvt_pk_bf16_f32 v113, v114, v115
v_exp_f32 v126, v126
v_exp_f32 v127, v127
v_pk_fma_f32 v[118:119], v[118:119], s[58:59], v[14:15] op_sel_hi:[1,1,0] neg_lo:[0,0,1] neg_hi:[0,0,1]
v_mfma_f32_16x16x32_bf16 v[84:87], v[232:235], v[24:27], 0
ds_read_b64_tr_b16 v[250:251], v6 offset:2048
v_cvt_pk_bf16_f32 v114, v124, v125
v_exp_f32 v116, v116
v_exp_f32 v117, v117
v_pk_fma_f32 v[128:129], v[128:129], s[58:59], v[14:15] op_sel_hi:[1,1,0] neg_lo:[0,0,1] neg_hi:[0,0,1]
s_barrier
s_waitcnt lgkmcnt(6)
v_mfma_f32_16x16x32_bf16 v[76:79], v[236:239], v[40:43], v[76:79]
v_cvt_pk_bf16_f32 v115, v126, v127
v_exp_f32 v118, v118
v_exp_f32 v119, v119
v_pk_fma_f32 v[130:131], v[130:131], s[58:59], v[14:15] op_sel_hi:[1,1,0] neg_lo:[0,0,1] neg_hi:[0,0,1]
v_mfma_f32_16x16x32_bf16 v[80:83], v[236:239], v[44:47], v[80:83]
ds_read_b64_tr_b16 v[232:233], v6 offset:4096
v_cvt_pk_bf16_f32 v116, v116, v117
v_exp_f32 v128, v128
v_exp_f32 v129, v129
v_pk_fma_f32 v[120:121], v[120:121], s[58:59], v[8:9] op_sel_hi:[1,1,0] neg_lo:[0,0,1] neg_hi:[0,0,1]
v_mfma_f32_16x16x32_bf16 v[84:87], v[236:239], v[48:51], v[84:87]
ds_read_b64_tr_b16 v[234:235], v6 offset:6144
v_cvt_pk_bf16_f32 v117, v118, v119
v_exp_f32 v130, v130
v_exp_f32 v131, v131
v_pk_fma_f32 v[122:123], v[122:123], s[58:59], v[8:9] op_sel_hi:[1,1,0] neg_lo:[0,0,1] neg_hi:[0,0,1]
s_waitcnt lgkmcnt(6)
v_mfma_f32_16x16x32_bf16 v[76:79], v[240:243], v[64:67], v[76:79]
v_cvt_pk_bf16_f32 v118, v128, v129
v_exp_f32 v120, v120
v_exp_f32 v121, v121
v_pk_fma_f32 v[132:133], v[132:133], s[58:59], v[8:9] op_sel_hi:[1,1,0] neg_lo:[0,0,1] neg_hi:[0,0,1]
v_mfma_f32_16x16x32_bf16 v[80:83], v[240:243], v[68:71], v[80:83]
ds_read_b64_tr_b16 v[236:237], v6 offset:8192
v_cvt_pk_bf16_f32 v119, v130, v131
v_exp_f32 v122, v122
v_exp_f32 v123, v123
v_pk_fma_f32 v[134:135], v[134:135], s[58:59], v[8:9] op_sel_hi:[1,1,0] neg_lo:[0,0,1] neg_hi:[0,0,1]
v_mfma_f32_16x16x32_bf16 v[84:87], v[240:243], v[72:75], v[84:87]
ds_read_b64_tr_b16 v[238:239], v6 offset:10240
v_cvt_pk_bf16_f32 v120, v120, v121
v_exp_f32 v132, v132
v_exp_f32 v133, v133
v_pk_fma_f32 v[136:137], v[136:137], s[58:59], v[0:1] op_sel_hi:[1,1,0] neg_lo:[0,0,1] neg_hi:[0,0,1]
s_waitcnt lgkmcnt(6)
v_mfma_f32_16x16x32_bf16 v[76:79], v[244:247], v[88:91], v[76:79]
v_cvt_pk_bf16_f32 v121, v122, v123
v_exp_f32 v134, v134
v_exp_f32 v135, v135
v_pk_fma_f32 v[138:139], v[138:139], s[58:59], v[0:1] op_sel_hi:[1,1,0] neg_lo:[0,0,1] neg_hi:[0,0,1]
v_mfma_f32_16x16x32_bf16 v[80:83], v[244:247], v[92:95], v[80:83]
ds_read_b64_tr_b16 v[240:241], v6 offset:12288
v_cvt_pk_bf16_f32 v122, v132, v133
v_exp_f32 v136, v136
v_exp_f32 v137, v137
v_pk_fma_f32 v[148:149], v[148:149], s[58:59], v[0:1] op_sel_hi:[1,1,0] neg_lo:[0,0,1] neg_hi:[0,0,1]
v_mfma_f32_16x16x32_bf16 v[84:87], v[244:247], v[96:99], v[84:87]
ds_read_b64_tr_b16 v[242:243], v6 offset:14336
v_cvt_pk_bf16_f32 v123, v134, v135
v_exp_f32 v138, v138
v_exp_f32 v139, v139
v_pk_fma_f32 v[150:151], v[150:151], s[58:59], v[0:1] op_sel_hi:[1,1,0] neg_lo:[0,0,1] neg_hi:[0,0,1]
s_waitcnt lgkmcnt(6)
v_mfma_f32_16x16x32_bf16 v[100:103], v[248:251], v[16:19], 0
v_cvt_pk_bf16_f32 v136, v136, v137
v_exp_f32 v148, v148
v_exp_f32 v149, v149
v_pk_fma_f32 v[140:141], v[140:141], s[58:59], v[14:15] op_sel_hi:[1,1,0] neg_lo:[0,0,1] neg_hi:[0,0,1]
v_mfma_f32_16x16x32_bf16 v[104:107], v[248:251], v[20:23], 0
ds_read_b64_tr_b16 v[244:245], v3 offset:0
v_cvt_pk_bf16_f32 v137, v138, v139
v_exp_f32 v150, v150
v_exp_f32 v151, v151
v_pk_fma_f32 v[142:143], v[142:143], s[58:59], v[14:15] op_sel_hi:[1,1,0] neg_lo:[0,0,1] neg_hi:[0,0,1]
v_mfma_f32_16x16x32_bf16 v[108:111], v[248:251], v[24:27], 0
ds_read_b64_tr_b16 v[246:247], v3 offset:2048
v_cvt_pk_bf16_f32 v138, v148, v149
v_exp_f32 v140, v140
v_exp_f32 v141, v141
v_pk_fma_f32 v[152:153], v[152:153], s[58:59], v[14:15] op_sel_hi:[1,1,0] neg_lo:[0,0,1] neg_hi:[0,0,1]
s_waitcnt lgkmcnt(6)
v_mfma_f32_16x16x32_bf16 v[100:103], v[232:235], v[40:43], v[100:103]
v_cvt_pk_bf16_f32 v139, v150, v151
v_exp_f32 v142, v142
v_exp_f32 v143, v143
v_pk_fma_f32 v[154:155], v[154:155], s[58:59], v[14:15] op_sel_hi:[1,1,0] neg_lo:[0,0,1] neg_hi:[0,0,1]
v_mfma_f32_16x16x32_bf16 v[104:107], v[232:235], v[44:47], v[104:107]
ds_read_b64_tr_b16 v[248:249], v3 offset:4096
v_cvt_pk_bf16_f32 v140, v140, v141
v_exp_f32 v152, v152
v_exp_f32 v153, v153
v_pk_fma_f32 v[144:145], v[144:145], s[58:59], v[8:9] op_sel_hi:[1,1,0] neg_lo:[0,0,1] neg_hi:[0,0,1]
v_mfma_f32_16x16x32_bf16 v[108:111], v[232:235], v[48:51], v[108:111]
ds_read_b64_tr_b16 v[250:251], v3 offset:6144
v_cvt_pk_bf16_f32 v141, v142, v143
v_exp_f32 v154, v154
v_exp_f32 v155, v155
v_pk_fma_f32 v[146:147], v[146:147], s[58:59], v[8:9] op_sel_hi:[1,1,0] neg_lo:[0,0,1] neg_hi:[0,0,1]
s_waitcnt lgkmcnt(6)
v_mfma_f32_16x16x32_bf16 v[100:103], v[236:239], v[64:67], v[100:103]
v_cvt_pk_bf16_f32 v142, v152, v153
v_exp_f32 v144, v144
v_exp_f32 v145, v145
v_pk_fma_f32 v[156:157], v[156:157], s[58:59], v[8:9] op_sel_hi:[1,1,0] neg_lo:[0,0,1] neg_hi:[0,0,1]
v_mfma_f32_16x16x32_bf16 v[104:107], v[236:239], v[68:71], v[104:107]
ds_read_b64_tr_b16 v[232:233], v3 offset:8192
v_cvt_pk_bf16_f32 v143, v154, v155
v_exp_f32 v146, v146
v_exp_f32 v147, v147
v_pk_fma_f32 v[158:159], v[158:159], s[58:59], v[8:9] op_sel_hi:[1,1,0] neg_lo:[0,0,1] neg_hi:[0,0,1]
v_mfma_f32_16x16x32_bf16 v[108:111], v[236:239], v[72:75], v[108:111]
ds_read_b64_tr_b16 v[234:235], v3 offset:10240
v_cvt_pk_bf16_f32 v144, v144, v145
v_exp_f32 v156, v156
v_exp_f32 v157, v157
v_pk_fma_f32 v[160:161], v[160:161], s[58:59], v[0:1] op_sel_hi:[1,1,0] neg_lo:[0,0,1] neg_hi:[0,0,1]
s_waitcnt lgkmcnt(6)
v_mfma_f32_16x16x32_bf16 v[100:103], v[240:243], v[88:91], v[100:103]
v_cvt_pk_bf16_f32 v145, v146, v147
v_exp_f32 v158, v158
v_exp_f32 v159, v159
v_pk_fma_f32 v[162:163], v[162:163], s[58:59], v[0:1] op_sel_hi:[1,1,0] neg_lo:[0,0,1] neg_hi:[0,0,1]
v_mfma_f32_16x16x32_bf16 v[104:107], v[240:243], v[92:95], v[104:107]
ds_read_b64_tr_b16 v[236:237], v3 offset:12288
v_cvt_pk_bf16_f32 v146, v156, v157
v_exp_f32 v160, v160
v_exp_f32 v161, v161
v_pk_fma_f32 v[172:173], v[172:173], s[58:59], v[0:1] op_sel_hi:[1,1,0] neg_lo:[0,0,1] neg_hi:[0,0,1]
v_mfma_f32_16x16x32_bf16 v[108:111], v[240:243], v[96:99], v[108:111]
ds_read_b64_tr_b16 v[238:239], v3 offset:14336
v_cvt_pk_bf16_f32 v147, v158, v159
v_exp_f32 v162, v162
v_exp_f32 v163, v163
v_pk_fma_f32 v[174:175], v[174:175], s[58:59], v[0:1] op_sel_hi:[1,1,0] neg_lo:[0,0,1] neg_hi:[0,0,1]
s_waitcnt lgkmcnt(6)
v_mfma_f32_16x16x32_bf16 v[28:31], v[244:247], v[16:19], 0
v_cvt_pk_bf16_f32 v160, v160, v161
v_exp_f32 v172, v172
v_exp_f32 v173, v173
v_pk_fma_f32 v[164:165], v[164:165], s[58:59], v[14:15] op_sel_hi:[1,1,0] neg_lo:[0,0,1] neg_hi:[0,0,1]
v_mfma_f32_16x16x32_bf16 v[32:35], v[244:247], v[20:23], 0
ds_read_b64_tr_b16 v[240:241], v4 offset:0
v_cvt_pk_bf16_f32 v161, v162, v163
v_exp_f32 v174, v174
v_exp_f32 v175, v175
v_pk_fma_f32 v[166:167], v[166:167], s[58:59], v[14:15] op_sel_hi:[1,1,0] neg_lo:[0,0,1] neg_hi:[0,0,1]
v_mfma_f32_16x16x32_bf16 v[36:39], v[244:247], v[24:27], 0
ds_read_b64_tr_b16 v[242:243], v4 offset:2048
v_cvt_pk_bf16_f32 v162, v172, v173
v_exp_f32 v164, v164
v_exp_f32 v165, v165
v_pk_fma_f32 v[176:177], v[176:177], s[58:59], v[14:15] op_sel_hi:[1,1,0] neg_lo:[0,0,1] neg_hi:[0,0,1]
s_waitcnt lgkmcnt(6)
v_mfma_f32_16x16x32_bf16 v[28:31], v[248:251], v[40:43], v[28:31]
v_cvt_pk_bf16_f32 v163, v174, v175
v_exp_f32 v166, v166
v_exp_f32 v167, v167
v_pk_fma_f32 v[178:179], v[178:179], s[58:59], v[14:15] op_sel_hi:[1,1,0] neg_lo:[0,0,1] neg_hi:[0,0,1]
v_mfma_f32_16x16x32_bf16 v[32:35], v[248:251], v[44:47], v[32:35]
ds_read_b64_tr_b16 v[244:245], v4 offset:4096
v_cvt_pk_bf16_f32 v164, v164, v165
v_exp_f32 v176, v176
v_exp_f32 v177, v177
v_pk_fma_f32 v[168:169], v[168:169], s[58:59], v[8:9] op_sel_hi:[1,1,0] neg_lo:[0,0,1] neg_hi:[0,0,1]
v_mfma_f32_16x16x32_bf16 v[36:39], v[248:251], v[48:51], v[36:39]
ds_read_b64_tr_b16 v[246:247], v4 offset:6144
v_cvt_pk_bf16_f32 v165, v166, v167
v_exp_f32 v178, v178
v_exp_f32 v179, v179
v_pk_fma_f32 v[170:171], v[170:171], s[58:59], v[8:9] op_sel_hi:[1,1,0] neg_lo:[0,0,1] neg_hi:[0,0,1]
s_waitcnt lgkmcnt(6)
v_mfma_f32_16x16x32_bf16 v[28:31], v[232:235], v[64:67], v[28:31]
v_cvt_pk_bf16_f32 v166, v176, v177
v_exp_f32 v168, v168
v_exp_f32 v169, v169
v_pk_fma_f32 v[180:181], v[180:181], s[58:59], v[8:9] op_sel_hi:[1,1,0] neg_lo:[0,0,1] neg_hi:[0,0,1]
v_mfma_f32_16x16x32_bf16 v[32:35], v[232:235], v[68:71], v[32:35]
ds_read_b64_tr_b16 v[248:249], v4 offset:8192
v_cvt_pk_bf16_f32 v167, v178, v179
v_exp_f32 v170, v170
v_exp_f32 v171, v171
v_pk_fma_f32 v[182:183], v[182:183], s[58:59], v[8:9] op_sel_hi:[1,1,0] neg_lo:[0,0,1] neg_hi:[0,0,1]
v_mfma_f32_16x16x32_bf16 v[36:39], v[232:235], v[72:75], v[36:39]
ds_read_b64_tr_b16 v[250:251], v4 offset:10240
v_cvt_pk_bf16_f32 v168, v168, v169
v_exp_f32 v180, v180
v_exp_f32 v181, v181
v_pk_fma_f32 v[184:185], v[184:185], s[58:59], v[0:1] op_sel_hi:[1,1,0] neg_lo:[0,0,1] neg_hi:[0,0,1]
s_waitcnt lgkmcnt(6)
v_mfma_f32_16x16x32_bf16 v[28:31], v[236:239], v[88:91], v[28:31]
v_cvt_pk_bf16_f32 v169, v170, v171
v_exp_f32 v182, v182
v_exp_f32 v183, v183
v_pk_fma_f32 v[186:187], v[186:187], s[58:59], v[0:1] op_sel_hi:[1,1,0] neg_lo:[0,0,1] neg_hi:[0,0,1]
v_mfma_f32_16x16x32_bf16 v[32:35], v[236:239], v[92:95], v[32:35]
ds_read_b64_tr_b16 v[232:233], v4 offset:12288
v_cvt_pk_bf16_f32 v170, v180, v181
v_exp_f32 v184, v184
v_exp_f32 v185, v185
v_pk_fma_f32 v[196:197], v[196:197], s[58:59], v[0:1] op_sel_hi:[1,1,0] neg_lo:[0,0,1] neg_hi:[0,0,1]
v_mfma_f32_16x16x32_bf16 v[36:39], v[236:239], v[96:99], v[36:39]
ds_read_b64_tr_b16 v[234:235], v4 offset:14336
v_cvt_pk_bf16_f32 v171, v182, v183
v_exp_f32 v186, v186
v_exp_f32 v187, v187
v_pk_fma_f32 v[198:199], v[198:199], s[58:59], v[0:1] op_sel_hi:[1,1,0] neg_lo:[0,0,1] neg_hi:[0,0,1]
s_waitcnt lgkmcnt(6)
v_mfma_f32_16x16x32_bf16 v[52:55], v[240:243], v[16:19], 0
v_cvt_pk_bf16_f32 v184, v184, v185
v_exp_f32 v196, v196
v_exp_f32 v197, v197
v_pk_fma_f32 v[188:189], v[188:189], s[58:59], v[14:15] op_sel_hi:[1,1,0] neg_lo:[0,0,1] neg_hi:[0,0,1]
v_mfma_f32_16x16x32_bf16 v[56:59], v[240:243], v[20:23], 0
v_cvt_pk_bf16_f32 v185, v186, v187
v_exp_f32 v198, v198
v_exp_f32 v199, v199
v_pk_fma_f32 v[190:191], v[190:191], s[58:59], v[14:15] op_sel_hi:[1,1,0] neg_lo:[0,0,1] neg_hi:[0,0,1]
v_mfma_f32_16x16x32_bf16 v[60:63], v[240:243], v[24:27], 0
v_cvt_pk_bf16_f32 v186, v196, v197
v_exp_f32 v188, v188
v_exp_f32 v189, v189
v_pk_fma_f32 v[200:201], v[200:201], s[58:59], v[14:15] op_sel_hi:[1,1,0] neg_lo:[0,0,1] neg_hi:[0,0,1]
s_waitcnt lgkmcnt(4)
v_mfma_f32_16x16x32_bf16 v[52:55], v[244:247], v[40:43], v[52:55]
v_cvt_pk_bf16_f32 v187, v198, v199
v_exp_f32 v190, v190
v_exp_f32 v191, v191
v_pk_fma_f32 v[202:203], v[202:203], s[58:59], v[14:15] op_sel_hi:[1,1,0] neg_lo:[0,0,1] neg_hi:[0,0,1]
v_mfma_f32_16x16x32_bf16 v[56:59], v[244:247], v[44:47], v[56:59]
v_cvt_pk_bf16_f32 v188, v188, v189
v_exp_f32 v200, v200
v_exp_f32 v201, v201
v_pk_fma_f32 v[192:193], v[192:193], s[58:59], v[8:9] op_sel_hi:[1,1,0] neg_lo:[0,0,1] neg_hi:[0,0,1]
v_mfma_f32_16x16x32_bf16 v[60:63], v[244:247], v[48:51], v[60:63]
v_cvt_pk_bf16_f32 v189, v190, v191
v_exp_f32 v202, v202
v_exp_f32 v203, v203
v_pk_fma_f32 v[194:195], v[194:195], s[58:59], v[8:9] op_sel_hi:[1,1,0] neg_lo:[0,0,1] neg_hi:[0,0,1]
s_waitcnt lgkmcnt(2)
v_mfma_f32_16x16x32_bf16 v[52:55], v[248:251], v[64:67], v[52:55]
v_cvt_pk_bf16_f32 v190, v200, v201
v_exp_f32 v192, v192
v_exp_f32 v193, v193
v_pk_fma_f32 v[204:205], v[204:205], s[58:59], v[8:9] op_sel_hi:[1,1,0] neg_lo:[0,0,1] neg_hi:[0,0,1]
v_mfma_f32_16x16x32_bf16 v[56:59], v[248:251], v[68:71], v[56:59]
v_cvt_pk_bf16_f32 v191, v202, v203
v_exp_f32 v194, v194
v_exp_f32 v195, v195
v_pk_fma_f32 v[206:207], v[206:207], s[58:59], v[8:9] op_sel_hi:[1,1,0] neg_lo:[0,0,1] neg_hi:[0,0,1]
v_mfma_f32_16x16x32_bf16 v[60:63], v[248:251], v[72:75], v[60:63]
v_cvt_pk_bf16_f32 v192, v192, v193
v_exp_f32 v204, v204
v_exp_f32 v205, v205
s_waitcnt lgkmcnt(0)
v_mfma_f32_16x16x32_bf16 v[52:55], v[232:235], v[88:91], v[52:55]
v_cvt_pk_bf16_f32 v193, v194, v195
v_exp_f32 v206, v206
v_exp_f32 v207, v207
v_mfma_f32_16x16x32_bf16 v[56:59], v[232:235], v[92:95], v[56:59]
v_cvt_pk_bf16_f32 v194, v204, v205
v_mfma_f32_16x16x32_bf16 v[60:63], v[232:235], v[96:99], v[60:63]
v_cvt_pk_bf16_f32 v195, v206, v207
v_and_b32 v3, 0xffff, v3
v_and_b32 v4, 0xffff, v4
v_and_b32 v5, 0xffff, v5
v_and_b32 v6, 0xffff, v6
s_barrier
ds_read_b64_tr_b16 v[172:173], v5 offset:0
ds_read_b64_tr_b16 v[174:175], v5 offset:2048
v_mfma_f32_16x16x32_bf16 v[216:219], v[252:255], v[96:99], v[216:219]
v_mfma_f32_16x16x32_bf16 v[208:211], v[252:255], v[112:115], v[208:211]
ds_read_b64_tr_b16 v[176:177], v5 offset:4096
ds_read_b64_tr_b16 v[178:179], v5 offset:6144
v_mfma_f32_16x16x32_bf16 v[212:215], v[252:255], v[116:119], v[212:215]
v_mfma_f32_16x16x32_bf16 v[216:219], v[252:255], v[120:123], v[216:219]
ds_read_b64_tr_b16 v[180:181], v5 offset:8192
ds_read_b64_tr_b16 v[182:183], v5 offset:10240
v_mfma_f32_16x16x32_bf16 v[208:211], v[252:255], v[136:139], v[208:211]
v_mfma_f32_16x16x32_bf16 v[212:215], v[252:255], v[140:143], v[212:215]
ds_read_b64_tr_b16 v[196:197], v5 offset:12288
ds_read_b64_tr_b16 v[198:199], v5 offset:14336
v_mfma_f32_16x16x32_bf16 v[216:219], v[252:255], v[144:147], v[216:219]
v_mfma_f32_16x16x32_bf16 v[208:211], v[252:255], v[160:163], v[208:211]
ds_read_b64_tr_b16 v[200:201], v6 offset:0
ds_read_b64_tr_b16 v[202:203], v6 offset:2048
v_mfma_f32_16x16x32_bf16 v[212:215], v[252:255], v[164:167], v[212:215]
v_mfma_f32_16x16x32_bf16 v[216:219], v[252:255], v[168:171], v[216:219]
ds_read_b64_tr_b16 v[204:205], v6 offset:4096
ds_read_b64_tr_b16 v[206:207], v6 offset:6144
v_mfma_f32_16x16x32_bf16 v[208:211], v[252:255], v[184:187], v[208:211]
v_mfma_f32_16x16x32_bf16 v[212:215], v[252:255], v[188:191], v[212:215]
ds_read_b64_tr_b16 v[232:233], v6 offset:8192
ds_read_b64_tr_b16 v[234:235], v6 offset:10240
v_mfma_f32_16x16x32_bf16 v[216:219], v[252:255], v[192:195], v[216:219]
ds_read_b64_tr_b16 v[236:237], v6 offset:12288
ds_read_b64_tr_b16 v[238:239], v6 offset:14336
s_waitcnt lgkmcnt(14)
v_mfma_f32_16x16x32_bf16 v[76:79], v[172:175], v[112:115], v[76:79]
v_and_b32 v13, 15, v1
s_waitcnt lgkmcnt(12)
v_mfma_f32_16x16x32_bf16 v[76:79], v[176:179], v[136:139], v[76:79]
v_lshlrev_b32 v13, 3, v13
v_mfma_f32_16x16x32_bf16 v[80:83], v[176:179], v[140:143], v[80:83]
s_mul_i32 s60, s52, 384
v_mfma_f32_16x16x32_bf16 v[80:83], v[172:175], v[116:119], v[80:83]
s_add_u32 s60, s60, 161856
v_mfma_f32_16x16x32_bf16 v[84:87], v[172:175], v[120:123], v[84:87]
ds_read_b64_tr_b16 v[172:173], v3 offset:0
ds_read_b64_tr_b16 v[174:175], v3 offset:2048
v_add_u32 v240, s60, v13
v_mfma_f32_16x16x32_bf16 v[84:87], v[176:179], v[144:147], v[84:87]
ds_read_b64_tr_b16 v[176:177], v3 offset:4096
ds_read_b64_tr_b16 v[178:179], v3 offset:6144
s_xor_b32 s61, s52, 1
s_waitcnt lgkmcnt(14)
v_mfma_f32_16x16x32_bf16 v[76:79], v[180:183], v[160:163], v[76:79]
s_mul_i32 s60, s61, 384
s_waitcnt lgkmcnt(12)
v_mfma_f32_16x16x32_bf16 v[76:79], v[196:199], v[184:187], v[76:79]
s_add_u32 s60, s60, 161856
v_mfma_f32_16x16x32_bf16 v[80:83], v[196:199], v[188:191], v[80:83]
v_add_u32 v241, s60, v13
v_mfma_f32_16x16x32_bf16 v[80:83], v[180:183], v[164:167], v[80:83]
v_lshlrev_b32 v13, 4, v1
v_mfma_f32_16x16x32_bf16 v[84:87], v[180:183], v[168:171], v[84:87]
ds_read_b64_tr_b16 v[180:181], v3 offset:8192
ds_read_b64_tr_b16 v[182:183], v3 offset:10240
s_mul_i32 s60, s52, 6144
v_mfma_f32_16x16x32_bf16 v[84:87], v[196:199], v[192:195], v[84:87]
ds_read_b64_tr_b16 v[196:197], v3 offset:12288
ds_read_b64_tr_b16 v[198:199], v3 offset:14336
s_add_u32 s60, s60, 65536
s_waitcnt lgkmcnt(14)
v_mfma_f32_16x16x32_bf16 v[100:103], v[200:203], v[112:115], v[100:103]
v_add_u32 v242, s60, v13
s_waitcnt lgkmcnt(12)
v_mfma_f32_16x16x32_bf16 v[100:103], v[204:207], v[136:139], v[100:103]
s_mul_i32 s60, s61, 6144
v_mfma_f32_16x16x32_bf16 v[104:107], v[204:207], v[140:143], v[104:107]
s_add_u32 s60, s60, 65536
v_mfma_f32_16x16x32_bf16 v[104:107], v[200:203], v[116:119], v[104:107]
v_add_u32 v243, s60, v13
v_mfma_f32_16x16x32_bf16 v[108:111], v[200:203], v[120:123], v[108:111]
ds_read_b64_tr_b16 v[200:201], v4 offset:0
ds_read_b64_tr_b16 v[202:203], v4 offset:2048
v_mov_b32 v220, v0
v_mfma_f32_16x16x32_bf16 v[108:111], v[204:207], v[144:147], v[108:111]
ds_read_b64_tr_b16 v[204:205], v4 offset:4096
ds_read_b64_tr_b16 v[206:207], v4 offset:6144
v_mov_b32 v221, v208
s_waitcnt lgkmcnt(14)
v_mfma_f32_16x16x32_bf16 v[100:103], v[232:235], v[160:163], v[100:103]
v_mov_b32 v224, v14
s_waitcnt lgkmcnt(12)
v_mfma_f32_16x16x32_bf16 v[100:103], v[236:239], v[184:187], v[100:103]
v_mov_b32 v225, v212
v_mfma_f32_16x16x32_bf16 v[104:107], v[236:239], v[188:191], v[104:107]
v_mov_b32 v228, v8
v_mfma_f32_16x16x32_bf16 v[104:107], v[232:235], v[164:167], v[104:107]
v_mov_b32 v229, v216
v_mfma_f32_16x16x32_bf16 v[108:111], v[232:235], v[168:171], v[108:111]
ds_read_b64_tr_b16 v[232:233], v4 offset:8192
ds_read_b64_tr_b16 v[234:235], v4 offset:10240
v_mfma_f32_16x16x32_bf16 v[108:111], v[236:239], v[192:195], v[108:111]
ds_read_b64_tr_b16 v[236:237], v4 offset:12288
ds_read_b64_tr_b16 v[238:239], v4 offset:14336
s_waitcnt lgkmcnt(14)
v_mfma_f32_16x16x32_bf16 v[28:31], v[172:175], v[112:115], v[28:31]
s_waitcnt lgkmcnt(12)
v_mfma_f32_16x16x32_bf16 v[28:31], v[176:179], v[136:139], v[28:31]
v_mfma_f32_16x16x32_bf16 v[32:35], v[176:179], v[140:143], v[32:35]
s_barrier
ds_write_b128 v242, v[76:79] offset:0
v_mfma_f32_16x16x32_bf16 v[32:35], v[172:175], v[116:119], v[32:35]
v_mfma_f32_16x16x32_bf16 v[36:39], v[172:175], v[120:123], v[36:39]
v_mfma_f32_16x16x32_bf16 v[36:39], v[176:179], v[144:147], v[36:39]
ds_write_b128 v242, v[80:83] offset:1024
s_waitcnt lgkmcnt(12)
v_mfma_f32_16x16x32_bf16 v[28:31], v[180:183], v[160:163], v[28:31]
s_waitcnt lgkmcnt(10)
v_mfma_f32_16x16x32_bf16 v[28:31], v[196:199], v[184:187], v[28:31]
v_mfma_f32_16x16x32_bf16 v[32:35], v[196:199], v[188:191], v[32:35]
ds_write_b128 v242, v[84:87] offset:2048
v_mfma_f32_16x16x32_bf16 v[32:35], v[180:183], v[164:167], v[32:35]
v_mfma_f32_16x16x32_bf16 v[36:39], v[180:183], v[168:171], v[36:39]
v_mfma_f32_16x16x32_bf16 v[36:39], v[196:199], v[192:195], v[36:39]
ds_write_b128 v242, v[100:103] offset:3072
s_waitcnt lgkmcnt(10)
v_mfma_f32_16x16x32_bf16 v[52:55], v[200:203], v[112:115], v[52:55]
s_waitcnt lgkmcnt(8)
v_mfma_f32_16x16x32_bf16 v[52:55], v[204:207], v[136:139], v[52:55]
v_mfma_f32_16x16x32_bf16 v[56:59], v[204:207], v[140:143], v[56:59]
ds_write_b128 v242, v[104:107] offset:4096
v_mfma_f32_16x16x32_bf16 v[56:59], v[200:203], v[116:119], v[56:59]
v_mfma_f32_16x16x32_bf16 v[60:63], v[200:203], v[120:123], v[60:63]
v_mfma_f32_16x16x32_bf16 v[60:63], v[204:207], v[144:147], v[60:63]
ds_write_b128 v242, v[108:111] offset:5120
s_waitcnt lgkmcnt(8)
v_mfma_f32_16x16x32_bf16 v[52:55], v[232:235], v[160:163], v[52:55]
s_waitcnt lgkmcnt(6)
v_mfma_f32_16x16x32_bf16 v[52:55], v[236:239], v[184:187], v[52:55]
v_mfma_f32_16x16x32_bf16 v[56:59], v[236:239], v[188:191], v[56:59]
v_mfma_f32_16x16x32_bf16 v[56:59], v[232:235], v[164:167], v[56:59]
v_mfma_f32_16x16x32_bf16 v[60:63], v[232:235], v[168:171], v[60:63]
v_mfma_f32_16x16x32_bf16 v[60:63], v[236:239], v[192:195], v[60:63]
ds_write_b64 v240, v[220:221] offset:0
ds_write_b64 v240, v[224:225] offset:128
ds_write_b64 v240, v[228:229] offset:256
s_waitcnt lgkmcnt(0)
s_barrier
ds_read_b64 v[222:223], v241 offset:0
ds_read_b64 v[226:227], v241 offset:128
ds_read_b64 v[230:231], v241 offset:256
ds_read_b128 v[124:127], v243 offset:0
ds_read_b128 v[148:151], v243 offset:3072
ds_read_b128 v[128:131], v243 offset:1024
ds_read_b128 v[152:155], v243 offset:4096
ds_read_b128 v[132:135], v243 offset:2048
ds_read_b128 v[156:159], v243 offset:5120
s_waitcnt lgkmcnt(8)
v_max_f32 v209, v222, v220
s_waitcnt lgkmcnt(7)
v_max_f32 v213, v226, v224
s_waitcnt lgkmcnt(6)
v_max_f32 v217, v230, v228
v_sub_f32 v208, v220, v209
v_sub_f32 v212, v224, v213
v_sub_f32 v216, v228, v217
v_sub_f32 v210, v222, v209
v_sub_f32 v214, v226, v213
v_sub_f32 v218, v230, v217
v_exp_f32 v208, v208
v_exp_f32 v212, v212
v_exp_f32 v216, v216
v_exp_f32 v210, v210
v_exp_f32 v214, v214
v_exp_f32 v218, v218
v_mul_f32 v209, v208, v221
v_mul_f32 v213, v212, v225
v_mul_f32 v217, v216, v229
v_fmac_f32 v209, v210, v223
v_fmac_f32 v213, v214, v227
v_fmac_f32 v217, v218, v231
v_rcp_f32 v209, v209
v_rcp_f32 v213, v213
v_rcp_f32 v217, v217
v_mul_f32 v208, v208, v209
v_mul_f32 v212, v212, v213
v_mul_f32 v216, v216, v217
v_mul_f32 v210, v210, v209
v_mul_f32 v214, v214, v213
v_mul_f32 v218, v218, v217
v_pk_mul_f32 v[28:29], v[28:29], v[208:209] op_sel_hi:[1,0]
v_pk_mul_f32 v[30:31], v[30:31], v[208:209] op_sel_hi:[1,0]
v_pk_mul_f32 v[32:33], v[32:33], v[212:213] op_sel_hi:[1,0]
v_pk_mul_f32 v[34:35], v[34:35], v[212:213] op_sel_hi:[1,0]
v_pk_mul_f32 v[36:37], v[36:37], v[216:217] op_sel_hi:[1,0]
v_pk_mul_f32 v[38:39], v[38:39], v[216:217] op_sel_hi:[1,0]
v_pk_mul_f32 v[52:53], v[52:53], v[208:209] op_sel_hi:[1,0]
v_pk_mul_f32 v[54:55], v[54:55], v[208:209] op_sel_hi:[1,0]
v_pk_mul_f32 v[56:57], v[56:57], v[212:213] op_sel_hi:[1,0]
v_pk_mul_f32 v[58:59], v[58:59], v[212:213] op_sel_hi:[1,0]
v_pk_mul_f32 v[60:61], v[60:61], v[216:217] op_sel_hi:[1,0]
v_pk_mul_f32 v[62:63], v[62:63], v[216:217] op_sel_hi:[1,0]
s_waitcnt lgkmcnt(5)
v_pk_fma_f32 v[28:29], v[124:125], v[210:211], v[28:29] op_sel_hi:[1,0,1]
v_pk_fma_f32 v[30:31], v[126:127], v[210:211], v[30:31] op_sel_hi:[1,0,1]
v_cvt_pk_bf16_f32 v28, v28, v29
v_cvt_pk_bf16_f32 v29, v30, v31
s_waitcnt lgkmcnt(4)
v_pk_fma_f32 v[52:53], v[148:149], v[210:211], v[52:53] op_sel_hi:[1,0,1]
v_pk_fma_f32 v[54:55], v[150:151], v[210:211], v[54:55] op_sel_hi:[1,0,1]
v_cvt_pk_bf16_f32 v30, v52, v53
v_cvt_pk_bf16_f32 v31, v54, v55
ds_write_b128 v243, v[28:31] offset:0
s_waitcnt lgkmcnt(4)
v_pk_fma_f32 v[32:33], v[128:129], v[214:215], v[32:33] op_sel_hi:[1,0,1]
v_pk_fma_f32 v[34:35], v[130:131], v[214:215], v[34:35] op_sel_hi:[1,0,1]
v_cvt_pk_bf16_f32 v32, v32, v33
v_cvt_pk_bf16_f32 v33, v34, v35
s_waitcnt lgkmcnt(3)
v_pk_fma_f32 v[56:57], v[152:153], v[214:215], v[56:57] op_sel_hi:[1,0,1]
v_pk_fma_f32 v[58:59], v[154:155], v[214:215], v[58:59] op_sel_hi:[1,0,1]
v_cvt_pk_bf16_f32 v34, v56, v57
v_cvt_pk_bf16_f32 v35, v58, v59
ds_write_b128 v243, v[32:35] offset:1024
s_waitcnt lgkmcnt(3)
v_pk_fma_f32 v[36:37], v[132:133], v[218:219], v[36:37] op_sel_hi:[1,0,1]
v_pk_fma_f32 v[38:39], v[134:135], v[218:219], v[38:39] op_sel_hi:[1,0,1]
v_cvt_pk_bf16_f32 v36, v36, v37
v_cvt_pk_bf16_f32 v37, v38, v39
s_waitcnt lgkmcnt(2)
v_pk_fma_f32 v[60:61], v[156:157], v[218:219], v[60:61] op_sel_hi:[1,0,1]
v_pk_fma_f32 v[62:63], v[158:159], v[218:219], v[62:63] op_sel_hi:[1,0,1]
v_cvt_pk_bf16_f32 v38, v60, v61
v_cvt_pk_bf16_f32 v39, v62, v63
ds_write_b128 v243, v[36:39] offset:2048
s_waitcnt lgkmcnt(0)
s_barrier
s_lshl_b32 s61, s55, 3
v_mov_b32 v13, s61
s_cmp_lg_u32 s52, 0
s_cbranch_scc1 L_ib3
s_mov_b64 exec, 1
L_ib4:
s_waitcnt vmcnt(0)
v_cmp_eq_u32 vcc, 0, v10
s_cbranch_vccz L_ib5
s_sleep 4
buffer_load_dword v10, v13, s[44:47], 0 offen sc1
s_sub_u32 s57, s57, 1
s_cbranch_scc1 L_end
s_branch L_ib4
L_ib5:
s_mov_b64 exec, -1
L_ib3:
s_barrier
ds_read_b64_tr_b16 v[172:173], v5 offset:32768
ds_read_b64_tr_b16 v[174:175], v5 offset:34816
ds_read_b64_tr_b16 v[176:177], v5 offset:36864
ds_read_b64_tr_b16 v[178:179], v5 offset:38912
ds_read_b64_tr_b16 v[180:181], v5 offset:40960
ds_read_b64_tr_b16 v[182:183], v5 offset:43008
ds_read_b64_tr_b16 v[196:197], v5 offset:45056
ds_read_b64_tr_b16 v[198:199], v5 offset:47104
ds_read_b64_tr_b16 v[200:201], v6 offset:32768
ds_read_b64_tr_b16 v[202:203], v6 offset:34816
ds_read_b64_tr_b16 v[204:205], v6 offset:36864
ds_read_b64_tr_b16 v[206:207], v6 offset:38912
ds_read_b64_tr_b16 v[232:233], v6 offset:40960
ds_read_b64_tr_b16 v[234:235], v6 offset:43008
ds_read_b64_tr_b16 v[236:237], v6 offset:45056
ds_read_b64_tr_b16 v[238:239], v6 offset:47104
s_waitcnt lgkmcnt(14)
v_mfma_f32_16x16x32_bf16 v[76:79], v[172:175], v[16:19], 0
s_waitcnt lgkmcnt(12)
v_mfma_f32_16x16x32_bf16 v[76:79], v[176:179], v[40:43], v[76:79]
v_mfma_f32_16x16x32_bf16 v[80:83], v[176:179], v[44:47], 0
v_mfma_f32_16x16x32_bf16 v[80:83], v[172:175], v[20:23], v[80:83]
v_mfma_f32_16x16x32_bf16 v[84:87], v[172:175], v[24:27], 0
ds_read_b64_tr_b16 v[172:173], v3 offset:32768
ds_read_b64_tr_b16 v[174:175], v3 offset:34816
v_mfma_f32_16x16x32_bf16 v[84:87], v[176:179], v[48:51], v[84:87]
ds_read_b64_tr_b16 v[176:177], v3 offset:36864
ds_read_b64_tr_b16 v[178:179], v3 offset:38912
s_waitcnt lgkmcnt(14)
v_mfma_f32_16x16x32_bf16 v[76:79], v[180:183], v[64:67], v[76:79]
s_waitcnt lgkmcnt(12)
v_mfma_f32_16x16x32_bf16 v[76:79], v[196:199], v[88:91], v[76:79]
v_mfma_f32_16x16x32_bf16 v[80:83], v[196:199], v[92:95], v[80:83]
v_mfma_f32_16x16x32_bf16 v[80:83], v[180:183], v[68:71], v[80:83]
v_mfma_f32_16x16x32_bf16 v[84:87], v[180:183], v[72:75], v[84:87]
ds_read_b64_tr_b16 v[180:181], v3 offset:40960
ds_read_b64_tr_b16 v[182:183], v3 offset:43008
v_mfma_f32_16x16x32_bf16 v[84:87], v[196:199], v[96:99], v[84:87]
ds_read_b64_tr_b16 v[196:197], v3 offset:45056
ds_read_b64_tr_b16 v[198:199], v3 offset:47104
s_waitcnt lgkmcnt(14)
v_mfma_f32_16x16x32_bf16 v[100:103], v[200:203], v[16:19], 0
s_waitcnt lgkmcnt(12)
v_mfma_f32_16x16x32_bf16 v[100:103], v[204:207], v[40:43], v[100:103]
v_mfma_f32_16x16x32_bf16 v[104:107], v[204:207], v[44:47], 0
s_barrier
v_mfma_f32_16x16x32_bf16 v[104:107], v[200:203], v[20:23], v[104:107]
v_mfma_f32_16x16x32_bf16 v[108:111], v[200:203], v[24:27], 0
ds_read_b64_tr_b16 v[200:201], v4 offset:32768
ds_read_b64_tr_b16 v[202:203], v4 offset:34816
v_mfma_f32_16x16x32_bf16 v[108:111], v[204:207], v[48:51], v[108:111]
ds_read_b64_tr_b16 v[204:205], v4 offset:36864
ds_read_b64_tr_b16 v[206:207], v4 offset:38912
s_waitcnt lgkmcnt(14)
v_mfma_f32_16x16x32_bf16 v[100:103], v[232:235], v[64:67], v[100:103]
s_waitcnt lgkmcnt(12)
v_mfma_f32_16x16x32_bf16 v[100:103], v[236:239], v[88:91], v[100:103]
v_mfma_f32_16x16x32_bf16 v[104:107], v[236:239], v[92:95], v[104:107]
v_mfma_f32_16x16x32_bf16 v[104:107], v[232:235], v[68:71], v[104:107]
v_mfma_f32_16x16x32_bf16 v[108:111], v[232:235], v[72:75], v[108:111]
ds_read_b64_tr_b16 v[232:233], v4 offset:40960
ds_read_b64_tr_b16 v[234:235], v4 offset:43008
v_mfma_f32_16x16x32_bf16 v[108:111], v[236:239], v[96:99], v[108:111]
ds_read_b64_tr_b16 v[236:237], v4 offset:45056
ds_read_b64_tr_b16 v[238:239], v4 offset:47104
s_waitcnt lgkmcnt(14)
v_mfma_f32_16x16x32_bf16 v[28:31], v[172:175], v[16:19], 0
s_waitcnt lgkmcnt(12)
v_mfma_f32_16x16x32_bf16 v[28:31], v[176:179], v[40:43], v[28:31]
v_mfma_f32_16x16x32_bf16 v[32:35], v[176:179], v[44:47], 0
v_mfma_f32_16x16x32_bf16 v[32:35], v[172:175], v[20:23], v[32:35]
v_mfma_f32_16x16x32_bf16 v[36:39], v[172:175], v[24:27], 0
v_mfma_f32_16x16x32_bf16 v[36:39], v[176:179], v[48:51], v[36:39]
s_waitcnt lgkmcnt(10)
v_mfma_f32_16x16x32_bf16 v[28:31], v[180:183], v[64:67], v[28:31]
s_waitcnt lgkmcnt(8)
v_mfma_f32_16x16x32_bf16 v[28:31], v[196:199], v[88:91], v[28:31]
v_mfma_f32_16x16x32_bf16 v[32:35], v[196:199], v[92:95], v[32:35]
s_barrier
v_mfma_f32_16x16x32_bf16 v[32:35], v[180:183], v[68:71], v[32:35]
v_mfma_f32_16x16x32_bf16 v[36:39], v[180:183], v[72:75], v[36:39]
v_mfma_f32_16x16x32_bf16 v[36:39], v[196:199], v[96:99], v[36:39]
s_waitcnt lgkmcnt(6)
v_mfma_f32_16x16x32_bf16 v[52:55], v[200:203], v[16:19], 0
s_waitcnt lgkmcnt(4)
v_mfma_f32_16x16x32_bf16 v[52:55], v[204:207], v[40:43], v[52:55]
v_mfma_f32_16x16x32_bf16 v[56:59], v[204:207], v[44:47], 0
v_mfma_f32_16x16x32_bf16 v[56:59], v[200:203], v[20:23], v[56:59]
v_mfma_f32_16x16x32_bf16 v[60:63], v[200:203], v[24:27], 0
v_mfma_f32_16x16x32_bf16 v[60:63], v[204:207], v[48:51], v[60:63]
s_waitcnt lgkmcnt(2)
v_mfma_f32_16x16x32_bf16 v[52:55], v[232:235], v[64:67], v[52:55]
s_waitcnt lgkmcnt(0)
v_mfma_f32_16x16x32_bf16 v[52:55], v[236:239], v[88:91], v[52:55]
v_mfma_f32_16x16x32_bf16 v[56:59], v[236:239], v[92:95], v[56:59]
v_mfma_f32_16x16x32_bf16 v[56:59], v[232:235], v[68:71], v[56:59]
v_mfma_f32_16x16x32_bf16 v[60:63], v[232:235], v[72:75], v[60:63]
v_mfma_f32_16x16x32_bf16 v[60:63], v[236:239], v[96:99], v[60:63]
s_barrier
ds_read_b64_tr_b16 v[172:173], v5 offset:0
ds_read_b64_tr_b16 v[174:175], v5 offset:2048
ds_read_b64_tr_b16 v[176:177], v5 offset:4096
ds_read_b64_tr_b16 v[178:179], v5 offset:6144
ds_read_b64_tr_b16 v[180:181], v5 offset:8192
ds_read_b64_tr_b16 v[182:183], v5 offset:10240
ds_read_b64_tr_b16 v[196:197], v5 offset:12288
ds_read_b64_tr_b16 v[198:199], v5 offset:14336
ds_read_b64_tr_b16 v[200:201], v6 offset:0
ds_read_b64_tr_b16 v[202:203], v6 offset:2048
ds_read_b64_tr_b16 v[204:205], v6 offset:4096
ds_read_b64_tr_b16 v[206:207], v6 offset:6144
ds_read_b64_tr_b16 v[232:233], v6 offset:8192
ds_read_b64_tr_b16 v[234:235], v6 offset:10240
ds_read_b64_tr_b16 v[236:237], v6 offset:12288
ds_read_b64_tr_b16 v[238:239], v6 offset:14336
s_waitcnt lgkmcnt(14)
v_mfma_f32_16x16x32_bf16 v[76:79], v[172:175], v[112:115], v[76:79]
s_waitcnt lgkmcnt(12)
v_mfma_f32_16x16x32_bf16 v[76:79], v[176:179], v[136:139], v[76:79]
v_mfma_f32_16x16x32_bf16 v[80:83], v[176:179], v[140:143], v[80:83]
v_mfma_f32_16x16x32_bf16 v[80:83], v[172:175], v[116:119], v[80:83]
v_mfma_f32_16x16x32_bf16 v[84:87], v[172:175], v[120:123], v[84:87]
ds_read_b64_tr_b16 v[172:173], v3 offset:0
ds_read_b64_tr_b16 v[174:175], v3 offset:2048
v_mfma_f32_16x16x32_bf16 v[84:87], v[176:179], v[144:147], v[84:87]
ds_read_b64_tr_b16 v[176:177], v3 offset:4096
ds_read_b64_tr_b16 v[178:179], v3 offset:6144
s_waitcnt lgkmcnt(14)
v_mfma_f32_16x16x32_bf16 v[76:79], v[180:183], v[160:163], v[76:79]
s_waitcnt lgkmcnt(12)
v_mfma_f32_16x16x32_bf16 v[76:79], v[196:199], v[184:187], v[76:79]
v_mfma_f32_16x16x32_bf16 v[80:83], v[196:199], v[188:191], v[80:83]
v_mfma_f32_16x16x32_bf16 v[80:83], v[180:183], v[164:167], v[80:83]
v_mfma_f32_16x16x32_bf16 v[84:87], v[180:183], v[168:171], v[84:87]
ds_read_b64_tr_b16 v[180:181], v3 offset:8192
ds_read_b64_tr_b16 v[182:183], v3 offset:10240
v_mfma_f32_16x16x32_bf16 v[84:87], v[196:199], v[192:195], v[84:87]
ds_read_b64_tr_b16 v[196:197], v3 offset:12288
ds_read_b64_tr_b16 v[198:199], v3 offset:14336
s_waitcnt lgkmcnt(14)
v_mfma_f32_16x16x32_bf16 v[100:103], v[200:203], v[112:115], v[100:103]
s_waitcnt lgkmcnt(12)
v_mfma_f32_16x16x32_bf16 v[100:103], v[204:207], v[136:139], v[100:103]
v_mfma_f32_16x16x32_bf16 v[104:107], v[204:207], v[140:143], v[104:107]
v_mfma_f32_16x16x32_bf16 v[104:107], v[200:203], v[116:119], v[104:107]
v_mfma_f32_16x16x32_bf16 v[108:111], v[200:203], v[120:123], v[108:111]
ds_read_b64_tr_b16 v[200:201], v4 offset:0
ds_read_b64_tr_b16 v[202:203], v4 offset:2048
v_mfma_f32_16x16x32_bf16 v[108:111], v[204:207], v[144:147], v[108:111]
ds_read_b64_tr_b16 v[204:205], v4 offset:4096
ds_read_b64_tr_b16 v[206:207], v4 offset:6144
s_waitcnt lgkmcnt(14)
v_mfma_f32_16x16x32_bf16 v[100:103], v[232:235], v[160:163], v[100:103]
s_waitcnt lgkmcnt(12)
v_mfma_f32_16x16x32_bf16 v[100:103], v[236:239], v[184:187], v[100:103]
v_mfma_f32_16x16x32_bf16 v[104:107], v[236:239], v[188:191], v[104:107]
v_mfma_f32_16x16x32_bf16 v[104:107], v[232:235], v[164:167], v[104:107]
v_mfma_f32_16x16x32_bf16 v[108:111], v[232:235], v[168:171], v[108:111]
ds_read_b64_tr_b16 v[232:233], v4 offset:8192
ds_read_b64_tr_b16 v[234:235], v4 offset:10240
v_mfma_f32_16x16x32_bf16 v[108:111], v[236:239], v[192:195], v[108:111]
ds_read_b64_tr_b16 v[236:237], v4 offset:12288
ds_read_b64_tr_b16 v[238:239], v4 offset:14336
s_waitcnt lgkmcnt(14)
v_mfma_f32_16x16x32_bf16 v[28:31], v[172:175], v[112:115], v[28:31]
s_waitcnt lgkmcnt(12)
v_mfma_f32_16x16x32_bf16 v[28:31], v[176:179], v[136:139], v[28:31]
v_mfma_f32_16x16x32_bf16 v[32:35], v[176:179], v[140:143], v[32:35]
s_barrier
ds_write_b128 v242, v[76:79] offset:0
v_mfma_f32_16x16x32_bf16 v[32:35], v[172:175], v[116:119], v[32:35]
v_mfma_f32_16x16x32_bf16 v[36:39], v[172:175], v[120:123], v[36:39]
v_mfma_f32_16x16x32_bf16 v[36:39], v[176:179], v[144:147], v[36:39]
ds_write_b128 v242, v[80:83] offset:1024
s_waitcnt lgkmcnt(12)
v_mfma_f32_16x16x32_bf16 v[28:31], v[180:183], v[160:163], v[28:31]
s_waitcnt lgkmcnt(10)
v_mfma_f32_16x16x32_bf16 v[28:31], v[196:199], v[184:187], v[28:31]
v_mfma_f32_16x16x32_bf16 v[32:35], v[196:199], v[188:191], v[32:35]
ds_write_b128 v242, v[84:87] offset:2048
v_mfma_f32_16x16x32_bf16 v[32:35], v[180:183], v[164:167], v[32:35]
v_mfma_f32_16x16x32_bf16 v[36:39], v[180:183], v[168:171], v[36:39]
v_mfma_f32_16x16x32_bf16 v[36:39], v[196:199], v[192:195], v[36:39]
ds_write_b128 v242, v[100:103] offset:3072
s_waitcnt lgkmcnt(10)
v_mfma_f32_16x16x32_bf16 v[52:55], v[200:203], v[112:115], v[52:55]
s_waitcnt lgkmcnt(8)
v_mfma_f32_16x16x32_bf16 v[52:55], v[204:207], v[136:139], v[52:55]
v_mfma_f32_16x16x32_bf16 v[56:59], v[204:207], v[140:143], v[56:59]
ds_write_b128 v242, v[104:107] offset:4096
v_mfma_f32_16x16x32_bf16 v[56:59], v[200:203], v[116:119], v[56:59]
v_mfma_f32_16x16x32_bf16 v[60:63], v[200:203], v[120:123], v[60:63]
v_mfma_f32_16x16x32_bf16 v[60:63], v[204:207], v[144:147], v[60:63]
ds_write_b128 v242, v[108:111] offset:5120
s_waitcnt lgkmcnt(8)
v_mfma_f32_16x16x32_bf16 v[52:55], v[232:235], v[160:163], v[52:55]
s_waitcnt lgkmcnt(6)
v_mfma_f32_16x16x32_bf16 v[52:55], v[236:239], v[184:187], v[52:55]
v_mfma_f32_16x16x32_bf16 v[56:59], v[236:239], v[188:191], v[56:59]
v_mfma_f32_16x16x32_bf16 v[56:59], v[232:235], v[164:167], v[56:59]
v_mfma_f32_16x16x32_bf16 v[60:63], v[232:235], v[168:171], v[60:63]
v_mfma_f32_16x16x32_bf16 v[60:63], v[236:239], v[192:195], v[60:63]
v_pk_mul_f32 v[28:29], v[28:29], v[208:209] op_sel_hi:[1,0]
v_pk_mul_f32 v[30:31], v[30:31], v[208:209] op_sel_hi:[1,0]
v_pk_mul_f32 v[32:33], v[32:33], v[212:213] op_sel_hi:[1,0]
v_pk_mul_f32 v[34:35], v[34:35], v[212:213] op_sel_hi:[1,0]
v_pk_mul_f32 v[36:37], v[36:37], v[216:217] op_sel_hi:[1,0]
v_pk_mul_f32 v[38:39], v[38:39], v[216:217] op_sel_hi:[1,0]
v_pk_mul_f32 v[52:53], v[52:53], v[208:209] op_sel_hi:[1,0]
v_pk_mul_f32 v[54:55], v[54:55], v[208:209] op_sel_hi:[1,0]
v_pk_mul_f32 v[56:57], v[56:57], v[212:213] op_sel_hi:[1,0]
v_pk_mul_f32 v[58:59], v[58:59], v[212:213] op_sel_hi:[1,0]
v_pk_mul_f32 v[60:61], v[60:61], v[216:217] op_sel_hi:[1,0]
v_pk_mul_f32 v[62:63], v[62:63], v[216:217] op_sel_hi:[1,0]
s_waitcnt lgkmcnt(0)
s_barrier
ds_read_b128 v[124:127], v243 offset:0
ds_read_b128 v[148:151], v243 offset:3072
ds_read_b128 v[128:131], v243 offset:1024
ds_read_b128 v[152:155], v243 offset:4096
ds_read_b128 v[132:135], v243 offset:2048
ds_read_b128 v[156:159], v243 offset:5120
s_waitcnt lgkmcnt(5)
v_pk_fma_f32 v[28:29], v[124:125], v[210:211], v[28:29] op_sel_hi:[1,0,1]
v_pk_fma_f32 v[30:31], v[126:127], v[210:211], v[30:31] op_sel_hi:[1,0,1]
v_cvt_pk_bf16_f32 v28, v28, v29
v_cvt_pk_bf16_f32 v29, v30, v31
s_waitcnt lgkmcnt(4)
v_pk_fma_f32 v[52:53], v[148:149], v[210:211], v[52:53] op_sel_hi:[1,0,1]
v_pk_fma_f32 v[54:55], v[150:151], v[210:211], v[54:55] op_sel_hi:[1,0,1]
v_cvt_pk_bf16_f32 v30, v52, v53
v_cvt_pk_bf16_f32 v31, v54, v55
ds_write_b128 v243, v[28:31] offset:0
s_waitcnt lgkmcnt(4)
v_pk_fma_f32 v[32:33], v[128:129], v[214:215], v[32:33] op_sel_hi:[1,0,1]
v_pk_fma_f32 v[34:35], v[130:131], v[214:215], v[34:35] op_sel_hi:[1,0,1]
v_cvt_pk_bf16_f32 v32, v32, v33
v_cvt_pk_bf16_f32 v33, v34, v35
s_waitcnt lgkmcnt(3)
v_pk_fma_f32 v[56:57], v[152:153], v[214:215], v[56:57] op_sel_hi:[1,0,1]
v_pk_fma_f32 v[58:59], v[154:155], v[214:215], v[58:59] op_sel_hi:[1,0,1]
v_cvt_pk_bf16_f32 v34, v56, v57
v_cvt_pk_bf16_f32 v35, v58, v59
ds_write_b128 v243, v[32:35] offset:1024
s_waitcnt lgkmcnt(3)
v_pk_fma_f32 v[36:37], v[132:133], v[218:219], v[36:37] op_sel_hi:[1,0,1]
v_pk_fma_f32 v[38:39], v[134:135], v[218:219], v[38:39] op_sel_hi:[1,0,1]
v_cvt_pk_bf16_f32 v36, v36, v37
v_cvt_pk_bf16_f32 v37, v38, v39
s_waitcnt lgkmcnt(2)
v_pk_fma_f32 v[60:61], v[156:157], v[218:219], v[60:61] op_sel_hi:[1,0,1]
v_pk_fma_f32 v[62:63], v[158:159], v[218:219], v[62:63] op_sel_hi:[1,0,1]
v_cvt_pk_bf16_f32 v38, v60, v61
v_cvt_pk_bf16_f32 v39, v62, v63
ds_write_b128 v243, v[36:39] offset:2048
s_waitcnt lgkmcnt(0)
s_barrier
s_barrier
ds_read_b64_tr_b16 v[172:173], v5 offset:32768
ds_read_b64_tr_b16 v[174:175], v5 offset:34816
ds_read_b64_tr_b16 v[176:177], v5 offset:36864
ds_read_b64_tr_b16 v[178:179], v5 offset:38912
ds_read_b64_tr_b16 v[180:181], v5 offset:40960
ds_read_b64_tr_b16 v[182:183], v5 offset:43008
ds_read_b64_tr_b16 v[196:197], v5 offset:45056
ds_read_b64_tr_b16 v[198:199], v5 offset:47104
ds_read_b64_tr_b16 v[200:201], v6 offset:32768
ds_read_b64_tr_b16 v[202:203], v6 offset:34816
ds_read_b64_tr_b16 v[204:205], v6 offset:36864
ds_read_b64_tr_b16 v[206:207], v6 offset:38912
ds_read_b64_tr_b16 v[232:233], v6 offset:40960
ds_read_b64_tr_b16 v[234:235], v6 offset:43008
ds_read_b64_tr_b16 v[236:237], v6 offset:45056
ds_read_b64_tr_b16 v[238:239], v6 offset:47104
s_waitcnt lgkmcnt(14)
v_mfma_f32_16x16x32_bf16 v[76:79], v[172:175], v[16:19], 0
s_waitcnt lgkmcnt(12)
v_mfma_f32_16x16x32_bf16 v[76:79], v[176:179], v[40:43], v[76:79]
v_mfma_f32_16x16x32_bf16 v[80:83], v[176:179], v[44:47], 0
v_mfma_f32_16x16x32_bf16 v[80:83], v[172:175], v[20:23], v[80:83]
v_mfma_f32_16x16x32_bf16 v[84:87], v[172:175], v[24:27], 0
ds_read_b64_tr_b16 v[172:173], v3 offset:32768
ds_read_b64_tr_b16 v[174:175], v3 offset:34816
v_mfma_f32_16x16x32_bf16 v[84:87], v[176:179], v[48:51], v[84:87]
ds_read_b64_tr_b16 v[176:177], v3 offset:36864
ds_read_b64_tr_b16 v[178:179], v3 offset:38912
s_waitcnt lgkmcnt(14)
v_mfma_f32_16x16x32_bf16 v[76:79], v[180:183], v[64:67], v[76:79]
s_waitcnt lgkmcnt(12)
v_mfma_f32_16x16x32_bf16 v[76:79], v[196:199], v[88:91], v[76:79]
v_mfma_f32_16x16x32_bf16 v[80:83], v[196:199], v[92:95], v[80:83]
v_mfma_f32_16x16x32_bf16 v[80:83], v[180:183], v[68:71], v[80:83]
v_mfma_f32_16x16x32_bf16 v[84:87], v[180:183], v[72:75], v[84:87]
ds_read_b64_tr_b16 v[180:181], v3 offset:40960
ds_read_b64_tr_b16 v[182:183], v3 offset:43008
v_mfma_f32_16x16x32_bf16 v[84:87], v[196:199], v[96:99], v[84:87]
ds_read_b64_tr_b16 v[196:197], v3 offset:45056
ds_read_b64_tr_b16 v[198:199], v3 offset:47104
s_waitcnt lgkmcnt(14)
v_mfma_f32_16x16x32_bf16 v[100:103], v[200:203], v[16:19], 0
s_waitcnt lgkmcnt(12)
v_mfma_f32_16x16x32_bf16 v[100:103], v[204:207], v[40:43], v[100:103]
v_mfma_f32_16x16x32_bf16 v[104:107], v[204:207], v[44:47], 0
s_barrier
v_mfma_f32_16x16x32_bf16 v[104:107], v[200:203], v[20:23], v[104:107]
v_mfma_f32_16x16x32_bf16 v[108:111], v[200:203], v[24:27], 0
ds_read_b64_tr_b16 v[200:201], v4 offset:32768
ds_read_b64_tr_b16 v[202:203], v4 offset:34816
v_mfma_f32_16x16x32_bf16 v[108:111], v[204:207], v[48:51], v[108:111]
ds_read_b64_tr_b16 v[204:205], v4 offset:36864
ds_read_b64_tr_b16 v[206:207], v4 offset:38912
s_waitcnt lgkmcnt(14)
v_mfma_f32_16x16x32_bf16 v[100:103], v[232:235], v[64:67], v[100:103]
s_waitcnt lgkmcnt(12)
v_mfma_f32_16x16x32_bf16 v[100:103], v[236:239], v[88:91], v[100:103]
v_mfma_f32_16x16x32_bf16 v[104:107], v[236:239], v[92:95], v[104:107]
v_mfma_f32_16x16x32_bf16 v[104:107], v[232:235], v[68:71], v[104:107]
v_mfma_f32_16x16x32_bf16 v[108:111], v[232:235], v[72:75], v[108:111]
ds_read_b64_tr_b16 v[232:233], v4 offset:40960
ds_read_b64_tr_b16 v[234:235], v4 offset:43008
v_mfma_f32_16x16x32_bf16 v[108:111], v[236:239], v[96:99], v[108:111]
ds_read_b64_tr_b16 v[236:237], v4 offset:45056
ds_read_b64_tr_b16 v[238:239], v4 offset:47104
s_waitcnt lgkmcnt(14)
v_mfma_f32_16x16x32_bf16 v[28:31], v[172:175], v[16:19], 0
s_waitcnt lgkmcnt(12)
v_mfma_f32_16x16x32_bf16 v[28:31], v[176:179], v[40:43], v[28:31]
v_mfma_f32_16x16x32_bf16 v[32:35], v[176:179], v[44:47], 0
v_mfma_f32_16x16x32_bf16 v[32:35], v[172:175], v[20:23], v[32:35]
v_mfma_f32_16x16x32_bf16 v[36:39], v[172:175], v[24:27], 0
v_mfma_f32_16x16x32_bf16 v[36:39], v[176:179], v[48:51], v[36:39]
s_waitcnt lgkmcnt(10)
v_mfma_f32_16x16x32_bf16 v[28:31], v[180:183], v[64:67], v[28:31]
s_waitcnt lgkmcnt(8)
v_mfma_f32_16x16x32_bf16 v[28:31], v[196:199], v[88:91], v[28:31]
v_mfma_f32_16x16x32_bf16 v[32:35], v[196:199], v[92:95], v[32:35]
s_barrier
v_mfma_f32_16x16x32_bf16 v[32:35], v[180:183], v[68:71], v[32:35]
v_mfma_f32_16x16x32_bf16 v[36:39], v[180:183], v[72:75], v[36:39]
v_mfma_f32_16x16x32_bf16 v[36:39], v[196:199], v[96:99], v[36:39]
s_waitcnt lgkmcnt(6)
v_mfma_f32_16x16x32_bf16 v[52:55], v[200:203], v[16:19], 0
s_waitcnt lgkmcnt(4)
v_mfma_f32_16x16x32_bf16 v[52:55], v[204:207], v[40:43], v[52:55]
v_mfma_f32_16x16x32_bf16 v[56:59], v[204:207], v[44:47], 0
v_mfma_f32_16x16x32_bf16 v[56:59], v[200:203], v[20:23], v[56:59]
v_mfma_f32_16x16x32_bf16 v[60:63], v[200:203], v[24:27], 0
v_mfma_f32_16x16x32_bf16 v[60:63], v[204:207], v[48:51], v[60:63]
s_waitcnt lgkmcnt(2)
v_mfma_f32_16x16x32_bf16 v[52:55], v[232:235], v[64:67], v[52:55]
s_waitcnt lgkmcnt(0)
v_mfma_f32_16x16x32_bf16 v[52:55], v[236:239], v[88:91], v[52:55]
v_mfma_f32_16x16x32_bf16 v[56:59], v[236:239], v[92:95], v[56:59]
v_mfma_f32_16x16x32_bf16 v[56:59], v[232:235], v[68:71], v[56:59]
v_mfma_f32_16x16x32_bf16 v[60:63], v[232:235], v[72:75], v[60:63]
v_mfma_f32_16x16x32_bf16 v[60:63], v[236:239], v[96:99], v[60:63]
s_lshl_b32 s60, s55, 7
s_add_u32 s60, s60, s3
v_mov_b32 v10, s60
s_lshl_b32 s60, s3, 2
v_lshl_add_u32 v12, v1, 7, s60
v_mov_b32 v13, 1
s_barrier
ds_read_b64_tr_b16 v[172:173], v5 offset:0
ds_read_b64_tr_b16 v[174:175], v5 offset:2048
ds_read_b64_tr_b16 v[176:177], v5 offset:4096
ds_read_b64_tr_b16 v[178:179], v5 offset:6144
ds_read_b64_tr_b16 v[180:181], v5 offset:8192
ds_read_b64_tr_b16 v[182:183], v5 offset:10240
ds_read_b64_tr_b16 v[196:197], v5 offset:12288
ds_read_b64_tr_b16 v[198:199], v5 offset:14336
ds_read_b64_tr_b16 v[200:201], v6 offset:0
ds_read_b64_tr_b16 v[202:203], v6 offset:2048
ds_read_b64_tr_b16 v[204:205], v6 offset:4096
ds_read_b64_tr_b16 v[206:207], v6 offset:6144
ds_read_b64_tr_b16 v[232:233], v6 offset:8192
ds_read_b64_tr_b16 v[234:235], v6 offset:10240
ds_read_b64_tr_b16 v[236:237], v6 offset:12288
ds_read_b64_tr_b16 v[238:239], v6 offset:14336
s_waitcnt lgkmcnt(14)
v_mfma_f32_16x16x32_bf16 v[76:79], v[172:175], v[112:115], v[76:79]
s_waitcnt lgkmcnt(12)
v_mfma_f32_16x16x32_bf16 v[76:79], v[176:179], v[136:139], v[76:79]
v_mfma_f32_16x16x32_bf16 v[80:83], v[176:179], v[140:143], v[80:83]
v_mfma_f32_16x16x32_bf16 v[80:83], v[172:175], v[116:119], v[80:83]
v_mfma_f32_16x16x32_bf16 v[84:87], v[172:175], v[120:123], v[84:87]
ds_read_b64_tr_b16 v[172:173], v3 offset:0
ds_read_b64_tr_b16 v[174:175], v3 offset:2048
v_mfma_f32_16x16x32_bf16 v[84:87], v[176:179], v[144:147], v[84:87]
ds_read_b64_tr_b16 v[176:177], v3 offset:4096
ds_read_b64_tr_b16 v[178:179], v3 offset:6144
s_waitcnt lgkmcnt(14)
v_mfma_f32_16x16x32_bf16 v[76:79], v[180:183], v[160:163], v[76:79]
s_waitcnt lgkmcnt(12)
v_mfma_f32_16x16x32_bf16 v[76:79], v[196:199], v[184:187], v[76:79]
v_mfma_f32_16x16x32_bf16 v[80:83], v[196:199], v[188:191], v[80:83]
v_mfma_f32_16x16x32_bf16 v[80:83], v[180:183], v[164:167], v[80:83]
v_mfma_f32_16x16x32_bf16 v[84:87], v[180:183], v[168:171], v[84:87]
ds_read_b64_tr_b16 v[180:181], v3 offset:8192
ds_read_b64_tr_b16 v[182:183], v3 offset:10240
v_mfma_f32_16x16x32_bf16 v[84:87], v[196:199], v[192:195], v[84:87]
ds_read_b64_tr_b16 v[196:197], v3 offset:12288
ds_read_b64_tr_b16 v[198:199], v3 offset:14336
s_waitcnt lgkmcnt(14)
v_mfma_f32_16x16x32_bf16 v[100:103], v[200:203], v[112:115], v[100:103]
s_waitcnt lgkmcnt(12)
v_mfma_f32_16x16x32_bf16 v[100:103], v[204:207], v[136:139], v[100:103]
v_mfma_f32_16x16x32_bf16 v[104:107], v[204:207], v[140:143], v[104:107]
v_mfma_f32_16x16x32_bf16 v[104:107], v[200:203], v[116:119], v[104:107]
v_mfma_f32_16x16x32_bf16 v[108:111], v[200:203], v[120:123], v[108:111]
ds_read_b64_tr_b16 v[200:201], v4 offset:0
ds_read_b64_tr_b16 v[202:203], v4 offset:2048
v_mfma_f32_16x16x32_bf16 v[108:111], v[204:207], v[144:147], v[108:111]
ds_read_b64_tr_b16 v[204:205], v4 offset:4096
ds_read_b64_tr_b16 v[206:207], v4 offset:6144
s_waitcnt lgkmcnt(14)
v_mfma_f32_16x16x32_bf16 v[100:103], v[232:235], v[160:163], v[100:103]
s_waitcnt lgkmcnt(12)
v_mfma_f32_16x16x32_bf16 v[100:103], v[236:239], v[184:187], v[100:103]
v_mfma_f32_16x16x32_bf16 v[104:107], v[236:239], v[188:191], v[104:107]
v_mfma_f32_16x16x32_bf16 v[104:107], v[232:235], v[164:167], v[104:107]
v_mfma_f32_16x16x32_bf16 v[108:111], v[232:235], v[168:171], v[108:111]
ds_read_b64_tr_b16 v[232:233], v4 offset:8192
ds_read_b64_tr_b16 v[234:235], v4 offset:10240
v_mfma_f32_16x16x32_bf16 v[108:111], v[236:239], v[192:195], v[108:111]
ds_read_b64_tr_b16 v[236:237], v4 offset:12288
ds_read_b64_tr_b16 v[238:239], v4 offset:14336
s_waitcnt lgkmcnt(14)
v_mfma_f32_16x16x32_bf16 v[28:31], v[172:175], v[112:115], v[28:31]
s_waitcnt lgkmcnt(12)
v_mfma_f32_16x16x32_bf16 v[28:31], v[176:179], v[136:139], v[28:31]
v_mfma_f32_16x16x32_bf16 v[32:35], v[176:179], v[140:143], v[32:35]
s_barrier
ds_write_b128 v242, v[76:79] offset:0
v_mfma_f32_16x16x32_bf16 v[32:35], v[172:175], v[116:119], v[32:35]
v_mfma_f32_16x16x32_bf16 v[36:39], v[172:175], v[120:123], v[36:39]
v_mfma_f32_16x16x32_bf16 v[36:39], v[176:179], v[144:147], v[36:39]
ds_write_b128 v242, v[80:83] offset:1024
s_waitcnt lgkmcnt(12)
v_mfma_f32_16x16x32_bf16 v[28:31], v[180:183], v[160:163], v[28:31]
s_waitcnt lgkmcnt(10)
v_mfma_f32_16x16x32_bf16 v[28:31], v[196:199], v[184:187], v[28:31]
v_mfma_f32_16x16x32_bf16 v[32:35], v[196:199], v[188:191], v[32:35]
ds_write_b128 v242, v[84:87] offset:2048
v_mfma_f32_16x16x32_bf16 v[32:35], v[180:183], v[164:167], v[32:35]
v_mfma_f32_16x16x32_bf16 v[36:39], v[180:183], v[168:171], v[36:39]
v_mfma_f32_16x16x32_bf16 v[36:39], v[196:199], v[192:195], v[36:39]
ds_write_b128 v242, v[100:103] offset:3072
s_waitcnt lgkmcnt(10)
v_mfma_f32_16x16x32_bf16 v[52:55], v[200:203], v[112:115], v[52:55]
s_waitcnt lgkmcnt(8)
v_mfma_f32_16x16x32_bf16 v[52:55], v[204:207], v[136:139], v[52:55]
v_mfma_f32_16x16x32_bf16 v[56:59], v[204:207], v[140:143], v[56:59]
ds_write_b128 v242, v[104:107] offset:4096
v_mfma_f32_16x16x32_bf16 v[56:59], v[200:203], v[116:119], v[56:59]
v_mfma_f32_16x16x32_bf16 v[60:63], v[200:203], v[120:123], v[60:63]
v_mfma_f32_16x16x32_bf16 v[60:63], v[204:207], v[144:147], v[60:63]
ds_write_b128 v242, v[108:111] offset:5120
s_waitcnt lgkmcnt(8)
v_mfma_f32_16x16x32_bf16 v[52:55], v[232:235], v[160:163], v[52:55]
s_waitcnt lgkmcnt(6)
v_mfma_f32_16x16x32_bf16 v[52:55], v[236:239], v[184:187], v[52:55]
v_mfma_f32_16x16x32_bf16 v[56:59], v[236:239], v[188:191], v[56:59]
v_mfma_f32_16x16x32_bf16 v[56:59], v[232:235], v[164:167], v[56:59]
v_mfma_f32_16x16x32_bf16 v[60:63], v[232:235], v[168:171], v[60:63]
v_mfma_f32_16x16x32_bf16 v[60:63], v[236:239], v[192:195], v[60:63]
v_pk_mul_f32 v[28:29], v[28:29], v[208:209] op_sel_hi:[1,0]
v_pk_mul_f32 v[30:31], v[30:31], v[208:209] op_sel_hi:[1,0]
v_pk_mul_f32 v[32:33], v[32:33], v[212:213] op_sel_hi:[1,0]
v_pk_mul_f32 v[34:35], v[34:35], v[212:213] op_sel_hi:[1,0]
v_pk_mul_f32 v[36:37], v[36:37], v[216:217] op_sel_hi:[1,0]
v_pk_mul_f32 v[38:39], v[38:39], v[216:217] op_sel_hi:[1,0]
v_pk_mul_f32 v[52:53], v[52:53], v[208:209] op_sel_hi:[1,0]
v_pk_mul_f32 v[54:55], v[54:55], v[208:209] op_sel_hi:[1,0]
v_pk_mul_f32 v[56:57], v[56:57], v[212:213] op_sel_hi:[1,0]
v_pk_mul_f32 v[58:59], v[58:59], v[212:213] op_sel_hi:[1,0]
v_pk_mul_f32 v[60:61], v[60:61], v[216:217] op_sel_hi:[1,0]
v_pk_mul_f32 v[62:63], v[62:63], v[216:217] op_sel_hi:[1,0]
s_waitcnt lgkmcnt(0)
s_barrier
ds_read_b128 v[124:127], v243 offset:0
ds_read_b128 v[148:151], v243 offset:3072
ds_read_b128 v[128:131], v243 offset:1024
ds_read_b128 v[152:155], v243 offset:4096
ds_read_b128 v[132:135], v243 offset:2048
ds_read_b128 v[156:159], v243 offset:5120
s_waitcnt lgkmcnt(5)
v_pk_fma_f32 v[28:29], v[124:125], v[210:211], v[28:29] op_sel_hi:[1,0,1]
v_pk_fma_f32 v[30:31], v[126:127], v[210:211], v[30:31] op_sel_hi:[1,0,1]
v_cvt_pk_bf16_f32 v28, v28, v29
v_cvt_pk_bf16_f32 v29, v30, v31
s_waitcnt lgkmcnt(4)
v_pk_fma_f32 v[52:53], v[148:149], v[210:211], v[52:53] op_sel_hi:[1,0,1]
v_pk_fma_f32 v[54:55], v[150:151], v[210:211], v[54:55] op_sel_hi:[1,0,1]
v_cvt_pk_bf16_f32 v30, v52, v53
v_cvt_pk_bf16_f32 v31, v54, v55
ds_write_b128 v243, v[28:31] offset:0
s_waitcnt lgkmcnt(4)
v_pk_fma_f32 v[32:33], v[128:129], v[214:215], v[32:33] op_sel_hi:[1,0,1]
v_pk_fma_f32 v[34:35], v[130:131], v[214:215], v[34:35] op_sel_hi:[1,0,1]
v_cvt_pk_bf16_f32 v32, v32, v33
v_cvt_pk_bf16_f32 v33, v34, v35
s_waitcnt lgkmcnt(3)
v_pk_fma_f32 v[56:57], v[152:153], v[214:215], v[56:57] op_sel_hi:[1,0,1]
v_pk_fma_f32 v[58:59], v[154:155], v[214:215], v[58:59] op_sel_hi:[1,0,1]
v_cvt_pk_bf16_f32 v34, v56, v57
v_cvt_pk_bf16_f32 v35, v58, v59
ds_write_b128 v243, v[32:35] offset:1024
s_waitcnt lgkmcnt(3)
v_pk_fma_f32 v[36:37], v[132:133], v[218:219], v[36:37] op_sel_hi:[1,0,1]
v_pk_fma_f32 v[38:39], v[134:135], v[218:219], v[38:39] op_sel_hi:[1,0,1]
v_cvt_pk_bf16_f32 v36, v36, v37
v_cvt_pk_bf16_f32 v37, v38, v39
s_waitcnt lgkmcnt(2)
v_pk_fma_f32 v[60:61], v[156:157], v[218:219], v[60:61] op_sel_hi:[1,0,1]
v_pk_fma_f32 v[62:63], v[158:159], v[218:219], v[62:63] op_sel_hi:[1,0,1]
v_cvt_pk_bf16_f32 v38, v60, v61
v_cvt_pk_bf16_f32 v39, v62, v63
ds_write_b128 v243, v[36:39] offset:2048
s_waitcnt lgkmcnt(0)
s_barrier
s_barrier
ds_read_b64_tr_b16 v[172:173], v5 offset:32768
ds_read_b64_tr_b16 v[174:175], v5 offset:34816
ds_read_b64_tr_b16 v[176:177], v5 offset:36864
ds_read_b64_tr_b16 v[178:179], v5 offset:38912
ds_read_b64_tr_b16 v[180:181], v5 offset:40960
ds_read_b64_tr_b16 v[182:183], v5 offset:43008
ds_read_b64_tr_b16 v[196:197], v5 offset:45056
ds_read_b64_tr_b16 v[198:199], v5 offset:47104
ds_read_b64_tr_b16 v[200:201], v6 offset:32768
ds_read_b64_tr_b16 v[202:203], v6 offset:34816
ds_read_b64_tr_b16 v[204:205], v6 offset:36864
ds_read_b64_tr_b16 v[206:207], v6 offset:38912
ds_read_b64_tr_b16 v[232:233], v6 offset:40960
ds_read_b64_tr_b16 v[234:235], v6 offset:43008
ds_read_b64_tr_b16 v[236:237], v6 offset:45056
ds_read_b64_tr_b16 v[238:239], v6 offset:47104
s_waitcnt lgkmcnt(14)
v_mfma_f32_16x16x32_bf16 v[76:79], v[172:175], v[16:19], 0
s_waitcnt lgkmcnt(12)
v_mfma_f32_16x16x32_bf16 v[76:79], v[176:179], v[40:43], v[76:79]
v_mfma_f32_16x16x32_bf16 v[80:83], v[176:179], v[44:47], 0
v_mfma_f32_16x16x32_bf16 v[80:83], v[172:175], v[20:23], v[80:83]
v_mfma_f32_16x16x32_bf16 v[84:87], v[172:175], v[24:27], 0
ds_read_b64_tr_b16 v[172:173], v3 offset:32768
ds_read_b64_tr_b16 v[174:175], v3 offset:34816
v_mfma_f32_16x16x32_bf16 v[84:87], v[176:179], v[48:51], v[84:87]
ds_read_b64_tr_b16 v[176:177], v3 offset:36864
ds_read_b64_tr_b16 v[178:179], v3 offset:38912
s_waitcnt lgkmcnt(14)
v_mfma_f32_16x16x32_bf16 v[76:79], v[180:183], v[64:67], v[76:79]
s_waitcnt lgkmcnt(12)
v_mfma_f32_16x16x32_bf16 v[76:79], v[196:199], v[88:91], v[76:79]
v_mfma_f32_16x16x32_bf16 v[80:83], v[196:199], v[92:95], v[80:83]
v_mfma_f32_16x16x32_bf16 v[80:83], v[180:183], v[68:71], v[80:83]
v_mfma_f32_16x16x32_bf16 v[84:87], v[180:183], v[72:75], v[84:87]
ds_read_b64_tr_b16 v[180:181], v3 offset:40960
ds_read_b64_tr_b16 v[182:183], v3 offset:43008
v_mfma_f32_16x16x32_bf16 v[84:87], v[196:199], v[96:99], v[84:87]
ds_read_b64_tr_b16 v[196:197], v3 offset:45056
ds_read_b64_tr_b16 v[198:199], v3 offset:47104
s_waitcnt lgkmcnt(14)
v_mfma_f32_16x16x32_bf16 v[100:103], v[200:203], v[16:19], 0
s_waitcnt lgkmcnt(12)
v_mfma_f32_16x16x32_bf16 v[100:103], v[204:207], v[40:43], v[100:103]
v_mfma_f32_16x16x32_bf16 v[104:107], v[204:207], v[44:47], 0
s_barrier
v_mfma_f32_16x16x32_bf16 v[104:107], v[200:203], v[20:23], v[104:107]
v_mfma_f32_16x16x32_bf16 v[108:111], v[200:203], v[24:27], 0
ds_read_b64_tr_b16 v[200:201], v4 offset:32768
ds_read_b64_tr_b16 v[202:203], v4 offset:34816
v_mfma_f32_16x16x32_bf16 v[108:111], v[204:207], v[48:51], v[108:111]
ds_read_b64_tr_b16 v[204:205], v4 offset:36864
ds_read_b64_tr_b16 v[206:207], v4 offset:38912
s_waitcnt lgkmcnt(14)
v_mfma_f32_16x16x32_bf16 v[100:103], v[232:235], v[64:67], v[100:103]
s_waitcnt lgkmcnt(12)
v_mfma_f32_16x16x32_bf16 v[100:103], v[236:239], v[88:91], v[100:103]
v_mfma_f32_16x16x32_bf16 v[104:107], v[236:239], v[92:95], v[104:107]
v_mfma_f32_16x16x32_bf16 v[104:107], v[232:235], v[68:71], v[104:107]
v_mfma_f32_16x16x32_bf16 v[108:111], v[232:235], v[72:75], v[108:111]
ds_read_b64_tr_b16 v[232:233], v4 offset:40960
ds_read_b64_tr_b16 v[234:235], v4 offset:43008
v_mfma_f32_16x16x32_bf16 v[108:111], v[236:239], v[96:99], v[108:111]
ds_read_b64_tr_b16 v[236:237], v4 offset:45056
ds_read_b64_tr_b16 v[238:239], v4 offset:47104
s_waitcnt lgkmcnt(14)
v_mfma_f32_16x16x32_bf16 v[28:31], v[172:175], v[16:19], 0
s_waitcnt lgkmcnt(12)
v_mfma_f32_16x16x32_bf16 v[28:31], v[176:179], v[40:43], v[28:31]
v_mfma_f32_16x16x32_bf16 v[32:35], v[176:179], v[44:47], 0
v_mfma_f32_16x16x32_bf16 v[32:35], v[172:175], v[20:23], v[32:35]
v_mfma_f32_16x16x32_bf16 v[36:39], v[172:175], v[24:27], 0
v_mfma_f32_16x16x32_bf16 v[36:39], v[176:179], v[48:51], v[36:39]
s_waitcnt lgkmcnt(10)
v_mfma_f32_16x16x32_bf16 v[28:31], v[180:183], v[64:67], v[28:31]
s_waitcnt lgkmcnt(8)
v_mfma_f32_16x16x32_bf16 v[28:31], v[196:199], v[88:91], v[28:31]
v_mfma_f32_16x16x32_bf16 v[32:35], v[196:199], v[92:95], v[32:35]
s_barrier
v_mfma_f32_16x16x32_bf16 v[32:35], v[180:183], v[68:71], v[32:35]
v_mfma_f32_16x16x32_bf16 v[36:39], v[180:183], v[72:75], v[36:39]
v_mfma_f32_16x16x32_bf16 v[36:39], v[196:199], v[96:99], v[36:39]
s_waitcnt lgkmcnt(6)
v_mfma_f32_16x16x32_bf16 v[52:55], v[200:203], v[16:19], 0
s_waitcnt lgkmcnt(4)
v_mfma_f32_16x16x32_bf16 v[52:55], v[204:207], v[40:43], v[52:55]
v_mfma_f32_16x16x32_bf16 v[56:59], v[204:207], v[44:47], 0
v_mfma_f32_16x16x32_bf16 v[56:59], v[200:203], v[20:23], v[56:59]
v_mfma_f32_16x16x32_bf16 v[60:63], v[200:203], v[24:27], 0
v_mfma_f32_16x16x32_bf16 v[60:63], v[204:207], v[48:51], v[60:63]
s_waitcnt lgkmcnt(2)
v_mfma_f32_16x16x32_bf16 v[52:55], v[232:235], v[64:67], v[52:55]
s_waitcnt lgkmcnt(0)
v_mfma_f32_16x16x32_bf16 v[52:55], v[236:239], v[88:91], v[52:55]
v_mfma_f32_16x16x32_bf16 v[56:59], v[236:239], v[92:95], v[56:59]
v_mfma_f32_16x16x32_bf16 v[56:59], v[232:235], v[68:71], v[56:59]
v_mfma_f32_16x16x32_bf16 v[60:63], v[232:235], v[72:75], v[60:63]
v_mfma_f32_16x16x32_bf16 v[60:63], v[236:239], v[96:99], v[60:63]
v_lshrrev_b32 v7, 3, v1
v_and_b32 v2, 6, v7
v_xor_b32 v2, v2, v1
v_and_b32 v2, 7, v2
s_lshl_b32 s60, s52, 3
v_add_u32 v7, s60, v7
v_mul_u32_u24 v7, 896, v7
v_lshl_add_u32 v7, v2, 4, v7
s_lshl_b32 s53, s52, 10
s_sub_u32 s60, s3, s55
s_and_b32 s60, s60, 7
s_add_u32 s61, s60, 5
s_mul_i32 s64, s61, 37
s_lshr_b32 s64, s64, 8
s_mul_i32 s64, s64, 7
s_sub_u32 s61, s61, s64
s_lshl_b32 s80, s61, 7
s_add_u32 s61, s60, 6
s_mul_i32 s64, s61, 37
s_lshr_b32 s64, s64, 8
s_mul_i32 s64, s64, 7
s_sub_u32 s61, s61, s64
s_lshl_b32 s81, s61, 7
s_add_u32 s61, s60, 7
s_mul_i32 s64, s61, 37
s_lshr_b32 s64, s64, 8
s_mul_i32 s64, s64, 7
s_sub_u32 s61, s61, s64
s_lshl_b32 s82, s61, 7
s_barrier
ds_read_b64_tr_b16 v[172:173], v5 offset:0
ds_read_b64_tr_b16 v[174:175], v5 offset:2048
ds_read_b64_tr_b16 v[176:177], v5 offset:4096
ds_read_b64_tr_b16 v[178:179], v5 offset:6144
ds_read_b64_tr_b16 v[180:181], v5 offset:8192
ds_read_b64_tr_b16 v[182:183], v5 offset:10240
ds_read_b64_tr_b16 v[196:197], v5 offset:12288
ds_read_b64_tr_b16 v[198:199], v5 offset:14336
ds_read_b64_tr_b16 v[200:201], v6 offset:0
ds_read_b64_tr_b16 v[202:203], v6 offset:2048
ds_read_b64_tr_b16 v[204:205], v6 offset:4096
ds_read_b64_tr_b16 v[206:207], v6 offset:6144
ds_read_b64_tr_b16 v[232:233], v6 offset:8192
ds_read_b64_tr_b16 v[234:235], v6 offset:10240
ds_read_b64_tr_b16 v[236:237], v6 offset:12288
ds_read_b64_tr_b16 v[238:239], v6 offset:14336
s_waitcnt lgkmcnt(14)
v_mfma_f32_16x16x32_bf16 v[76:79], v[172:175], v[112:115], v[76:79]
s_waitcnt lgkmcnt(12)
v_mfma_f32_16x16x32_bf16 v[76:79], v[176:179], v[136:139], v[76:79]
v_mfma_f32_16x16x32_bf16 v[80:83], v[176:179], v[140:143], v[80:83]
v_mfma_f32_16x16x32_bf16 v[80:83], v[172:175], v[116:119], v[80:83]
v_mfma_f32_16x16x32_bf16 v[84:87], v[172:175], v[120:123], v[84:87]
ds_read_b64_tr_b16 v[172:173], v3 offset:0
ds_read_b64_tr_b16 v[174:175], v3 offset:2048
v_mfma_f32_16x16x32_bf16 v[84:87], v[176:179], v[144:147], v[84:87]
ds_read_b64_tr_b16 v[176:177], v3 offset:4096
ds_read_b64_tr_b16 v[178:179], v3 offset:6144
s_waitcnt lgkmcnt(14)
v_mfma_f32_16x16x32_bf16 v[76:79], v[180:183], v[160:163], v[76:79]
s_waitcnt lgkmcnt(12)
v_mfma_f32_16x16x32_bf16 v[76:79], v[196:199], v[184:187], v[76:79]
v_mfma_f32_16x16x32_bf16 v[80:83], v[196:199], v[188:191], v[80:83]
v_mfma_f32_16x16x32_bf16 v[80:83], v[180:183], v[164:167], v[80:83]
v_mfma_f32_16x16x32_bf16 v[84:87], v[180:183], v[168:171], v[84:87]
ds_read_b64_tr_b16 v[180:181], v3 offset:8192
ds_read_b64_tr_b16 v[182:183], v3 offset:10240
v_mfma_f32_16x16x32_bf16 v[84:87], v[196:199], v[192:195], v[84:87]
ds_read_b64_tr_b16 v[196:197], v3 offset:12288
ds_read_b64_tr_b16 v[198:199], v3 offset:14336
s_cmp_lg_u32 s52, 0
s_cbranch_scc1 L_gs
s_mov_b64 exec, 255
buffer_store_dword v13, v12, s[48:51], 0 offen sc1
s_mov_b64 exec, -1
L_gs:
s_waitcnt lgkmcnt(14)
v_mfma_f32_16x16x32_bf16 v[100:103], v[200:203], v[112:115], v[100:103]
s_waitcnt lgkmcnt(12)
v_mfma_f32_16x16x32_bf16 v[100:103], v[204:207], v[136:139], v[100:103]
v_mfma_f32_16x16x32_bf16 v[104:107], v[204:207], v[140:143], v[104:107]
v_mfma_f32_16x16x32_bf16 v[104:107], v[200:203], v[116:119], v[104:107]
v_mfma_f32_16x16x32_bf16 v[108:111], v[200:203], v[120:123], v[108:111]
ds_read_b64_tr_b16 v[200:201], v4 offset:0
ds_read_b64_tr_b16 v[202:203], v4 offset:2048
v_mfma_f32_16x16x32_bf16 v[108:111], v[204:207], v[144:147], v[108:111]
ds_read_b64_tr_b16 v[204:205], v4 offset:4096
ds_read_b64_tr_b16 v[206:207], v4 offset:6144
s_waitcnt lgkmcnt(14)
v_mfma_f32_16x16x32_bf16 v[100:103], v[232:235], v[160:163], v[100:103]
s_waitcnt lgkmcnt(12)
v_mfma_f32_16x16x32_bf16 v[100:103], v[236:239], v[184:187], v[100:103]
v_mfma_f32_16x16x32_bf16 v[104:107], v[236:239], v[188:191], v[104:107]
v_mfma_f32_16x16x32_bf16 v[104:107], v[232:235], v[164:167], v[104:107]
v_mfma_f32_16x16x32_bf16 v[108:111], v[232:235], v[168:171], v[108:111]
ds_read_b64_tr_b16 v[232:233], v4 offset:8192
ds_read_b64_tr_b16 v[234:235], v4 offset:10240
v_mfma_f32_16x16x32_bf16 v[108:111], v[236:239], v[192:195], v[108:111]
ds_read_b64_tr_b16 v[236:237], v4 offset:12288
ds_read_b64_tr_b16 v[238:239], v4 offset:14336
s_waitcnt lgkmcnt(14)
v_mfma_f32_16x16x32_bf16 v[28:31], v[172:175], v[112:115], v[28:31]
s_waitcnt lgkmcnt(12)
v_mfma_f32_16x16x32_bf16 v[28:31], v[176:179], v[136:139], v[28:31]
v_mfma_f32_16x16x32_bf16 v[32:35], v[176:179], v[140:143], v[32:35]
ds_write_b128 v242, v[76:79] offset:0
v_mfma_f32_16x16x32_bf16 v[32:35], v[172:175], v[116:119], v[32:35]
v_mfma_f32_16x16x32_bf16 v[36:39], v[172:175], v[120:123], v[36:39]
v_mfma_f32_16x16x32_bf16 v[36:39], v[176:179], v[144:147], v[36:39]
ds_write_b128 v242, v[80:83] offset:1024
s_waitcnt lgkmcnt(12)
v_mfma_f32_16x16x32_bf16 v[28:31], v[180:183], v[160:163], v[28:31]
s_waitcnt lgkmcnt(10)
v_mfma_f32_16x16x32_bf16 v[28:31], v[196:199], v[184:187], v[28:31]
v_mfma_f32_16x16x32_bf16 v[32:35], v[196:199], v[188:191], v[32:35]
ds_write_b128 v242, v[84:87] offset:2048
v_mfma_f32_16x16x32_bf16 v[32:35], v[180:183], v[164:167], v[32:35]
v_mfma_f32_16x16x32_bf16 v[36:39], v[180:183], v[168:171], v[36:39]
v_mfma_f32_16x16x32_bf16 v[36:39], v[196:199], v[192:195], v[36:39]
ds_write_b128 v242, v[100:103] offset:3072
s_waitcnt lgkmcnt(10)
v_mfma_f32_16x16x32_bf16 v[52:55], v[200:203], v[112:115], v[52:55]
s_waitcnt lgkmcnt(8)
v_mfma_f32_16x16x32_bf16 v[52:55], v[204:207], v[136:139], v[52:55]
v_mfma_f32_16x16x32_bf16 v[56:59], v[204:207], v[140:143], v[56:59]
ds_write_b128 v242, v[104:107] offset:4096
v_mfma_f32_16x16x32_bf16 v[56:59], v[200:203], v[116:119], v[56:59]
v_mfma_f32_16x16x32_bf16 v[60:63], v[200:203], v[120:123], v[60:63]
v_mfma_f32_16x16x32_bf16 v[60:63], v[204:207], v[144:147], v[60:63]
ds_write_b128 v242, v[108:111] offset:5120
s_waitcnt lgkmcnt(8)
v_mfma_f32_16x16x32_bf16 v[52:55], v[232:235], v[160:163], v[52:55]
s_waitcnt lgkmcnt(6)
v_mfma_f32_16x16x32_bf16 v[52:55], v[236:239], v[184:187], v[52:55]
v_mfma_f32_16x16x32_bf16 v[56:59], v[236:239], v[188:191], v[56:59]
v_mfma_f32_16x16x32_bf16 v[56:59], v[232:235], v[164:167], v[56:59]
v_mfma_f32_16x16x32_bf16 v[60:63], v[232:235], v[168:171], v[60:63]
v_mfma_f32_16x16x32_bf16 v[60:63], v[236:239], v[192:195], v[60:63]
s_waitcnt lgkmcnt(0)
s_barrier
ds_read_b128 v[124:127], v243 offset:0
ds_read_b128 v[148:151], v243 offset:3072
ds_read_b128 v[128:131], v243 offset:1024
ds_read_b128 v[152:155], v243 offset:4096
ds_read_b128 v[132:135], v243 offset:2048
ds_read_b128 v[156:159], v243 offset:5120
v_pk_mul_f32 v[28:29], v[28:29], v[208:209] op_sel_hi:[1,0]
v_pk_mul_f32 v[30:31], v[30:31], v[208:209] op_sel_hi:[1,0]
v_pk_mul_f32 v[32:33], v[32:33], v[212:213] op_sel_hi:[1,0]
v_pk_mul_f32 v[34:35], v[34:35], v[212:213] op_sel_hi:[1,0]
v_pk_mul_f32 v[36:37], v[36:37], v[216:217] op_sel_hi:[1,0]
v_pk_mul_f32 v[38:39], v[38:39], v[216:217] op_sel_hi:[1,0]
v_pk_mul_f32 v[52:53], v[52:53], v[208:209] op_sel_hi:[1,0]
v_pk_mul_f32 v[54:55], v[54:55], v[208:209] op_sel_hi:[1,0]
v_pk_mul_f32 v[56:57], v[56:57], v[212:213] op_sel_hi:[1,0]
v_pk_mul_f32 v[58:59], v[58:59], v[212:213] op_sel_hi:[1,0]
v_pk_mul_f32 v[60:61], v[60:61], v[216:217] op_sel_hi:[1,0]
v_pk_mul_f32 v[62:63], v[62:63], v[216:217] op_sel_hi:[1,0]
s_waitcnt lgkmcnt(5)
v_pk_fma_f32 v[28:29], v[124:125], v[210:211], v[28:29] op_sel_hi:[1,0,1]
v_pk_fma_f32 v[30:31], v[126:127], v[210:211], v[30:31] op_sel_hi:[1,0,1]
v_cvt_pk_bf16_f32 v28, v28, v29
v_cvt_pk_bf16_f32 v29, v30, v31
s_waitcnt lgkmcnt(4)
v_pk_fma_f32 v[52:53], v[148:149], v[210:211], v[52:53] op_sel_hi:[1,0,1]
v_pk_fma_f32 v[54:55], v[150:151], v[210:211], v[54:55] op_sel_hi:[1,0,1]
v_cvt_pk_bf16_f32 v30, v52, v53
v_cvt_pk_bf16_f32 v31, v54, v55
ds_write_b128 v243, v[28:31] offset:0
s_waitcnt lgkmcnt(4)
v_pk_fma_f32 v[32:33], v[128:129], v[214:215], v[32:33] op_sel_hi:[1,0,1]
v_pk_fma_f32 v[34:35], v[130:131], v[214:215], v[34:35] op_sel_hi:[1,0,1]
v_cvt_pk_bf16_f32 v32, v32, v33
v_cvt_pk_bf16_f32 v33, v34, v35
s_waitcnt lgkmcnt(3)
v_pk_fma_f32 v[56:57], v[152:153], v[214:215], v[56:57] op_sel_hi:[1,0,1]
v_pk_fma_f32 v[58:59], v[154:155], v[214:215], v[58:59] op_sel_hi:[1,0,1]
v_cvt_pk_bf16_f32 v34, v56, v57
v_cvt_pk_bf16_f32 v35, v58, v59
ds_write_b128 v243, v[32:35] offset:1024
s_waitcnt lgkmcnt(3)
v_pk_fma_f32 v[36:37], v[132:133], v[218:219], v[36:37] op_sel_hi:[1,0,1]
v_pk_fma_f32 v[38:39], v[134:135], v[218:219], v[38:39] op_sel_hi:[1,0,1]
v_cvt_pk_bf16_f32 v36, v36, v37
v_cvt_pk_bf16_f32 v37, v38, v39
s_waitcnt lgkmcnt(2)
v_pk_fma_f32 v[60:61], v[156:157], v[218:219], v[60:61] op_sel_hi:[1,0,1]
v_pk_fma_f32 v[62:63], v[158:159], v[218:219], v[62:63] op_sel_hi:[1,0,1]
v_cvt_pk_bf16_f32 v38, v60, v61
v_cvt_pk_bf16_f32 v39, v62, v63
ds_write_b128 v243, v[36:39] offset:2048
s_waitcnt lgkmcnt(0)
s_barrier
s_add_u32 m0, s53, 114688
s_add_u32 s54, s80, 344064
buffer_load_dwordx4 v7, s[36:39], s54 offen  lds
s_add_u32 m0, s53, 143360
s_add_u32 s54, s80, 372736
buffer_load_dwordx4 v7, s[36:39], s54 offen  lds
s_add_u32 m0, s53, 118784
s_add_u32 s54, s81, 344064
buffer_load_dwordx4 v7, s[36:39], s54 offen  lds
s_add_u32 m0, s53, 147456
s_add_u32 s54, s81, 372736
buffer_load_dwordx4 v7, s[36:39], s54 offen  lds
s_add_u32 m0, s53, 122880
s_add_u32 s54, s82, 344064
buffer_load_dwordx4 v7, s[36:39], s54 offen  lds
s_add_u32 m0, s53, 151552
s_add_u32 s54, s82, 372736
buffer_load_dwordx4 v7, s[36:39], s54 offen  lds
v_mov_b32 v10, 2
s_waitcnt vmcnt(0)
s_barrier
s_barrier
s_cmp_lg_u32 s52, 0
s_cbranch_scc1 L_gd
s_mov_b64 exec, 0xff
buffer_store_dword v10, v12, s[48:51], 0 offen sc1
s_mov_b64 exec, -1
L_gd:
s_sub_u32 s56, s3, s55
s_and_b32 s56, s56, 7
s_and_b32 s64, s52, 3
s_lshl_b32 s64, s64, 3
v_lshrrev_b32 v19, 3, v1
v_add_u32 v19, s64, v19
v_and_b32 v17, 7, v1
v_lshlrev_b32 v17, 4, v17
v_mul_u32_u24 v18, 896, v19
s_lshl_b32 s60, s56, 7
v_add3_u32 v18, v18, v17, s60
v_lshrrev_b32 v20, 5, v17
v_mul_u32_u24 v20, 1504, v20
v_lshl_add_u32 v20, v19, 5, v20
v_add_u32 v20, v20, v17
s_mul_i32 s60, s56, 49152
v_add_u32 v16, s60, v20
v_add_u32 v20, 155648, v20
s_lshl_b32 s60, s3, 7
v_and_b32 v17, 7, v1
v_lshl_add_u32 v17, v17, 2, s60
s_mul_i32 s65, s55, 43008
s_add_u32 s44, s14, s65
s_addc_u32 s45, s15, 0
s_and_b32 s45, s45, 0xffff
s_mov_b32 s46, 43008
s_mov_b32 s47, 0x20000
s_cmp_eq_u32 s56, 7
s_cbranch_scc1 L_finA
s_lshl_b32 s65, 1, s3
s_cmp_lg_u32 s3, 0
s_cbranch_scc1 L_oA0
ds_read_b128 v[24:27], v20
L_oA0:
s_cmp_lg_u32 s3, 1
s_cbranch_scc1 L_oA1
ds_read_b128 v[28:31], v20
L_oA1:
s_cmp_lg_u32 s3, 2
s_cbranch_scc1 L_oA2
ds_read_b128 v[32:35], v20
L_oA2:
s_cmp_lg_u32 s3, 3
s_cbranch_scc1 L_oA3
ds_read_b128 v[36:39], v20
L_oA3:
s_cmp_lg_u32 s3, 4
s_cbranch_scc1 L_oA4
ds_read_b128 v[40:43], v20
L_oA4:
s_cmp_lg_u32 s3, 5
s_cbranch_scc1 L_oA5
ds_read_b128 v[44:47], v20
L_oA5:
s_cmp_lg_u32 s3, 6
s_cbranch_scc1 L_oA6
ds_read_b128 v[48:51], v20
L_oA6:
s_cmp_lg_u32 s3, 7
s_cbranch_scc1 L_oA7
ds_read_b128 v[52:55], v20
L_oA7:
L_pollA:
s_sleep 1
buffer_load_dword v19, v17, s[48:51], 0 offen sc1
s_sub_u32 s57, s57, 1
s_cbranch_scc1 L_end
L_chkA:
s_waitcnt vmcnt(0)
v_cmp_eq_u32 vcc, 2, v19
s_nop 0
s_andn2_b32 s60, vcc_lo, s65
s_and_b32 s60, s60, 0xff
s_cbranch_scc0 L_pollA
s_bitcmp1_b32 s60, 0
s_cbranch_scc0 L_lA0
s_mov_b32 s54, 0
buffer_load_dwordx4 v[24:27], v16, s[40:43], s54 offen sc1
L_lA0:
s_bitcmp1_b32 s60, 1
s_cbranch_scc0 L_lA1
s_mov_b32 s54, 6144
buffer_load_dwordx4 v[28:31], v16, s[40:43], s54 offen sc1
L_lA1:
s_bitcmp1_b32 s60, 2
s_cbranch_scc0 L_lA2
s_mov_b32 s54, 12288
buffer_load_dwordx4 v[32:35], v16, s[40:43], s54 offen sc1
L_lA2:
s_bitcmp1_b32 s60, 3
s_cbranch_scc0 L_lA3
s_mov_b32 s54, 18432
buffer_load_dwordx4 v[36:39], v16, s[40:43], s54 offen sc1
L_lA3:
s_bitcmp1_b32 s60, 4
s_cbranch_scc0 L_lA4
s_mov_b32 s54, 24576
buffer_load_dwordx4 v[40:43], v16, s[40:43], s54 offen sc1
L_lA4:
s_bitcmp1_b32 s60, 5
s_cbranch_scc0 L_lA5
s_mov_b32 s54, 30720
buffer_load_dwordx4 v[44:47], v16, s[40:43], s54 offen sc1
L_lA5:
s_bitcmp1_b32 s60, 6
s_cbranch_scc0 L_lA6
s_mov_b32 s54, 36864
buffer_load_dwordx4 v[48:51], v16, s[40:43], s54 offen sc1
L_lA6:
s_bitcmp1_b32 s60, 7
s_cbranch_scc0 L_lA7
s_mov_b32 s54, 43008
buffer_load_dwordx4 v[52:55], v16, s[40:43], s54 offen sc1
L_lA7:
s_or_b32 s65, s65, s60
s_cmp_lg_u32 s65, 0xff
s_cbranch_scc1 L_pollA
s_waitcnt vmcnt(0) lgkmcnt(0)
v_lshlrev_b32 v56, 16, v24
v_and_b32 v57, 0xffff0000, v24
v_lshlrev_b32 v58, 16, v25
v_and_b32 v59, 0xffff0000, v25
v_lshlrev_b32 v60, 16, v26
v_and_b32 v61, 0xffff0000, v26
v_lshlrev_b32 v62, 16, v27
v_and_b32 v63, 0xffff0000, v27
v_lshlrev_b32 v64, 16, v28
v_and_b32 v65, 0xffff0000, v28
v_pk_add_f32 v[56:57], v[56:57], v[64:65]
v_lshlrev_b32 v64, 16, v29
v_and_b32 v65, 0xffff0000, v29
v_pk_add_f32 v[58:59], v[58:59], v[64:65]
v_lshlrev_b32 v64, 16, v30
v_and_b32 v65, 0xffff0000, v30
v_pk_add_f32 v[60:61], v[60:61], v[64:65]
v_lshlrev_b32 v64, 16, v31
v_and_b32 v65, 0xffff0000, v31
v_pk_add_f32 v[62:63], v[62:63], v[64:65]
v_lshlrev_b32 v64, 16, v32
v_and_b32 v65, 0xffff0000, v32
v_pk_add_f32 v[56:57], v[56:57], v[64:65]
v_lshlrev_b32 v64, 16, v33
v_and_b32 v65, 0xffff0000, v33
v_pk_add_f32 v[58:59], v[58:59], v[64:65]
v_lshlrev_b32 v64, 16, v34
v_and_b32 v65, 0xffff0000, v34
v_pk_add_f32 v[60:61], v[60:61], v[64:65]
v_lshlrev_b32 v64, 16, v35
v_and_b32 v65, 0xffff0000, v35
v_pk_add_f32 v[62:63], v[62:63], v[64:65]
v_lshlrev_b32 v64, 16, v36
v_and_b32 v65, 0xffff0000, v36
v_pk_add_f32 v[56:57], v[56:57], v[64:65]
v_lshlrev_b32 v64, 16, v37
v_and_b32 v65, 0xffff0000, v37
v_pk_add_f32 v[58:59], v[58:59], v[64:65]
v_lshlrev_b32 v64, 16, v38
v_and_b32 v65, 0xffff0000, v38
v_pk_add_f32 v[60:61], v[60:61], v[64:65]
v_lshlrev_b32 v64, 16, v39
v_and_b32 v65, 0xffff0000, v39
v_pk_add_f32 v[62:63], v[62:63], v[64:65]
v_lshlrev_b32 v64, 16, v40
v_and_b32 v65, 0xffff0000, v40
v_pk_add_f32 v[56:57], v[56:57], v[64:65]
v_lshlrev_b32 v64, 16, v41
v_and_b32 v65, 0xffff0000, v41
v_pk_add_f32 v[58:59], v[58:59], v[64:65]
v_lshlrev_b32 v64, 16, v42
v_and_b32 v65, 0xffff0000, v42
v_pk_add_f32 v[60:61], v[60:61], v[64:65]
v_lshlrev_b32 v64, 16, v43
v_and_b32 v65, 0xffff0000, v43
v_pk_add_f32 v[62:63], v[62:63], v[64:65]
v_lshlrev_b32 v64, 16, v44
v_and_b32 v65, 0xffff0000, v44
v_pk_add_f32 v[56:57], v[56:57], v[64:65]
v_lshlrev_b32 v64, 16, v45
v_and_b32 v65, 0xffff0000, v45
v_pk_add_f32 v[58:59], v[58:59], v[64:65]
v_lshlrev_b32 v64, 16, v46
v_and_b32 v65, 0xffff0000, v46
v_pk_add_f32 v[60:61], v[60:61], v[64:65]
v_lshlrev_b32 v64, 16, v47
v_and_b32 v65, 0xffff0000, v47
v_pk_add_f32 v[62:63], v[62:63], v[64:65]
v_lshlrev_b32 v64, 16, v48
v_and_b32 v65, 0xffff0000, v48
v_pk_add_f32 v[56:57], v[56:57], v[64:65]
v_lshlrev_b32 v64, 16, v49
v_and_b32 v65, 0xffff0000, v49
v_pk_add_f32 v[58:59], v[58:59], v[64:65]
v_lshlrev_b32 v64, 16, v50
v_and_b32 v65, 0xffff0000, v50
v_pk_add_f32 v[60:61], v[60:61], v[64:65]
v_lshlrev_b32 v64, 16, v51
v_and_b32 v65, 0xffff0000, v51
v_pk_add_f32 v[62:63], v[62:63], v[64:65]
v_lshlrev_b32 v64, 16, v52
v_and_b32 v65, 0xffff0000, v52
v_pk_add_f32 v[56:57], v[56:57], v[64:65]
v_lshlrev_b32 v64, 16, v53
v_and_b32 v65, 0xffff0000, v53
v_pk_add_f32 v[58:59], v[58:59], v[64:65]
v_lshlrev_b32 v64, 16, v54
v_and_b32 v65, 0xffff0000, v54
v_pk_add_f32 v[60:61], v[60:61], v[64:65]
v_lshlrev_b32 v64, 16, v55
v_and_b32 v65, 0xffff0000, v55
v_pk_add_f32 v[62:63], v[62:63], v[64:65]
v_cvt_pk_bf16_f32 v24, v56, v57
v_cvt_pk_bf16_f32 v25, v58, v59
v_cvt_pk_bf16_f32 v26, v60, v61
v_cvt_pk_bf16_f32 v27, v62, v63
buffer_store_dwordx4 v[24:27], v18, s[44:47], 0 offen sc1
L_finA:
s_endpgm
L_last:
.section .rodata,"a"
.p2align 6
.amdhsa_kernel standalone__gqa_block_cached__near_ridge_kernel
  .amdhsa_next_free_vgpr 256
  .amdhsa_next_free_sgpr 102
  .amdhsa_accum_offset 256
  .amdhsa_group_segment_fixed_size 0
  .amdhsa_kernarg_size 64
  .amdhsa_user_sgpr_count 2
  .amdhsa_user_sgpr_kernarg_segment_ptr 1
  .amdhsa_system_sgpr_workgroup_id_x 1
  .amdhsa_float_denorm_mode_32 3
.end_amdhsa_kernel
```
